```python
import torch

def _softmax(x, axis=-1):
    return torch.softmax(x, dim=axis)
def _gelu(x):
    return torch.nn.functional.gelu(x, approximate="tanh")
def _silu(x):
    return torch.nn.functional.silu(x)
def _sigmoid(x):
    return torch.sigmoid(x)
def _layernorm(x, axis=-1, eps=1e-5):
    m = x.mean(dim=axis, keepdim=True)
    v = x.var(dim=axis, keepdim=True, unbiased=False)
    return (x - m) / torch.sqrt(v + eps)
def _scatter_add(tgt, idx, src, axis=0):
    return tgt.clone().index_add_(axis, idx, src)
def _segment_sum(src, seg, n):
    out = torch.zeros((n,) + src.shape[1:], dtype=src.dtype)
    return out.index_add_(0, seg, src)
def _pad(x, pw):
    flat = tuple(v for pair in reversed(pw) for v in pair)
    return torch.nn.functional.pad(x, flat)

kernel_name = 'sequential_preLN__grouped_kv_mqa__mixer_channel_mlp__prompt'

def setup_inputs():

    _w = (lambda a: (lambda t: t.to(torch.bfloat16) if t.is_floating_point() else t)(torch.as_tensor(a)))
    def _A_setup():
        B, S, D, H = 1, 2048, 576, 32
        Dh = D // H
        return {
            "x": _w((lambda *s: torch.randn(*s, dtype=torch.bfloat16) * 0.05)(B, S, D)),
            "wq": _w((lambda *s: torch.randn(*s, dtype=torch.bfloat16) * 0.05)(D, H * Dh)),
            "wk": _w((lambda *s: torch.randn(*s, dtype=torch.bfloat16) * 0.05)(D, Dh)),
            "wv": _w((lambda *s: torch.randn(*s, dtype=torch.bfloat16) * 0.05)(D, Dh)),
            "wo": _w((lambda *s: torch.randn(*s, dtype=torch.bfloat16) * 0.05)(H * Dh, D)),
        }
    _A_in = _A_setup()

    def _B_setup():
        B, S, D, F = 1, 2048, 576, 4608
        return {
            "x": _w((lambda *s: torch.randn(*s, dtype=torch.bfloat16) * 0.05)(B, S, D)),
            "w1": _w((lambda *s: torch.randn(*s, dtype=torch.bfloat16) * 3.2)(D, F) * (D ** -0.5)),
            "b1": _w((lambda *s: torch.randn(*s, dtype=torch.bfloat16) * 1.6)(F)),
            "w2": _w((lambda *s: torch.randn(*s, dtype=torch.bfloat16) * 0.1)(F, D) * (F ** -0.5)),
            "b2": _w((lambda *s: torch.randn(*s, dtype=torch.bfloat16) * 0.2)(D)),
        }
    _B_in = _B_setup()

    return {
        "A_x": _A_in["x"],
        "A_wq": _A_in["wq"],
        "A_wk": _A_in["wk"],
        "A_wv": _A_in["wv"],
        "A_wo": _A_in["wo"],
        "B_x": _B_in["x"],
        "B_w1": _B_in["w1"],
        "B_b1": _B_in["b1"],
        "B_w2": _B_in["w2"],
        "B_b2": _B_in["b2"],
    }

def reference(A_x, A_wq, A_wk, A_wv, A_wo, B_x, B_w1, B_b1, B_w2, B_b2):
    def _A_ref(x, wq, wk, wv, wo):
        B, S, D = x.shape
        H = 32
        Dh = D // H
        q = (lambda x, *d: x.permute(*d))((x @ wq).reshape(B, S, H, Dh), 0, 2, 1, 3)
        k = x @ wk
        v = x @ wv
        scores = torch.einsum("bhqd,bkd->bhqk", q, k) * (Dh ** -0.5)
        p = _softmax(scores, axis=-1)
        o = torch.einsum("bhqk,bkd->bhqd", p, v)
        return (lambda x, *d: x.permute(*d))(o, 0, 2, 1, 3).reshape(B, S, H * Dh) @ wo

    def _B_ref(x, w1, b1, w2, b2):
        y = _layernorm(x, axis=-1)
        h = _gelu(torch.einsum("bsd,df->bsf", y, w1) + b1)
        return torch.einsum("bsf,fd->bsd", h, w2) + b2

    x = A_x
    h = x + _A_ref(_layernorm(x, axis=-1), A_wq, A_wk, A_wv, A_wo)
    h2 = h + _B_ref(_layernorm(h, axis=-1), B_w1, B_b1, B_w2, B_b2)
    return h2
```

```asm
; @launch grid=(256,1,1) block=(256,1,1) lds=159808
.amdgcn_target "amdgcn-amd-amdhsa--gfx950"
.text
.globl sequential_preLN__grouped_kv_mqa__mixer_channel_mlp__prompt_kernel
.p2align 8
.type sequential_preLN__grouped_kv_mqa__mixer_channel_mlp__prompt_kernel,@function
sequential_preLN__grouped_kv_mqa__mixer_channel_mlp__prompt_kernel:
    s_cmp_ge_u32 s2, 256
    s_cbranch_scc1 M_END
    s_load_dwordx8 s[44:51], s[0:1], 0
    s_load_dwordx4 s[60:63], s[0:1], 88
    s_load_dwordx2 s[52:53], s[0:1], 32
    s_load_dwordx2 s[54:55], s[0:1], 48
    s_load_dwordx2 s[56:57], s[0:1], 64
    s_load_dwordx2 s[58:59], s[0:1], 80
    s_memrealtime s[64:65]
    v_and_b32 v1, 63, v0
    s_getpc_b64 s[66:67]
M_PC:
    s_lshr_b32 s3, s2, 3
    s_and_b32 s3, s3, 15
    s_lshl_b32 s3, s3, 13
    v_lshl_add_u32 v24, v1, 7, s3
    v_min_u32 v24, M_CODE_END-M_PC-4, v24
    global_load_dword v202, v24, s[66:67]
    v_and_b32 v1, 63, v0
    v_lshrrev_b32 v2, 6, v0
    s_nop 0
    v_readfirstlane_b32 s36, v2
    s_and_b32 s37, s2, 7
    s_lshl_b32 s37, s37, 2
    s_lshr_b32 s3, s2, 6
    s_add_u32 s37, s37, s3
    s_bfe_u32 s38, s2, 0x30003
    s_and_b32 s39, s2, 2
    s_lshl_b32 s39, s39, 1
    s_bfe_u32 s3, s2, 131075
    s_add_u32 s39, s39, s3
    s_and_b32 s41, s36, 1
    s_bfe_u32 s40, s2, 0x10002
    s_lshl_b32 s40, s40, 3
    s_lshr_b32 s3, s2, 5
    s_add_u32 s40, s40, s3
    s_lshl_b32 s40, s40, 2
    s_add_u32 s40, s40, s36
    v_lshlrev_b32 v2, 4, v1
    v_and_b32 v3, 31, v1
    v_lshlrev_b32 v4, 2, v3
    v_lshlrev_b32 v5, 3, v1
    s_lshl_b32 s42, s36, 10
    s_min_u32 s43, s36, 2
    s_lshl_b32 s43, s43, 10
    v_lshrrev_b32 v20, 3, v1
    s_lshl_b32 s3, s36, 3
    v_add_u32 v20, s3, v20
    v_and_b32 v21, 7, v1
    v_lshlrev_b32 v21, 4, v21
    v_mul_u32_u24 v22, 1152, v20
    v_add_u32 v22, v22, v21
    s_mul_i32 s66, s37, 73728
    s_bfe_u32 s3, s38, 0x10001
    s_mul_i32 s70, s3, 36864
    s_xor_b32 s67, s70, 36864
    s_add_u32 s70, s70, s66
    s_add_u32 s67, s67, s66
    v_add_u32 v24, 0, v0
    v_mul_u32_u24 v25, 21846, v24
    v_lshrrev_b32 v25, 16, v25
    v_mul_u32_u24 v26, 3, v25
    v_sub_u32 v26, v24, v26
    v_mul_u32_u24 v25, 36, v25
    v_lshl_add_u32 v238, v26, 4, v25
    v_add_u32 v24, 256, v0
    v_mul_u32_u24 v25, 21846, v24
    v_lshrrev_b32 v25, 16, v25
    v_mul_u32_u24 v26, 3, v25
    v_sub_u32 v26, v24, v26
    v_mul_u32_u24 v25, 36, v25
    v_lshl_add_u32 v239, v26, 4, v25
    v_add_u32 v24, 512, v0
    v_mul_u32_u24 v25, 21846, v24
    v_lshrrev_b32 v25, 16, v25
    v_mul_u32_u24 v26, 3, v25
    v_sub_u32 v26, v24, v26
    v_mul_u32_u24 v25, 36, v25
    v_lshl_add_u32 v240, v26, 4, v25
    v_add_u32 v24, 768, v0
    v_mul_u32_u24 v25, 21846, v24
    v_lshrrev_b32 v25, 16, v25
    v_mul_u32_u24 v26, 3, v25
    v_sub_u32 v26, v24, v26
    v_mul_u32_u24 v25, 36, v25
    v_lshl_add_u32 v241, v26, 4, v25
    v_add_u32 v24, 1024, v0
    v_mul_u32_u24 v25, 21846, v24
    v_lshrrev_b32 v25, 16, v25
    v_mul_u32_u24 v26, 3, v25
    v_sub_u32 v26, v24, v26
    v_mul_u32_u24 v25, 36, v25
    v_lshl_add_u32 v242, v26, 4, v25
    v_add_u32 v24, 1280, v0
    v_mul_u32_u24 v25, 21846, v24
    v_lshrrev_b32 v25, 16, v25
    v_mul_u32_u24 v26, 3, v25
    v_sub_u32 v26, v24, v26
    v_mul_u32_u24 v25, 36, v25
    v_lshl_add_u32 v243, v26, 4, v25
    s_lshr_b32 s3, s43, 4
    v_add_u32 v24, s3, v1
    v_add_u32 v24, 1536, v24
    v_mul_u32_u24 v25, 21846, v24
    v_lshrrev_b32 v25, 16, v25
    v_mul_u32_u24 v26, 3, v25
    v_sub_u32 v26, v24, v26
    v_mul_u32_u24 v25, 36, v25
    v_lshl_add_u32 v244, v26, 4, v25
    s_lshr_b32 s3, s2, 3
    s_mul_i32 s68, s3, 20736
    v_min_u32 v24, 161, v0
    v_lshlrev_b32 v24, 7, v24
    v_min_u32 v25, 17, v1
    v_lshlrev_b32 v25, 7, v25
    s_mul_i32 s69, s38, 9216
    s_add_u32 s69, s69, s66
    s_mul_i32 s3, s36, 2304
    s_add_u32 s69, s69, s3
    s_waitcnt lgkmcnt(0)
    s_mov_b32 s4, s44
    s_mov_b32 s5, s45
    s_mov_b32 s6, 0x00240000
    s_mov_b32 s7, 0x00020000
    s_mov_b32 s24, s46
    s_mov_b32 s25, s47
    s_mov_b32 s26, 0x000a2000
    s_mov_b32 s27, 0x00020000
    buffer_load_dword v202, v25, s[4:7], s69 offen
    s_cmp_ge_u32 s38, 4
    s_cselect_b32 s28, s50, s48
    s_cselect_b32 s29, s51, s49
    s_mov_b32 s30, 20736
    s_mov_b32 s31, 0x00020000
    s_mov_b32 s72, s67
    s_mov_b32 s65, s70
    s_mov_b32 s51, s70
    buffer_load_dword v202, v24, s[24:27], s68 offen
    s_and_b32 s3, s37, 3
    s_lshl_b32 s3, s3, 2
    s_and_b32 s68, s38, 3
    s_add_u32 s3, s3, s68
    s_lshl_b32 s3, s3, 2
    s_add_u32 s3, s3, s36
    s_mul_i32 s68, s3, 384
    v_min_u32 v24, 2, v1
    v_lshlrev_b32 v24, 7, v24
    buffer_load_dword v202, v24, s[28:31], s68 offen
    buffer_load_dwordx4 v[48:51], v22, s[4:7], s65 offen offset:0
    buffer_load_dwordx4 v[52:55], v22, s[4:7], s65 offen offset:128
    buffer_load_dwordx4 v[56:59], v22, s[4:7], s65 offen offset:256
    buffer_load_dwordx4 v[60:63], v22, s[4:7], s65 offen offset:384
    buffer_load_dwordx4 v[64:67], v22, s[4:7], s65 offen offset:512
    buffer_load_dwordx4 v[68:71], v22, s[4:7], s65 offen offset:640
    s_mov_b32 s20, s62
    s_mov_b32 s21, s63
    s_mov_b32 s22, 0x10000000
    s_mov_b32 s23, 0x00020000
    s_or_b32 s3, s2, s36
    s_cmp_lg_u32 s3, 0
    s_cbranch_scc1 M_NOTAG
    s_or_b32 s64, s64, 1
    v_mov_b32 v24, s64
    v_mov_b32 v25, 0
    s_mov_b64 exec, 1
    global_store_dword v25, v24, s[60:61] sc1
    s_mov_b64 exec, -1
M_NOTAG:
    s_mov_b32 s8, s52
    s_mov_b32 s9, s53
    s_mov_b32 s10, 0x000a2000
    s_mov_b32 s11, 0x00020000
    s_mov_b32 s12, s54
    s_mov_b32 s13, s55
    s_mov_b32 s14, 0x00510000
    s_mov_b32 s15, 0x00020000
    s_mov_b32 s16, s56
    s_mov_b32 s17, s57
    s_mov_b32 s18, 0x00510000
    s_mov_b32 s19, 0x00020000
    s_mov_b32 s32, s58
    s_mov_b32 s33, s59
    s_mov_b32 s34, 0x00240000
    s_mov_b32 s35, 0x00020000
    v_mul_u32_u24 v6, 1168, v20
    v_add_u32 v6, v6, v21
    v_add_u32 v6, 82944, v6
    v_mov_b32 v176, v2
    v_lshlrev_b32 v179, 2, v1
    v_add_u32 v179, 2048, v179
    v_mov_b32 v40, 11
    v_mov_b32 v41, 10
    v_and_b32 v42, 27, v3
    v_cmp_eq_u32 vcc, 18, v42
    s_nop 1
    v_cndmask_b32 v40, v40, v41, vcc
    v_subrev_u32 v41, 8, v3
    v_cmp_gt_u32 vcc, 18, v3
    s_nop 1
    v_cndmask_b32 v40, v40, v41, vcc
    v_add_u32 v41, 4, v3
    v_cmp_gt_u32 vcc, 16, v3
    s_nop 1
    v_cndmask_b32 v40, v40, v41, vcc
    v_subrev_u32 v41, 4, v3
    v_cmp_gt_u32 vcc, 12, v3
    s_nop 1
    v_cndmask_b32 v40, v40, v41, vcc
    v_add_u32 v41, 12, v3
    v_cmp_gt_u32 vcc, 4, v3
    s_nop 1
    v_cndmask_b32 v40, v40, v41, vcc
    v_lshrrev_b32 v41, 5, v1
    v_mul_u32_u24 v41, 320, v41
    v_lshl_add_u32 v40, v40, 4, v41
    v_add_u32 v182, 2304, v40
    v_mov_b32 v29, 0x00003f80
    v_mov_b32 v144, 0
    v_mov_b32 v145, 0
    v_mov_b32 v146, 0
    v_mov_b32 v147, 0
    v_mov_b32 v148, 0
    v_mov_b32 v149, 0
    v_mov_b32 v150, 0
    v_mov_b32 v151, 0
    v_mov_b32 v152, 0
    v_mov_b32 v153, 0
    v_mov_b32 v154, 0
    v_mov_b32 v155, 0
    v_mov_b32 v156, 0
    v_mov_b32 v157, 0
    v_mov_b32 v158, 0
    v_mov_b32 v159, 0
    v_mov_b32 v160, 0
    v_mov_b32 v161, 0
    v_mov_b32 v162, 0
    v_mov_b32 v163, 0
    v_mov_b32 v164, 0
    v_mov_b32 v165, 0
    v_mov_b32 v166, 0
    v_mov_b32 v167, 0
    v_mov_b32 v168, 0
    v_mov_b32 v169, 0
    v_mov_b32 v170, 0
    v_mov_b32 v171, 0
    v_mov_b32 v172, 0
    v_mov_b32 v173, 0
    v_mov_b32 v174, 0
    v_mov_b32 v175, 0
    s_lshl_b32 s3, s36, 6
    v_add_u32 v40, s3, v1
    v_mul_u32_u24 v41, 7282, v40
    v_lshrrev_b32 v41, 16, v41
    v_mul_u32_u24 v42, 9, v41
    v_sub_u32 v42, v40, v42
    v_lshlrev_b32 v42, 4, v42
    v_lshrrev_b32 v43, 4, v41
    v_bfe_u32 v44, v41, 2, 2
    v_bfe_u32 v45, v41, 1, 1
    v_and_b32 v46, 1, v41
    v_and_b32 v47, 3, v41
    v_lshl_add_u32 v47, v47, 2, v44
    v_lshl_add_u32 v47, v43, 4, v47
    v_mul_u32_u24 v47, 1152, v47
    v_add_u32 v30, v47, v42
    v_mul_u32_u24 v47, 18, v43
    v_lshl_add_u32 v47, v46, 3, v47
    v_lshl_add_u32 v47, v45, 2, v47
    v_add_u32 v47, v47, v44
    v_mul_u32_u24 v47, 1152, v47
    v_add_u32 v185, v47, v42
    v_lshl_add_u32 v46, v46, 2, v44
    v_lshrrev_b32 v47, 1, v46
    v_and_b32 v46, 1, v46
    v_lshl_add_u32 v47, v43, 3, v47
    v_lshl_add_u32 v47, v45, 2, v47
    v_mul_u32_u24 v47, 18, v47
    v_add3_u32 v46, v47, v46, 16
    v_mul_u32_u24 v46, 1152, v46
    v_add_u32 v186, v46, v42
    v_add_u32 v40, 256, v0
    v_mul_u32_u24 v41, 7282, v40
    v_lshrrev_b32 v41, 16, v41
    v_mul_u32_u24 v42, 9, v41
    v_sub_u32 v42, v40, v42
    v_lshlrev_b32 v42, 4, v42
    v_lshrrev_b32 v43, 4, v41
    v_bfe_u32 v44, v41, 2, 2
    v_bfe_u32 v45, v41, 1, 1
    v_and_b32 v46, 1, v41
    v_and_b32 v47, 3, v41
    v_lshl_add_u32 v47, v47, 2, v44
    v_lshl_add_u32 v47, v43, 4, v47
    v_mul_u32_u24 v47, 1152, v47
    v_add_u32 v31, v47, v42
    v_mul_u32_u24 v47, 18, v43
    v_lshl_add_u32 v47, v46, 3, v47
    v_lshl_add_u32 v47, v45, 2, v47
    v_add_u32 v47, v47, v44
    v_mul_u32_u24 v47, 1152, v47
    v_add_u32 v187, v47, v42
    v_lshl_add_u32 v46, v46, 2, v44
    v_lshrrev_b32 v47, 1, v46
    v_and_b32 v46, 1, v46
    v_lshl_add_u32 v47, v43, 3, v47
    v_lshl_add_u32 v47, v45, 2, v47
    v_mul_u32_u24 v47, 18, v47
    v_add3_u32 v46, v47, v46, 16
    v_mul_u32_u24 v46, 1152, v46
    v_add_u32 v188, v46, v42
    v_add_u32 v40, 512, v1
    v_mul_u32_u24 v41, 7282, v40
    v_lshrrev_b32 v41, 16, v41
    v_mul_u32_u24 v42, 9, v41
    v_sub_u32 v42, v40, v42
    v_lshlrev_b32 v42, 4, v42
    v_lshrrev_b32 v43, 4, v41
    v_bfe_u32 v44, v41, 2, 2
    v_bfe_u32 v45, v41, 1, 1
    v_and_b32 v46, 1, v41
    v_and_b32 v47, 3, v41
    v_lshl_add_u32 v47, v47, 2, v44
    v_lshl_add_u32 v47, v43, 4, v47
    v_mul_u32_u24 v47, 1152, v47
    v_add_u32 v32, v47, v42
    v_mul_u32_u24 v47, 18, v43
    v_lshl_add_u32 v47, v46, 3, v47
    v_lshl_add_u32 v47, v45, 2, v47
    v_add_u32 v47, v47, v44
    v_mul_u32_u24 v47, 1152, v47
    v_add_u32 v189, v47, v42
    v_lshl_add_u32 v46, v46, 2, v44
    v_lshrrev_b32 v47, 1, v46
    v_and_b32 v46, 1, v46
    v_lshl_add_u32 v47, v43, 3, v47
    v_lshl_add_u32 v47, v45, 2, v47
    v_mul_u32_u24 v47, 18, v47
    v_add3_u32 v46, v47, v46, 16
    v_mul_u32_u24 v46, 1152, v46
    v_add_u32 v190, v46, v42
    s_mul_i32 s64, s38, 144
    s_mul_i32 s65, s36, 82944
    s_add_u32 s65, s65, s64
    s_mul_i32 s66, s36, 9216
    s_and_b32 s67, s38, 1
    v_lshrrev_b32 v40, 5, v1
    v_mul_u32_u24 v41, 1152, v3
    v_lshl_add_u32 v203, v40, 3, v41
    v_and_b32 v40, 15, v1
    v_bfe_u32 v41, v1, 4, 1
    v_mul_u32_u24 v40, 1152, v40
    v_lshl_add_u32 v204, v41, 3, v40
    s_lshl_b32 s68, s37, 1
    s_lshr_b32 s3, s36, 1
    s_add_u32 s68, s68, s3
    s_mul_i32 s69, s68, 36864
    s_add_u32 s69, s69, s64
    s_and_b32 s3, s36, 1
    s_mul_i32 s70, s3, 18432
    s_add_u32 s70, s70, s69
    s_lshl_b32 s3, s3, 6
    s_add_u32 s69, s69, s3
    s_lshl_b32 s3, s67, 4
    s_add_u32 s69, s69, s3
    s_xor_b32 s3, s67, 1
    s_lshl_b32 s3, s3, 7
    s_add_u32 s70, s70, s3
    v_min_u32 v40, 19, v1
    v_mul_u32_u24 v41, 13108, v40
    v_lshrrev_b32 v41, 16, v41
    v_lshlrev_b32 v205, 7, v40
    v_lshl_add_u32 v205, v41, 9, v205
    s_lshr_b32 s3, s2, 3
    s_mul_i32 s71, s3, 165888
    s_and_b32 s3, s2, 2
    s_mul_i32 s3, s3, 2304
    s_add_u32 s71, s71, s3
    s_and_b32 s3, s2, 1
    s_lshl_b32 s3, s3, 9
    s_add_u32 s71, s71, s3
    s_lshr_b32 s3, s2, 3
    s_mul_i32 s73, s3, 82944
    s_and_b32 s3, s2, 2
    s_mul_i32 s3, s3, 1327104
    s_add_u32 s73, s73, s3
    s_and_b32 s3, s2, 1
    s_lshl_b32 s3, s3, 9
    s_add_u32 s73, s73, s3
    v_mov_b32 v128, 0
    v_mov_b32 v129, 0
    v_mov_b32 v130, 0
    v_mov_b32 v131, 0
    v_mov_b32 v132, 0
    v_mov_b32 v133, 0
    v_mov_b32 v134, 0
    v_mov_b32 v135, 0
    v_mov_b32 v136, 0
    v_mov_b32 v137, 0
    v_mov_b32 v138, 0
    v_mov_b32 v139, 0
    v_mov_b32 v140, 0
    v_mov_b32 v141, 0
    v_mov_b32 v142, 0
    v_mov_b32 v143, 0
    v_lshrrev_b32 v40, 5, v1
    v_mul_u32_u24 v7, 1168, v3
    v_lshl_add_u32 v7, v40, 4, v7
    s_bfe_u32 s3, s38, 0x10001
    s_mul_i32 s3, s3, 37376
    s_sub_u32 s44, 120320, s3
    s_add_u32 s3, s3, 82944
    v_add_u32 v28, s44, v7
    v_add_u32 v7, s3, v7
    v_bfe_u32 v41, v1, 2, 2
    v_lshlrev_b32 v42, 2, v41
    v_lshl_add_u32 v42, v40, 1, v42
    v_mul_u32_u24 v42, 144, v42
    v_bfe_u32 v43, v1, 4, 1
    v_and_b32 v44, 3, v1
    v_lshl_add_u32 v43, v43, 2, v44
    v_add_u32 v43, s41, v43
    v_lshrrev_b32 v43, s41, v43
    s_mul_i32 s44, s36, 36
    s_lshl_b32 s3, s41, 2
    s_sub_u32 s44, s44, s3
    s_add_u32 s44, s44, 0
    v_lshl_add_u32 v42, v43, 3, v42
    v_add_u32 v33, s44, v42
    v_add_u32 v34, 41472, v33
    v_lshrrev_b32 v35, 4, v1
    v_lshl_add_u32 v45, v35, 3, v41
    v_mul_u32_u24 v45, 48, v45
    v_lshl_add_u32 v45, v44, 3, v45
    s_lshl_b32 s3, s36, 5
    s_add_u32 s3, s3, 120320
    v_add_u32 v36, s3, v45
    s_and_b32 s45, s38, 3
    s_and_b32 s3, s45, 1
    s_lshl_b32 s3, s3, 4
    v_and_b32 v37, 15, v1
    v_add_u32 v38, s3, v37
    v_mul_u32_u24 v38, 1168, v38
    v_lshl_add_u32 v38, v35, 4, v38
    v_add_u32 v38, 82944, v38
    s_lshl_b32 s46, s2, 7
    s_add_u32 s46, s46, 393216
    s_mul_i32 s47, s36, 73728
    s_add_u32 s47, s47, s64
    s_mov_b32 s49, 0x3f803f80
    s_mov_b32 s50, 0xffff0000
    buffer_load_dwordx4 v[72:75], v22, s[4:7], s51 offen offset:768
    buffer_load_dwordx4 v[76:79], v22, s[4:7], s51 offen offset:896
    buffer_load_dwordx4 v[80:83], v22, s[4:7], s51 offen offset:1024
    buffer_load_dwordx4 v[84:87], v22, s[4:7], s72 offen offset:0
    buffer_load_dwordx4 v[88:91], v22, s[4:7], s72 offen offset:128
    buffer_load_dwordx4 v[92:95], v22, s[4:7], s72 offen offset:256
    buffer_load_dwordx4 v[96:99], v22, s[4:7], s72 offen offset:384
    buffer_load_dwordx4 v[100:103], v22, s[4:7], s72 offen offset:512
    buffer_load_dwordx4 v[104:107], v22, s[4:7], s72 offen offset:640
    buffer_load_dwordx4 v[108:111], v22, s[4:7], s72 offen offset:768
    buffer_load_dwordx4 v[112:115], v22, s[4:7], s72 offen offset:896
    buffer_load_dwordx4 v[116:119], v22, s[4:7], s72 offen offset:1024
    s_waitcnt vmcnt(9)
    v_mov_b32 v20, 0
    v_mov_b32 v21, 0
    v_mov_b32 v22, 0
    v_mov_b32 v23, 0
    v_mov_b32 v24, 0
    v_mov_b32 v25, 0
    v_mov_b32 v26, 0
    v_mov_b32 v27, 0
    v_dot2_f32_bf16 v20, v48, s49, v20
    v_dot2_f32_bf16 v24, v48, v48, v24
    v_dot2_f32_bf16 v21, v49, s49, v21
    v_dot2_f32_bf16 v25, v49, v49, v25
    v_dot2_f32_bf16 v22, v50, s49, v22
    v_dot2_f32_bf16 v26, v50, v50, v26
    v_dot2_f32_bf16 v23, v51, s49, v23
    v_dot2_f32_bf16 v27, v51, v51, v27
    v_dot2_f32_bf16 v20, v52, s49, v20
    v_dot2_f32_bf16 v24, v52, v52, v24
    s_add_u32 m0, s42, 120320
    s_nop 0
    buffer_load_dwordx4 v238, s[28:31], 0 offen lds
    v_dot2_f32_bf16 v21, v53, s49, v21
    v_dot2_f32_bf16 v25, v53, v53, v25
    v_dot2_f32_bf16 v22, v54, s49, v22
    v_dot2_f32_bf16 v26, v54, v54, v26
    v_dot2_f32_bf16 v23, v55, s49, v23
    v_dot2_f32_bf16 v27, v55, v55, v27
    v_dot2_f32_bf16 v20, v56, s49, v20
    v_dot2_f32_bf16 v24, v56, v56, v24
    v_dot2_f32_bf16 v21, v57, s49, v21
    v_dot2_f32_bf16 v25, v57, v57, v25
    s_add_u32 m0, s42, 124416
    s_nop 0
    buffer_load_dwordx4 v239, s[28:31], 0 offen lds
    v_dot2_f32_bf16 v22, v58, s49, v22
    v_dot2_f32_bf16 v26, v58, v58, v26
    v_dot2_f32_bf16 v23, v59, s49, v23
    v_dot2_f32_bf16 v27, v59, v59, v27
    v_dot2_f32_bf16 v20, v60, s49, v20
    v_dot2_f32_bf16 v24, v60, v60, v24
    v_dot2_f32_bf16 v21, v61, s49, v21
    v_dot2_f32_bf16 v25, v61, v61, v25
    v_dot2_f32_bf16 v22, v62, s49, v22
    v_dot2_f32_bf16 v26, v62, v62, v26
    s_add_u32 m0, s42, 128512
    s_nop 0
    buffer_load_dwordx4 v240, s[28:31], 0 offen lds
    v_dot2_f32_bf16 v23, v63, s49, v23
    v_dot2_f32_bf16 v27, v63, v63, v27
    v_dot2_f32_bf16 v20, v64, s49, v20
    v_dot2_f32_bf16 v24, v64, v64, v24
    v_dot2_f32_bf16 v21, v65, s49, v21
    v_dot2_f32_bf16 v25, v65, v65, v25
    v_dot2_f32_bf16 v22, v66, s49, v22
    v_dot2_f32_bf16 v26, v66, v66, v26
    v_dot2_f32_bf16 v23, v67, s49, v23
    v_dot2_f32_bf16 v27, v67, v67, v27
    s_add_u32 m0, s42, 132608
    s_nop 0
    buffer_load_dwordx4 v241, s[28:31], 0 offen lds
    v_dot2_f32_bf16 v20, v68, s49, v20
    v_dot2_f32_bf16 v24, v68, v68, v24
    v_dot2_f32_bf16 v21, v69, s49, v21
    v_dot2_f32_bf16 v25, v69, v69, v25
    v_dot2_f32_bf16 v22, v70, s49, v22
    v_dot2_f32_bf16 v26, v70, v70, v26
    v_dot2_f32_bf16 v23, v71, s49, v23
    v_dot2_f32_bf16 v27, v71, v71, v27
    v_dot2_f32_bf16 v20, v72, s49, v20
    v_dot2_f32_bf16 v24, v72, v72, v24
    s_add_u32 m0, s42, 136704
    s_nop 0
    buffer_load_dwordx4 v242, s[28:31], 0 offen lds
    v_dot2_f32_bf16 v21, v73, s49, v21
    v_dot2_f32_bf16 v25, v73, v73, v25
    v_dot2_f32_bf16 v22, v74, s49, v22
    v_dot2_f32_bf16 v26, v74, v74, v26
    v_dot2_f32_bf16 v23, v75, s49, v23
    v_dot2_f32_bf16 v27, v75, v75, v27
    v_dot2_f32_bf16 v20, v76, s49, v20
    v_dot2_f32_bf16 v24, v76, v76, v24
    v_dot2_f32_bf16 v21, v77, s49, v21
    v_dot2_f32_bf16 v25, v77, v77, v25
    s_add_u32 m0, s42, 140800
    s_nop 0
    buffer_load_dwordx4 v243, s[28:31], 0 offen lds
    v_dot2_f32_bf16 v22, v78, s49, v22
    v_dot2_f32_bf16 v26, v78, v78, v26
    v_dot2_f32_bf16 v23, v79, s49, v23
    v_dot2_f32_bf16 v27, v79, v79, v27
    v_dot2_f32_bf16 v20, v80, s49, v20
    v_dot2_f32_bf16 v24, v80, v80, v24
    v_dot2_f32_bf16 v21, v81, s49, v21
    v_dot2_f32_bf16 v25, v81, v81, v25
    v_dot2_f32_bf16 v22, v82, s49, v22
    v_dot2_f32_bf16 v26, v82, v82, v26
    s_add_u32 m0, s43, 144896
    s_nop 0
    buffer_load_dwordx4 v244, s[28:31], 0 offen lds
    v_dot2_f32_bf16 v23, v83, s49, v23
    v_dot2_f32_bf16 v27, v83, v83, v27
    v_add_f32 v20, v20, v21
    s_nop 0
    v_add_f32 v22, v22, v23
    v_add_f32 v24, v24, v25
    v_add_f32 v26, v26, v27
    v_add_f32 v40, v20, v22
    v_add_f32 v41, v24, v26
    s_waitcnt vmcnt(7)
    v_mov_b32 v20, 0
    v_mov_b32 v21, 0
    v_mov_b32 v22, 0
    v_mov_b32 v23, 0
    v_mov_b32 v24, 0
    v_mov_b32 v25, 0
    v_mov_b32 v26, 0
    v_mov_b32 v27, 0
    v_dot2_f32_bf16 v20, v84, s49, v20
    v_dot2_f32_bf16 v24, v84, v84, v24
    v_dot2_f32_bf16 v21, v85, s49, v21
    v_dot2_f32_bf16 v25, v85, v85, v25
    v_dot2_f32_bf16 v22, v86, s49, v22
    v_dot2_f32_bf16 v26, v86, v86, v26
    v_dot2_f32_bf16 v23, v87, s49, v23
    v_dot2_f32_bf16 v27, v87, v87, v27
    v_dot2_f32_bf16 v20, v88, s49, v20
    v_dot2_f32_bf16 v24, v88, v88, v24
    v_dot2_f32_bf16 v21, v89, s49, v21
    v_dot2_f32_bf16 v25, v89, v89, v25
    s_add_u32 m0, s42, 0
    s_add_u32 s48, s64, 0
    buffer_load_dwordx4 v30, s[24:27], s48 offen lds
    v_dot2_f32_bf16 v22, v90, s49, v22
    v_dot2_f32_bf16 v26, v90, v90, v26
    v_dot2_f32_bf16 v23, v91, s49, v23
    v_dot2_f32_bf16 v27, v91, v91, v27
    v_dot2_f32_bf16 v20, v92, s49, v20
    v_dot2_f32_bf16 v24, v92, v92, v24
    v_dot2_f32_bf16 v21, v93, s49, v21
    v_dot2_f32_bf16 v25, v93, v93, v25
    v_dot2_f32_bf16 v22, v94, s49, v22
    v_dot2_f32_bf16 v26, v94, v94, v26
    v_dot2_f32_bf16 v23, v95, s49, v23
    v_dot2_f32_bf16 v27, v95, v95, v27
    s_add_u32 m0, s42, 4096
    s_add_u32 s48, s64, 0
    buffer_load_dwordx4 v31, s[24:27], s48 offen lds
    v_dot2_f32_bf16 v20, v96, s49, v20
    v_dot2_f32_bf16 v24, v96, v96, v24
    v_dot2_f32_bf16 v21, v97, s49, v21
    v_dot2_f32_bf16 v25, v97, v97, v25
    v_dot2_f32_bf16 v22, v98, s49, v22
    v_dot2_f32_bf16 v26, v98, v98, v26
    v_dot2_f32_bf16 v23, v99, s49, v23
    v_dot2_f32_bf16 v27, v99, v99, v27
    v_dot2_f32_bf16 v20, v100, s49, v20
    v_dot2_f32_bf16 v24, v100, v100, v24
    v_dot2_f32_bf16 v21, v101, s49, v21
    v_dot2_f32_bf16 v25, v101, v101, v25
    s_add_u32 m0, s66, 8192
    s_add_u32 s48, s47, 0
    buffer_load_dwordx4 v32, s[24:27], s48 offen lds
    v_dot2_f32_bf16 v22, v102, s49, v22
    v_dot2_f32_bf16 v26, v102, v102, v26
    v_dot2_f32_bf16 v23, v103, s49, v23
    v_dot2_f32_bf16 v27, v103, v103, v27
    v_dot2_f32_bf16 v20, v104, s49, v20
    v_dot2_f32_bf16 v24, v104, v104, v24
    v_dot2_f32_bf16 v21, v105, s49, v21
    v_dot2_f32_bf16 v25, v105, v105, v25
    v_dot2_f32_bf16 v22, v106, s49, v22
    v_dot2_f32_bf16 v26, v106, v106, v26
    v_dot2_f32_bf16 v23, v107, s49, v23
    v_dot2_f32_bf16 v27, v107, v107, v27
    s_add_u32 m0, s42, 9216
    s_add_u32 s48, s64, 73728
    buffer_load_dwordx4 v30, s[24:27], s48 offen lds
    v_dot2_f32_bf16 v20, v108, s49, v20
    v_dot2_f32_bf16 v24, v108, v108, v24
    v_dot2_f32_bf16 v21, v109, s49, v21
    v_dot2_f32_bf16 v25, v109, v109, v25
    v_dot2_f32_bf16 v22, v110, s49, v22
    v_dot2_f32_bf16 v26, v110, v110, v26
    v_dot2_f32_bf16 v23, v111, s49, v23
    v_dot2_f32_bf16 v27, v111, v111, v27
    v_dot2_f32_bf16 v20, v112, s49, v20
    v_dot2_f32_bf16 v24, v112, v112, v24
    v_dot2_f32_bf16 v21, v113, s49, v21
    v_dot2_f32_bf16 v25, v113, v113, v25
    s_add_u32 m0, s42, 13312
    s_add_u32 s48, s64, 73728
    buffer_load_dwordx4 v31, s[24:27], s48 offen lds
    v_dot2_f32_bf16 v22, v114, s49, v22
    v_dot2_f32_bf16 v26, v114, v114, v26
    v_dot2_f32_bf16 v23, v115, s49, v23
    v_dot2_f32_bf16 v27, v115, v115, v27
    v_dot2_f32_bf16 v20, v116, s49, v20
    v_dot2_f32_bf16 v24, v116, v116, v24
    v_dot2_f32_bf16 v21, v117, s49, v21
    v_dot2_f32_bf16 v25, v117, v117, v25
    v_dot2_f32_bf16 v22, v118, s49, v22
    v_dot2_f32_bf16 v26, v118, v118, v26
    v_dot2_f32_bf16 v23, v119, s49, v23
    v_dot2_f32_bf16 v27, v119, v119, v27
    s_add_u32 m0, s42, 18432
    s_add_u32 s48, s64, 147456
    buffer_load_dwordx4 v30, s[24:27], s48 offen lds
    v_add_f32 v20, v20, v21
    v_add_f32 v22, v22, v23
    v_add_f32 v24, v24, v25
    v_add_f32 v26, v26, v27
    v_add_f32 v42, v20, v22
    v_add_f32 v43, v24, v26
    v_mov_b32 v39, 0
    global_load_dword v29, v39, s[60:61] sc1
    v_add_f32_dpp v40, v40, v40 quad_perm:[1,0,3,2] row_mask:0xf bank_mask:0xf
    v_add_f32_dpp v41, v41, v41 quad_perm:[1,0,3,2] row_mask:0xf bank_mask:0xf
    v_add_f32_dpp v42, v42, v42 quad_perm:[1,0,3,2] row_mask:0xf bank_mask:0xf
    v_add_f32_dpp v43, v43, v43 quad_perm:[1,0,3,2] row_mask:0xf bank_mask:0xf
    v_add_f32_dpp v40, v40, v40 quad_perm:[2,3,0,1] row_mask:0xf bank_mask:0xf
    v_add_f32_dpp v41, v41, v41 quad_perm:[2,3,0,1] row_mask:0xf bank_mask:0xf
    v_add_f32_dpp v42, v42, v42 quad_perm:[2,3,0,1] row_mask:0xf bank_mask:0xf
    v_add_f32_dpp v43, v43, v43 quad_perm:[2,3,0,1] row_mask:0xf bank_mask:0xf
    v_add_f32_dpp v40, v40, v40 row_half_mirror row_mask:0xf bank_mask:0xf
    v_add_f32_dpp v41, v41, v41 row_half_mirror row_mask:0xf bank_mask:0xf
    v_add_f32_dpp v42, v42, v42 row_half_mirror row_mask:0xf bank_mask:0xf
    v_add_f32_dpp v43, v43, v43 row_half_mirror row_mask:0xf bank_mask:0xf
    v_mul_f32 v40, 0x3ae38e39, v40
    v_mul_f32 v41, 0x3ae38e39, v41
    v_mul_f32 v42, 0x3ae38e39, v42
    v_mul_f32 v43, 0x3ae38e39, v43
    v_fma_f32 v41, -v40, v40, v41
    v_max_f32 v41, 0, v41
    v_add_f32 v41, 0x3727c5ac, v41
    v_rsq_f32 v41, v41
    v_fma_f32 v43, -v42, v42, v43
    v_max_f32 v43, 0, v43
    v_add_f32 v43, 0x3727c5ac, v43
    v_rsq_f32 v43, v43
    v_mul_f32 v40, v40, v41
    v_sub_f32 v40, 0, v40
    v_mov_b32 v44, v41
    v_mul_f32 v42, v42, v43
    v_sub_f32 v42, 0, v42
    v_mov_b32 v46, v43
    v_lshlrev_b32 v20, 16, v48
    v_and_b32 v21, s50, v48
    v_lshlrev_b32 v22, 16, v49
    v_and_b32 v23, s50, v49
    v_lshlrev_b32 v24, 16, v50
    v_and_b32 v25, s50, v50
    v_lshlrev_b32 v26, 16, v51
    v_and_b32 v27, s50, v51
    v_pk_fma_f32 v[20:21], v[20:21], v[44:45], v[40:41] op_sel_hi:[1,0,0]
    v_pk_fma_f32 v[22:23], v[22:23], v[44:45], v[40:41] op_sel_hi:[1,0,0]
    v_pk_fma_f32 v[24:25], v[24:25], v[44:45], v[40:41] op_sel_hi:[1,0,0]
    v_pk_fma_f32 v[26:27], v[26:27], v[44:45], v[40:41] op_sel_hi:[1,0,0]
    v_cvt_pk_bf16_f32 v48, v20, v21
    v_cvt_pk_bf16_f32 v49, v22, v23
    v_cvt_pk_bf16_f32 v50, v24, v25
    v_cvt_pk_bf16_f32 v51, v26, v27
    ds_write_b128 v6, v[48:51] offset:0
    s_add_u32 m0, s42, 22528
    s_add_u32 s48, s64, 147456
    buffer_load_dwordx4 v31, s[24:27], s48 offen lds
    v_lshlrev_b32 v20, 16, v52
    v_and_b32 v21, s50, v52
    v_lshlrev_b32 v22, 16, v53
    v_and_b32 v23, s50, v53
    v_lshlrev_b32 v24, 16, v54
    v_and_b32 v25, s50, v54
    v_lshlrev_b32 v26, 16, v55
    v_and_b32 v27, s50, v55
    v_pk_fma_f32 v[20:21], v[20:21], v[44:45], v[40:41] op_sel_hi:[1,0,0]
    v_pk_fma_f32 v[22:23], v[22:23], v[44:45], v[40:41] op_sel_hi:[1,0,0]
    v_pk_fma_f32 v[24:25], v[24:25], v[44:45], v[40:41] op_sel_hi:[1,0,0]
    v_pk_fma_f32 v[26:27], v[26:27], v[44:45], v[40:41] op_sel_hi:[1,0,0]
    v_cvt_pk_bf16_f32 v52, v20, v21
    v_cvt_pk_bf16_f32 v53, v22, v23
    v_cvt_pk_bf16_f32 v54, v24, v25
    v_cvt_pk_bf16_f32 v55, v26, v27
    ds_write_b128 v6, v[52:55] offset:128
    s_add_u32 m0, s42, 27648
    s_add_u32 s48, s64, 221184
    buffer_load_dwordx4 v30, s[24:27], s48 offen lds
    v_lshlrev_b32 v20, 16, v56
    v_and_b32 v21, s50, v56
    v_lshlrev_b32 v22, 16, v57
    v_and_b32 v23, s50, v57
    v_lshlrev_b32 v24, 16, v58
    v_and_b32 v25, s50, v58
    v_lshlrev_b32 v26, 16, v59
    v_and_b32 v27, s50, v59
    v_pk_fma_f32 v[20:21], v[20:21], v[44:45], v[40:41] op_sel_hi:[1,0,0]
    v_pk_fma_f32 v[22:23], v[22:23], v[44:45], v[40:41] op_sel_hi:[1,0,0]
    v_pk_fma_f32 v[24:25], v[24:25], v[44:45], v[40:41] op_sel_hi:[1,0,0]
    v_pk_fma_f32 v[26:27], v[26:27], v[44:45], v[40:41] op_sel_hi:[1,0,0]
    v_cvt_pk_bf16_f32 v56, v20, v21
    v_cvt_pk_bf16_f32 v57, v22, v23
    v_cvt_pk_bf16_f32 v58, v24, v25
    v_cvt_pk_bf16_f32 v59, v26, v27
    ds_write_b128 v6, v[56:59] offset:256
    s_add_u32 m0, s42, 31744
    s_add_u32 s48, s64, 221184
    buffer_load_dwordx4 v31, s[24:27], s48 offen lds
    v_lshlrev_b32 v20, 16, v60
    v_and_b32 v21, s50, v60
    v_lshlrev_b32 v22, 16, v61
    v_and_b32 v23, s50, v61
    v_lshlrev_b32 v24, 16, v62
    v_and_b32 v25, s50, v62
    v_lshlrev_b32 v26, 16, v63
    v_and_b32 v27, s50, v63
    v_pk_fma_f32 v[20:21], v[20:21], v[44:45], v[40:41] op_sel_hi:[1,0,0]
    v_pk_fma_f32 v[22:23], v[22:23], v[44:45], v[40:41] op_sel_hi:[1,0,0]
    v_pk_fma_f32 v[24:25], v[24:25], v[44:45], v[40:41] op_sel_hi:[1,0,0]
    v_pk_fma_f32 v[26:27], v[26:27], v[44:45], v[40:41] op_sel_hi:[1,0,0]
    v_cvt_pk_bf16_f32 v60, v20, v21
    v_cvt_pk_bf16_f32 v61, v22, v23
    v_cvt_pk_bf16_f32 v62, v24, v25
    v_cvt_pk_bf16_f32 v63, v26, v27
    ds_write_b128 v6, v[60:63] offset:384
    s_add_u32 m0, s42, 36864
    s_add_u32 s48, s64, 294912
    buffer_load_dwordx4 v30, s[24:27], s48 offen lds
    v_lshlrev_b32 v20, 16, v64
    v_and_b32 v21, s50, v64
    v_lshlrev_b32 v22, 16, v65
    v_and_b32 v23, s50, v65
    v_lshlrev_b32 v24, 16, v66
    v_and_b32 v25, s50, v66
    v_lshlrev_b32 v26, 16, v67
    v_and_b32 v27, s50, v67
    v_pk_fma_f32 v[20:21], v[20:21], v[44:45], v[40:41] op_sel_hi:[1,0,0]
    v_pk_fma_f32 v[22:23], v[22:23], v[44:45], v[40:41] op_sel_hi:[1,0,0]
    v_pk_fma_f32 v[24:25], v[24:25], v[44:45], v[40:41] op_sel_hi:[1,0,0]
    v_pk_fma_f32 v[26:27], v[26:27], v[44:45], v[40:41] op_sel_hi:[1,0,0]
    v_cvt_pk_bf16_f32 v64, v20, v21
    v_cvt_pk_bf16_f32 v65, v22, v23
    v_cvt_pk_bf16_f32 v66, v24, v25
    v_cvt_pk_bf16_f32 v67, v26, v27
    ds_write_b128 v6, v[64:67] offset:512
    s_add_u32 m0, s42, 40960
    s_add_u32 s48, s64, 294912
    buffer_load_dwordx4 v31, s[24:27], s48 offen lds
    v_lshlrev_b32 v20, 16, v68
    v_and_b32 v21, s50, v68
    v_lshlrev_b32 v22, 16, v69
    v_and_b32 v23, s50, v69
    v_lshlrev_b32 v24, 16, v70
    v_and_b32 v25, s50, v70
    v_lshlrev_b32 v26, 16, v71
    v_and_b32 v27, s50, v71
    v_pk_fma_f32 v[20:21], v[20:21], v[44:45], v[40:41] op_sel_hi:[1,0,0]
    v_pk_fma_f32 v[22:23], v[22:23], v[44:45], v[40:41] op_sel_hi:[1,0,0]
    v_pk_fma_f32 v[24:25], v[24:25], v[44:45], v[40:41] op_sel_hi:[1,0,0]
    v_pk_fma_f32 v[26:27], v[26:27], v[44:45], v[40:41] op_sel_hi:[1,0,0]
    v_cvt_pk_bf16_f32 v68, v20, v21
    v_cvt_pk_bf16_f32 v69, v22, v23
    v_cvt_pk_bf16_f32 v70, v24, v25
    v_cvt_pk_bf16_f32 v71, v26, v27
    ds_write_b128 v6, v[68:71] offset:640
    s_add_u32 m0, s66, 45056
    s_add_u32 s48, s47, 294912
    buffer_load_dwordx4 v32, s[24:27], s48 offen lds
    v_lshlrev_b32 v20, 16, v72
    v_and_b32 v21, s50, v72
    v_lshlrev_b32 v22, 16, v73
    v_and_b32 v23, s50, v73
    v_lshlrev_b32 v24, 16, v74
    v_and_b32 v25, s50, v74
    v_lshlrev_b32 v26, 16, v75
    v_and_b32 v27, s50, v75
    v_pk_fma_f32 v[20:21], v[20:21], v[44:45], v[40:41] op_sel_hi:[1,0,0]
    v_pk_fma_f32 v[22:23], v[22:23], v[44:45], v[40:41] op_sel_hi:[1,0,0]
    v_pk_fma_f32 v[24:25], v[24:25], v[44:45], v[40:41] op_sel_hi:[1,0,0]
    v_pk_fma_f32 v[26:27], v[26:27], v[44:45], v[40:41] op_sel_hi:[1,0,0]
    v_cvt_pk_bf16_f32 v72, v20, v21
    v_cvt_pk_bf16_f32 v73, v22, v23
    v_cvt_pk_bf16_f32 v74, v24, v25
    v_cvt_pk_bf16_f32 v75, v26, v27
    ds_write_b128 v6, v[72:75] offset:768
    s_add_u32 m0, s42, 46080
    s_add_u32 s48, s64, 368640
    buffer_load_dwordx4 v30, s[24:27], s48 offen lds
    v_lshlrev_b32 v20, 16, v76
    v_and_b32 v21, s50, v76
    v_lshlrev_b32 v22, 16, v77
    v_and_b32 v23, s50, v77
    v_lshlrev_b32 v24, 16, v78
    v_and_b32 v25, s50, v78
    v_lshlrev_b32 v26, 16, v79
    v_and_b32 v27, s50, v79
    v_pk_fma_f32 v[20:21], v[20:21], v[44:45], v[40:41] op_sel_hi:[1,0,0]
    v_pk_fma_f32 v[22:23], v[22:23], v[44:45], v[40:41] op_sel_hi:[1,0,0]
    v_pk_fma_f32 v[24:25], v[24:25], v[44:45], v[40:41] op_sel_hi:[1,0,0]
    v_pk_fma_f32 v[26:27], v[26:27], v[44:45], v[40:41] op_sel_hi:[1,0,0]
    v_cvt_pk_bf16_f32 v76, v20, v21
    v_cvt_pk_bf16_f32 v77, v22, v23
    v_cvt_pk_bf16_f32 v78, v24, v25
    v_cvt_pk_bf16_f32 v79, v26, v27
    ds_write_b128 v6, v[76:79] offset:896
    s_add_u32 m0, s42, 50176
    s_add_u32 s48, s64, 368640
    buffer_load_dwordx4 v31, s[24:27], s48 offen lds
    v_lshlrev_b32 v20, 16, v80
    v_and_b32 v21, s50, v80
    v_lshlrev_b32 v22, 16, v81
    v_and_b32 v23, s50, v81
    v_lshlrev_b32 v24, 16, v82
    v_and_b32 v25, s50, v82
    v_lshlrev_b32 v26, 16, v83
    v_and_b32 v27, s50, v83
    v_pk_fma_f32 v[20:21], v[20:21], v[44:45], v[40:41] op_sel_hi:[1,0,0]
    v_pk_fma_f32 v[22:23], v[22:23], v[44:45], v[40:41] op_sel_hi:[1,0,0]
    v_pk_fma_f32 v[24:25], v[24:25], v[44:45], v[40:41] op_sel_hi:[1,0,0]
    v_pk_fma_f32 v[26:27], v[26:27], v[44:45], v[40:41] op_sel_hi:[1,0,0]
    v_cvt_pk_bf16_f32 v80, v20, v21
    v_cvt_pk_bf16_f32 v81, v22, v23
    v_cvt_pk_bf16_f32 v82, v24, v25
    v_cvt_pk_bf16_f32 v83, v26, v27
    ds_write_b128 v6, v[80:83] offset:1024
    s_add_u32 m0, s42, 55296
    s_add_u32 s48, s64, 442368
    buffer_load_dwordx4 v30, s[24:27], s48 offen lds
    s_mov_b32 s3, 0x8000
    s_waitcnt vmcnt(9)
M_TG:
    v_readfirstlane_b32 s2, v29
    s_nop 0
    s_cmp_lg_u32 s2, 0
    s_cbranch_scc1 M_TD
    global_load_dword v29, v39, s[60:61] sc1
    s_waitcnt vmcnt(0)
    s_sub_u32 s3, s3, 1
    s_cmp_lg_u32 s3, 0
    s_cbranch_scc1 M_TG
M_TD:
    s_waitcnt lgkmcnt(0)
    s_barrier
    s_cmp_ge_u32 s36, 2
    s_cbranch_scc1 M_A2
    ds_read_b128 v[48:51], v38 offset:0
    ds_read_b64_tr_b16 a[0:1], v36 offset:0
    ds_read_b64_tr_b16 a[2:3], v36 offset:192
    ds_read_b128 v[52:55], v38 offset:64
    ds_read_b64_tr_b16 a[4:5], v36 offset:1536
    ds_read_b64_tr_b16 a[6:7], v36 offset:1728
    ds_read_b128 v[56:59], v38 offset:128
    ds_read_b64_tr_b16 a[8:9], v36 offset:3072
    ds_read_b64_tr_b16 a[10:11], v36 offset:3264
    ds_read_b128 v[60:63], v38 offset:192
    ds_read_b64_tr_b16 a[12:13], v36 offset:4608
    ds_read_b64_tr_b16 a[14:15], v36 offset:4800
    s_mul_i32 s51, s37, 4864
    s_cmp_ge_u32 s38, 4
    s_cbranch_scc1 M_AV
    s_waitcnt lgkmcnt(9)
    v_mfma_f32_16x16x32_bf16 v[64:67], a[0:3], v[48:51], 0
    ds_read_b128 v[48:51], v38 offset:256
    ds_read_b64_tr_b16 a[0:1], v36 offset:6144
    ds_read_b64_tr_b16 a[2:3], v36 offset:6336
    s_waitcnt lgkmcnt(9)
    v_mfma_f32_16x16x32_bf16 v[64:67], a[4:7], v[52:55], v[64:67]
    ds_read_b128 v[52:55], v38 offset:320
    ds_read_b64_tr_b16 a[4:5], v36 offset:7680
    ds_read_b64_tr_b16 a[6:7], v36 offset:7872
    s_waitcnt lgkmcnt(9)
    v_mfma_f32_16x16x32_bf16 v[64:67], a[8:11], v[56:59], v[64:67]
    ds_read_b128 v[56:59], v38 offset:384
    ds_read_b64_tr_b16 a[8:9], v36 offset:9216
    ds_read_b64_tr_b16 a[10:11], v36 offset:9408
    s_waitcnt lgkmcnt(9)
    v_mfma_f32_16x16x32_bf16 v[64:67], a[12:15], v[60:63], v[64:67]
    ds_read_b128 v[60:63], v38 offset:448
    ds_read_b64_tr_b16 a[12:13], v36 offset:10752
    ds_read_b64_tr_b16 a[14:15], v36 offset:10944
    s_waitcnt lgkmcnt(9)
    v_mfma_f32_16x16x32_bf16 v[64:67], a[0:3], v[48:51], v[64:67]
    ds_read_b128 v[48:51], v38 offset:512
    ds_read_b64_tr_b16 a[0:1], v36 offset:12288
    ds_read_b64_tr_b16 a[2:3], v36 offset:12480
    s_waitcnt lgkmcnt(9)
    v_mfma_f32_16x16x32_bf16 v[64:67], a[4:7], v[52:55], v[64:67]
    ds_read_b128 v[52:55], v38 offset:576
    ds_read_b64_tr_b16 a[4:5], v36 offset:13824
    ds_read_b64_tr_b16 a[6:7], v36 offset:14016
    s_waitcnt lgkmcnt(9)
    v_mfma_f32_16x16x32_bf16 v[64:67], a[8:11], v[56:59], v[64:67]
    ds_read_b128 v[56:59], v38 offset:640
    ds_read_b64_tr_b16 a[8:9], v36 offset:15360
    ds_read_b64_tr_b16 a[10:11], v36 offset:15552
    s_waitcnt lgkmcnt(9)
    v_mfma_f32_16x16x32_bf16 v[64:67], a[12:15], v[60:63], v[64:67]
    ds_read_b128 v[60:63], v38 offset:704
    ds_read_b64_tr_b16 a[12:13], v36 offset:16896
    ds_read_b64_tr_b16 a[14:15], v36 offset:17088
    s_waitcnt lgkmcnt(9)
    v_mfma_f32_16x16x32_bf16 v[64:67], a[0:3], v[48:51], v[64:67]
    ds_read_b128 v[48:51], v38 offset:768
    ds_read_b64_tr_b16 a[0:1], v36 offset:18432
    ds_read_b64_tr_b16 a[2:3], v36 offset:18624
    s_waitcnt lgkmcnt(9)
    v_mfma_f32_16x16x32_bf16 v[64:67], a[4:7], v[52:55], v[64:67]
    ds_read_b128 v[52:55], v38 offset:832
    ds_read_b64_tr_b16 a[4:5], v36 offset:19968
    ds_read_b64_tr_b16 a[6:7], v36 offset:20160
    s_waitcnt lgkmcnt(9)
    v_mfma_f32_16x16x32_bf16 v[64:67], a[8:11], v[56:59], v[64:67]
    ds_read_b128 v[56:59], v38 offset:896
    ds_read_b64_tr_b16 a[8:9], v36 offset:21504
    ds_read_b64_tr_b16 a[10:11], v36 offset:21696
    s_waitcnt lgkmcnt(9)
    v_mfma_f32_16x16x32_bf16 v[64:67], a[12:15], v[60:63], v[64:67]
    ds_read_b128 v[60:63], v38 offset:960
    ds_read_b64_tr_b16 a[12:13], v36 offset:23040
    ds_read_b64_tr_b16 a[14:15], v36 offset:23232
    s_waitcnt lgkmcnt(9)
    v_mfma_f32_16x16x32_bf16 v[64:67], a[0:3], v[48:51], v[64:67]
    ds_read_b128 v[48:51], v38 offset:1024
    ds_read_b64_tr_b16 a[0:1], v36 offset:24576
    ds_read_b64_tr_b16 a[2:3], v36 offset:24768
    s_waitcnt lgkmcnt(9)
    v_mfma_f32_16x16x32_bf16 v[64:67], a[4:7], v[52:55], v[64:67]
    ds_read_b128 v[52:55], v38 offset:1088
    ds_read_b64_tr_b16 a[4:5], v36 offset:26112
    ds_read_b64_tr_b16 a[6:7], v36 offset:26304
    s_waitcnt lgkmcnt(9)
    v_mfma_f32_16x16x32_bf16 v[64:67], a[8:11], v[56:59], v[64:67]
    s_waitcnt lgkmcnt(6)
    v_mfma_f32_16x16x32_bf16 v[64:67], a[12:15], v[60:63], v[64:67]
    s_waitcnt lgkmcnt(3)
    v_mfma_f32_16x16x32_bf16 v[64:67], a[0:3], v[48:51], v[64:67]
    s_waitcnt lgkmcnt(0)
    v_mfma_f32_16x16x32_bf16 v[64:67], a[4:7], v[52:55], v[64:67]
    s_lshr_b32 s52, s45, 1
    s_and_b32 s3, s45, 1
    s_lshl_b32 s3, s3, 4
    v_add_u32 v68, s3, v37
    v_and_b32 v69, 1, v35
    v_lshl_add_u32 v69, v69, 5, v68
    v_lshlrev_b32 v69, 4, v69
    v_lshrrev_b32 v70, 1, v35
    v_lshl_add_u32 v69, v70, 3, v69
    v_mul_f32 v64, 0x3eae1a93, v64
    v_mul_f32 v65, 0x3eae1a93, v65
    v_mul_f32 v66, 0x3eae1a93, v66
    v_mul_f32 v67, 0x3eae1a93, v67
    v_cvt_pk_bf16_f32 v72, v64, v65
    v_cvt_pk_bf16_f32 v73, v66, v67
    v_mov_b32 v75, 0
    s_cmp_eq_u32 s36, 1
    s_cbranch_scc1 M_AK1
    s_lshl_b32 s52, s52, 10
    s_add_u32 s52, s52, s51
    buffer_store_dwordx2 v[72:73], v69, s[20:23], s52 offen sc1
    v_dot2_f32_bf16 v75, v72, v72, v75
    v_dot2_f32_bf16 v75, v73, v73, v75
    s_nop 2
    v_mov_b32 v76, v75
    s_nop 1
    v_permlane32_swap_b32 v75, v76
    v_add_f32 v75, v75, v76
    v_mov_b32 v76, v75
    s_nop 1
    v_permlane16_swap_b32 v75, v76
    v_add_f32 v75, v75, v76
    s_branch M_AK2
M_AK1:
    s_lshl_b32 s52, s52, 7
    s_add_u32 s52, s52, s51
    s_add_u32 s52, s52, 2048
    v_lshlrev_b32 v68, 2, v68
    s_mov_b64 exec, 0xffff
    buffer_store_dword v72, v68, s[20:23], s52 offen sc1
    s_mov_b64 exec, -1
    v_dot2_f32_bf16 v75, v72, v72, v75
    s_nop 2
M_AK2:
    s_nop 1
    v_max_f32_dpp v75, v75, v75 quad_perm:[1,0,3,2] row_mask:0xf bank_mask:0xf
    s_nop 1
    v_max_f32_dpp v75, v75, v75 quad_perm:[2,3,0,1] row_mask:0xf bank_mask:0xf
    s_nop 1
    v_max_f32_dpp v75, v75, v75 row_half_mirror row_mask:0xf bank_mask:0xf
    s_nop 1
    v_max_f32_dpp v75, v75, v75 row_mirror row_mask:0xf bank_mask:0xf
    s_branch M_AF
M_AV:
    s_waitcnt lgkmcnt(9)
    v_mfma_f32_16x16x32_bf16 v[64:67], v[48:51], a[0:3], 0
    ds_read_b128 v[48:51], v38 offset:256
    ds_read_b64_tr_b16 a[0:1], v36 offset:6144
    ds_read_b64_tr_b16 a[2:3], v36 offset:6336
    s_waitcnt lgkmcnt(9)
    v_mfma_f32_16x16x32_bf16 v[64:67], v[52:55], a[4:7], v[64:67]
    ds_read_b128 v[52:55], v38 offset:320
    ds_read_b64_tr_b16 a[4:5], v36 offset:7680
    ds_read_b64_tr_b16 a[6:7], v36 offset:7872
    s_waitcnt lgkmcnt(9)
    v_mfma_f32_16x16x32_bf16 v[64:67], v[56:59], a[8:11], v[64:67]
    ds_read_b128 v[56:59], v38 offset:384
    ds_read_b64_tr_b16 a[8:9], v36 offset:9216
    ds_read_b64_tr_b16 a[10:11], v36 offset:9408
    s_waitcnt lgkmcnt(9)
    v_mfma_f32_16x16x32_bf16 v[64:67], v[60:63], a[12:15], v[64:67]
    ds_read_b128 v[60:63], v38 offset:448
    ds_read_b64_tr_b16 a[12:13], v36 offset:10752
    ds_read_b64_tr_b16 a[14:15], v36 offset:10944
    s_waitcnt lgkmcnt(9)
    v_mfma_f32_16x16x32_bf16 v[64:67], v[48:51], a[0:3], v[64:67]
    ds_read_b128 v[48:51], v38 offset:512
    ds_read_b64_tr_b16 a[0:1], v36 offset:12288
    ds_read_b64_tr_b16 a[2:3], v36 offset:12480
    s_waitcnt lgkmcnt(9)
    v_mfma_f32_16x16x32_bf16 v[64:67], v[52:55], a[4:7], v[64:67]
    ds_read_b128 v[52:55], v38 offset:576
    ds_read_b64_tr_b16 a[4:5], v36 offset:13824
    ds_read_b64_tr_b16 a[6:7], v36 offset:14016
    s_waitcnt lgkmcnt(9)
    v_mfma_f32_16x16x32_bf16 v[64:67], v[56:59], a[8:11], v[64:67]
    ds_read_b128 v[56:59], v38 offset:640
    ds_read_b64_tr_b16 a[8:9], v36 offset:15360
    ds_read_b64_tr_b16 a[10:11], v36 offset:15552
    s_waitcnt lgkmcnt(9)
    v_mfma_f32_16x16x32_bf16 v[64:67], v[60:63], a[12:15], v[64:67]
    ds_read_b128 v[60:63], v38 offset:704
    ds_read_b64_tr_b16 a[12:13], v36 offset:16896
    ds_read_b64_tr_b16 a[14:15], v36 offset:17088
    s_waitcnt lgkmcnt(9)
    v_mfma_f32_16x16x32_bf16 v[64:67], v[48:51], a[0:3], v[64:67]
    ds_read_b128 v[48:51], v38 offset:768
    ds_read_b64_tr_b16 a[0:1], v36 offset:18432
    ds_read_b64_tr_b16 a[2:3], v36 offset:18624
    s_waitcnt lgkmcnt(9)
    v_mfma_f32_16x16x32_bf16 v[64:67], v[52:55], a[4:7], v[64:67]
    ds_read_b128 v[52:55], v38 offset:832
    ds_read_b64_tr_b16 a[4:5], v36 offset:19968
    ds_read_b64_tr_b16 a[6:7], v36 offset:20160
    s_waitcnt lgkmcnt(9)
    v_mfma_f32_16x16x32_bf16 v[64:67], v[56:59], a[8:11], v[64:67]
    ds_read_b128 v[56:59], v38 offset:896
    ds_read_b64_tr_b16 a[8:9], v36 offset:21504
    ds_read_b64_tr_b16 a[10:11], v36 offset:21696
    s_waitcnt lgkmcnt(9)
    v_mfma_f32_16x16x32_bf16 v[64:67], v[60:63], a[12:15], v[64:67]
    ds_read_b128 v[60:63], v38 offset:960
    ds_read_b64_tr_b16 a[12:13], v36 offset:23040
    ds_read_b64_tr_b16 a[14:15], v36 offset:23232
    s_waitcnt lgkmcnt(9)
    v_mfma_f32_16x16x32_bf16 v[64:67], v[48:51], a[0:3], v[64:67]
    ds_read_b128 v[48:51], v38 offset:1024
    ds_read_b64_tr_b16 a[0:1], v36 offset:24576
    ds_read_b64_tr_b16 a[2:3], v36 offset:24768
    s_waitcnt lgkmcnt(9)
    v_mfma_f32_16x16x32_bf16 v[64:67], v[52:55], a[4:7], v[64:67]
    ds_read_b128 v[52:55], v38 offset:1088
    ds_read_b64_tr_b16 a[4:5], v36 offset:26112
    ds_read_b64_tr_b16 a[6:7], v36 offset:26304
    s_waitcnt lgkmcnt(9)
    v_mfma_f32_16x16x32_bf16 v[64:67], v[56:59], a[8:11], v[64:67]
    s_waitcnt lgkmcnt(6)
    v_mfma_f32_16x16x32_bf16 v[64:67], v[60:63], a[12:15], v[64:67]
    s_waitcnt lgkmcnt(3)
    v_mfma_f32_16x16x32_bf16 v[64:67], v[48:51], a[0:3], v[64:67]
    s_waitcnt lgkmcnt(0)
    v_mfma_f32_16x16x32_bf16 v[64:67], v[52:55], a[4:7], v[64:67]
    s_mul_i32 s52, s45, 640
    s_add_u32 s52, s52, s51
    s_add_u32 s52, s52, 2304
    v_and_b32 v68, 1, v35
    v_mul_u32_u24 v68, 320, v68
    v_lshrrev_b32 v69, 1, v35
    v_lshl_add_u32 v68, v69, 3, v68
    s_nop 0
    v_cvt_pk_bf16_f32 v72, v64, v65
    v_cvt_pk_bf16_f32 v73, v66, v67
    v_mov_b32 v75, 0
    s_cmp_eq_u32 s36, 1
    s_cbranch_scc1 M_AV1
    v_add_u32 v69, 4, v37
    v_subrev_u32 v70, 4, v37
    v_cmp_gt_u32 vcc, 12, v37
    s_nop 1
    v_cndmask_b32 v69, v69, v70, vcc
    v_add_u32 v70, 12, v37
    v_cmp_gt_u32 vcc, 4, v37
    s_nop 1
    v_cndmask_b32 v69, v69, v70, vcc
    v_lshl_add_u32 v69, v69, 4, v68
    buffer_store_dwordx2 v[72:73], v69, s[20:23], s52 offen sc1
    s_branch M_AF
M_AV1:
    v_mov_b32 v70, 0x3f803f80
    v_cmp_eq_u32 vcc, 2, v37
    s_nop 1
    v_cndmask_b32 v72, v72, v70, vcc
    v_cndmask_b32 v73, v73, v70, vcc
    v_cmp_ne_u32 vcc, 3, v37
    s_nop 1
    v_cndmask_b32 v72, 0, v72, vcc
    v_cndmask_b32 v73, 0, v73, vcc
    v_add_u32 v69, 8, v37
    v_lshl_add_u32 v69, v69, 4, v68
    s_mov_b32 exec_lo, 0x000f000f
    s_mov_b32 exec_hi, 0x000f000f
    buffer_store_dwordx2 v[72:73], v69, s[20:23], s52 offen sc1
    s_mov_b64 exec, -1
M_AF:
M_A2:
    s_barrier
    v_lshlrev_b32 v20, 16, v84
    v_and_b32 v21, s50, v84
    v_lshlrev_b32 v22, 16, v85
    v_and_b32 v23, s50, v85
    v_lshlrev_b32 v24, 16, v86
    v_and_b32 v25, s50, v86
    v_lshlrev_b32 v26, 16, v87
    v_and_b32 v27, s50, v87
    v_pk_fma_f32 v[20:21], v[20:21], v[46:47], v[42:43] op_sel_hi:[1,0,0]
    v_pk_fma_f32 v[22:23], v[22:23], v[46:47], v[42:43] op_sel_hi:[1,0,0]
    v_pk_fma_f32 v[24:25], v[24:25], v[46:47], v[42:43] op_sel_hi:[1,0,0]
    v_pk_fma_f32 v[26:27], v[26:27], v[46:47], v[42:43] op_sel_hi:[1,0,0]
    v_cvt_pk_bf16_f32 v84, v20, v21
    v_cvt_pk_bf16_f32 v85, v22, v23
    v_cvt_pk_bf16_f32 v86, v24, v25
    v_cvt_pk_bf16_f32 v87, v26, v27
    ds_write_b128 v6, v[84:87] offset:37376
    s_add_u32 m0, s42, 59392
    s_add_u32 s48, s64, 442368
    buffer_load_dwordx4 v31, s[24:27], s48 offen lds
    v_lshlrev_b32 v20, 16, v88
    v_and_b32 v21, s50, v88
    v_lshlrev_b32 v22, 16, v89
    v_and_b32 v23, s50, v89
    v_lshlrev_b32 v24, 16, v90
    v_and_b32 v25, s50, v90
    v_lshlrev_b32 v26, 16, v91
    v_and_b32 v27, s50, v91
    v_pk_fma_f32 v[20:21], v[20:21], v[46:47], v[42:43] op_sel_hi:[1,0,0]
    v_pk_fma_f32 v[22:23], v[22:23], v[46:47], v[42:43] op_sel_hi:[1,0,0]
    v_pk_fma_f32 v[24:25], v[24:25], v[46:47], v[42:43] op_sel_hi:[1,0,0]
    v_pk_fma_f32 v[26:27], v[26:27], v[46:47], v[42:43] op_sel_hi:[1,0,0]
    v_cvt_pk_bf16_f32 v88, v20, v21
    v_cvt_pk_bf16_f32 v89, v22, v23
    v_cvt_pk_bf16_f32 v90, v24, v25
    v_cvt_pk_bf16_f32 v91, v26, v27
    ds_write_b128 v6, v[88:91] offset:37504
    s_add_u32 m0, s42, 64512
    s_add_u32 s48, s64, 516096
    buffer_load_dwordx4 v30, s[24:27], s48 offen lds
    v_lshlrev_b32 v20, 16, v92
    v_and_b32 v21, s50, v92
    v_lshlrev_b32 v22, 16, v93
    v_and_b32 v23, s50, v93
    v_lshlrev_b32 v24, 16, v94
    v_and_b32 v25, s50, v94
    v_lshlrev_b32 v26, 16, v95
    v_and_b32 v27, s50, v95
    v_pk_fma_f32 v[20:21], v[20:21], v[46:47], v[42:43] op_sel_hi:[1,0,0]
    v_pk_fma_f32 v[22:23], v[22:23], v[46:47], v[42:43] op_sel_hi:[1,0,0]
    v_pk_fma_f32 v[24:25], v[24:25], v[46:47], v[42:43] op_sel_hi:[1,0,0]
    v_pk_fma_f32 v[26:27], v[26:27], v[46:47], v[42:43] op_sel_hi:[1,0,0]
    v_cvt_pk_bf16_f32 v92, v20, v21
    v_cvt_pk_bf16_f32 v93, v22, v23
    v_cvt_pk_bf16_f32 v94, v24, v25
    v_cvt_pk_bf16_f32 v95, v26, v27
    ds_write_b128 v6, v[92:95] offset:37632
    s_add_u32 m0, s42, 68608
    s_add_u32 s48, s64, 516096
    buffer_load_dwordx4 v31, s[24:27], s48 offen lds
    v_lshlrev_b32 v20, 16, v96
    v_and_b32 v21, s50, v96
    v_lshlrev_b32 v22, 16, v97
    v_and_b32 v23, s50, v97
    v_lshlrev_b32 v24, 16, v98
    v_and_b32 v25, s50, v98
    v_lshlrev_b32 v26, 16, v99
    v_and_b32 v27, s50, v99
    v_pk_fma_f32 v[20:21], v[20:21], v[46:47], v[42:43] op_sel_hi:[1,0,0]
    v_pk_fma_f32 v[22:23], v[22:23], v[46:47], v[42:43] op_sel_hi:[1,0,0]
    v_pk_fma_f32 v[24:25], v[24:25], v[46:47], v[42:43] op_sel_hi:[1,0,0]
    v_pk_fma_f32 v[26:27], v[26:27], v[46:47], v[42:43] op_sel_hi:[1,0,0]
    v_cvt_pk_bf16_f32 v96, v20, v21
    v_cvt_pk_bf16_f32 v97, v22, v23
    v_cvt_pk_bf16_f32 v98, v24, v25
    v_cvt_pk_bf16_f32 v99, v26, v27
    ds_write_b128 v6, v[96:99] offset:37760
    s_add_u32 m0, s42, 73728
    s_add_u32 s48, s64, 589824
    buffer_load_dwordx4 v30, s[24:27], s48 offen lds
    v_lshlrev_b32 v20, 16, v100
    v_and_b32 v21, s50, v100
    v_lshlrev_b32 v22, 16, v101
    v_and_b32 v23, s50, v101
    v_lshlrev_b32 v24, 16, v102
    v_and_b32 v25, s50, v102
    v_lshlrev_b32 v26, 16, v103
    v_and_b32 v27, s50, v103
    v_pk_fma_f32 v[20:21], v[20:21], v[46:47], v[42:43] op_sel_hi:[1,0,0]
    v_pk_fma_f32 v[22:23], v[22:23], v[46:47], v[42:43] op_sel_hi:[1,0,0]
    v_pk_fma_f32 v[24:25], v[24:25], v[46:47], v[42:43] op_sel_hi:[1,0,0]
    v_pk_fma_f32 v[26:27], v[26:27], v[46:47], v[42:43] op_sel_hi:[1,0,0]
    v_cvt_pk_bf16_f32 v100, v20, v21
    v_cvt_pk_bf16_f32 v101, v22, v23
    v_cvt_pk_bf16_f32 v102, v24, v25
    v_cvt_pk_bf16_f32 v103, v26, v27
    ds_write_b128 v6, v[100:103] offset:37888
    s_add_u32 m0, s42, 77824
    s_add_u32 s48, s64, 589824
    buffer_load_dwordx4 v31, s[24:27], s48 offen lds
    v_lshlrev_b32 v20, 16, v104
    v_and_b32 v21, s50, v104
    v_lshlrev_b32 v22, 16, v105
    v_and_b32 v23, s50, v105
    v_lshlrev_b32 v24, 16, v106
    v_and_b32 v25, s50, v106
    v_lshlrev_b32 v26, 16, v107
    v_and_b32 v27, s50, v107
    v_pk_fma_f32 v[20:21], v[20:21], v[46:47], v[42:43] op_sel_hi:[1,0,0]
    v_pk_fma_f32 v[22:23], v[22:23], v[46:47], v[42:43] op_sel_hi:[1,0,0]
    v_pk_fma_f32 v[24:25], v[24:25], v[46:47], v[42:43] op_sel_hi:[1,0,0]
    v_pk_fma_f32 v[26:27], v[26:27], v[46:47], v[42:43] op_sel_hi:[1,0,0]
    v_cvt_pk_bf16_f32 v104, v20, v21
    v_cvt_pk_bf16_f32 v105, v22, v23
    v_cvt_pk_bf16_f32 v106, v24, v25
    v_cvt_pk_bf16_f32 v107, v26, v27
    ds_write_b128 v6, v[104:107] offset:38016
    s_mov_b32 m0, 81920
    s_add_u32 s48, s64, 589824
    buffer_load_dwordx4 v32, s[24:27], s48 offen lds
    s_waitcnt vmcnt(6)
    s_getreg_b32 s63, hwreg(HW_REG_XCC_ID, 0, 4)
    s_cmp_ge_u32 s36, 2
    s_cbranch_scc1 M_A3
    v_mov_b32 v74, s2
    s_lshl_b32 s3, s36, 3
    v_mov_b32 v73, s3
    v_and_b32 v75, -16, v75
    v_or_b32 v75, s63, v75
    s_mov_b64 exec, 1
    buffer_store_dwordx2 v[74:75], v73, s[20:23], s46 offen sc1
    s_mov_b64 exec, -1
M_A3:
    v_lshlrev_b32 v20, 16, v108
    v_and_b32 v21, s50, v108
    v_lshlrev_b32 v22, 16, v109
    v_and_b32 v23, s50, v109
    v_lshlrev_b32 v24, 16, v110
    v_and_b32 v25, s50, v110
    v_lshlrev_b32 v26, 16, v111
    v_and_b32 v27, s50, v111
    v_pk_fma_f32 v[20:21], v[20:21], v[46:47], v[42:43] op_sel_hi:[1,0,0]
    v_pk_fma_f32 v[22:23], v[22:23], v[46:47], v[42:43] op_sel_hi:[1,0,0]
    v_pk_fma_f32 v[24:25], v[24:25], v[46:47], v[42:43] op_sel_hi:[1,0,0]
    v_pk_fma_f32 v[26:27], v[26:27], v[46:47], v[42:43] op_sel_hi:[1,0,0]
    v_cvt_pk_bf16_f32 v108, v20, v21
    v_cvt_pk_bf16_f32 v109, v22, v23
    v_cvt_pk_bf16_f32 v110, v24, v25
    v_cvt_pk_bf16_f32 v111, v26, v27
    ds_write_b128 v6, v[108:111] offset:38144
    v_lshlrev_b32 v20, 16, v112
    v_and_b32 v21, s50, v112
    v_lshlrev_b32 v22, 16, v113
    v_and_b32 v23, s50, v113
    v_lshlrev_b32 v24, 16, v114
    v_and_b32 v25, s50, v114
    v_lshlrev_b32 v26, 16, v115
    v_and_b32 v27, s50, v115
    v_pk_fma_f32 v[20:21], v[20:21], v[46:47], v[42:43] op_sel_hi:[1,0,0]
    v_pk_fma_f32 v[22:23], v[22:23], v[46:47], v[42:43] op_sel_hi:[1,0,0]
    v_pk_fma_f32 v[24:25], v[24:25], v[46:47], v[42:43] op_sel_hi:[1,0,0]
    v_pk_fma_f32 v[26:27], v[26:27], v[46:47], v[42:43] op_sel_hi:[1,0,0]
    v_cvt_pk_bf16_f32 v112, v20, v21
    v_cvt_pk_bf16_f32 v113, v22, v23
    v_cvt_pk_bf16_f32 v114, v24, v25
    v_cvt_pk_bf16_f32 v115, v26, v27
    ds_write_b128 v6, v[112:115] offset:38272
    v_lshlrev_b32 v20, 16, v116
    v_and_b32 v21, s50, v116
    v_lshlrev_b32 v22, 16, v117
    v_and_b32 v23, s50, v117
    v_lshlrev_b32 v24, 16, v118
    v_and_b32 v25, s50, v118
    v_lshlrev_b32 v26, 16, v119
    v_and_b32 v27, s50, v119
    v_pk_fma_f32 v[20:21], v[20:21], v[46:47], v[42:43] op_sel_hi:[1,0,0]
    v_pk_fma_f32 v[22:23], v[22:23], v[46:47], v[42:43] op_sel_hi:[1,0,0]
    v_pk_fma_f32 v[24:25], v[24:25], v[46:47], v[42:43] op_sel_hi:[1,0,0]
    v_pk_fma_f32 v[26:27], v[26:27], v[46:47], v[42:43] op_sel_hi:[1,0,0]
    v_cvt_pk_bf16_f32 v116, v20, v21
    v_cvt_pk_bf16_f32 v117, v22, v23
    v_cvt_pk_bf16_f32 v118, v24, v25
    v_cvt_pk_bf16_f32 v119, v26, v27
    ds_write_b128 v6, v[116:119] offset:38400
    s_load_dwordx2 s[52:53], s[0:1], 56
    s_load_dwordx2 s[54:55], s[0:1], 72
    s_cmp_ge_u32 s36, 2
    s_cbranch_scc1 M_A5
    s_waitcnt vmcnt(1)
    s_branch M_A6
M_A5:
    s_waitcnt vmcnt(0)
M_A6:
    s_waitcnt lgkmcnt(0)
    s_barrier
    s_mov_b32 s24, s52
    s_mov_b32 s25, s53
    s_mov_b32 s26, 0x00002400
    s_mov_b32 s27, 0x00020000
    s_mov_b32 s28, s54
    s_mov_b32 s29, s55
    s_mov_b32 s30, 0x00000480
    s_mov_b32 s31, 0x00020000
    ds_read_b64_tr_b16 a[16:17], v33 offset:0
    ds_read_b64_tr_b16 a[18:19], v33 offset:144
    ds_read_b128 a[32:35], v7 offset:0
    ds_read_b128 a[48:51], v28 offset:0
    ds_read_b64_tr_b16 a[20:21], v33 offset:2304
    ds_read_b64_tr_b16 a[22:23], v33 offset:2448
    ds_read_b128 a[36:39], v7 offset:32
    ds_read_b128 a[52:55], v28 offset:32
    ds_read_b64_tr_b16 a[24:25], v33 offset:4608
    ds_read_b64_tr_b16 a[26:27], v33 offset:4752
    ds_read_b128 a[40:43], v7 offset:64
    ds_read_b128 a[56:59], v28 offset:64
    s_waitcnt lgkmcnt(8)
    v_mfma_f32_32x32x16_bf16 v[48:63], a[16:19], a[32:35], 0
    ds_read_b64_tr_b16 a[28:29], v33 offset:6912
    ds_read_b64_tr_b16 a[30:31], v33 offset:7056
    ds_read_b128 a[44:47], v7 offset:96
    ds_read_b128 a[60:63], v28 offset:96
    v_mfma_f32_32x32x16_bf16 v[64:79], a[16:19], a[48:51], 0
    s_mul_i32 s56, s37, 73728
    s_add_u32 s56, s56, 2097152
    s_lshl_b32 s57, s38, 2
    s_add_u32 s57, s57, s36
    s_lshl_b32 s58, s57, 10
    s_add_u32 s58, s58, s56
    s_waitcnt lgkmcnt(8)
    v_mfma_f32_32x32x16_bf16 v[48:63], a[20:23], a[36:39], v[48:63]
    ds_read_b64_tr_b16 a[16:17], v33 offset:9216
    ds_read_b64_tr_b16 a[18:19], v33 offset:9360
    ds_read_b128 a[32:35], v7 offset:128
    ds_read_b128 a[48:51], v28 offset:128
    v_mfma_f32_32x32x16_bf16 v[64:79], a[20:23], a[52:55], v[64:79]
    buffer_load_dwordx2 v[192:193], v203, s[4:7], s69 offen offset:0
    s_waitcnt lgkmcnt(8)
    v_mfma_f32_32x32x16_bf16 v[48:63], a[24:27], a[40:43], v[48:63]
    ds_read_b64_tr_b16 a[20:21], v33 offset:11520
    ds_read_b64_tr_b16 a[22:23], v33 offset:11664
    ds_read_b128 a[36:39], v7 offset:160
    ds_read_b128 a[52:55], v28 offset:160
    v_mfma_f32_32x32x16_bf16 v[64:79], a[24:27], a[56:59], v[64:79]
    s_lshl_b32 s57, s57, 7
    s_add_u32 s59, s57, s56
    s_add_u32 s59, s59, 32768
    v_and_b32 v206, 7, v1
    v_lshlrev_b32 v206, 7, v206
    v_bfe_u32 v207, v1, 3, 1
    s_waitcnt lgkmcnt(8)
    v_mfma_f32_32x32x16_bf16 v[48:63], a[28:31], a[44:47], v[48:63]
    ds_read_b64_tr_b16 a[24:25], v33 offset:13824
    ds_read_b64_tr_b16 a[26:27], v33 offset:13968
    ds_read_b128 a[40:43], v7 offset:192
    ds_read_b128 a[56:59], v28 offset:192
    v_mfma_f32_32x32x16_bf16 v[64:79], a[28:31], a[60:63], v[64:79]
    buffer_load_dwordx2 v[194:195], v203, s[4:7], s69 offen offset:16
    s_waitcnt lgkmcnt(8)
    v_mfma_f32_32x32x16_bf16 v[48:63], a[16:19], a[32:35], v[48:63]
    ds_read_b64_tr_b16 a[28:29], v33 offset:16128
    ds_read_b64_tr_b16 a[30:31], v33 offset:16272
    ds_read_b128 a[44:47], v7 offset:224
    ds_read_b128 a[60:63], v28 offset:224
    v_mfma_f32_32x32x16_bf16 v[64:79], a[16:19], a[48:51], v[64:79]
    v_mul_u32_u24 v207, 36864, v207
    v_add_u32 v206, v206, v207
    s_mul_i32 s60, s68, 36864
    s_mul_i32 s57, s38, 4608
    s_add_u32 s60, s60, s57
    s_lshl_b32 s57, s67, 9
    s_waitcnt lgkmcnt(8)
    v_mfma_f32_32x32x16_bf16 v[48:63], a[20:23], a[36:39], v[48:63]
    ds_read_b64_tr_b16 a[16:17], v33 offset:18432
    ds_read_b64_tr_b16 a[18:19], v33 offset:18576
    ds_read_b128 a[32:35], v7 offset:256
    ds_read_b128 a[48:51], v28 offset:256
    v_mfma_f32_32x32x16_bf16 v[64:79], a[20:23], a[52:55], v[64:79]
    buffer_load_dwordx2 v[196:197], v203, s[4:7], s69 offen offset:32
    s_waitcnt lgkmcnt(8)
    v_mfma_f32_32x32x16_bf16 v[48:63], a[24:27], a[40:43], v[48:63]
    ds_read_b64_tr_b16 a[20:21], v33 offset:20736
    ds_read_b64_tr_b16 a[22:23], v33 offset:20880
    ds_read_b128 a[36:39], v7 offset:288
    ds_read_b128 a[52:55], v28 offset:288
    v_mfma_f32_32x32x16_bf16 v[64:79], a[24:27], a[56:59], v[64:79]
    s_sub_u32 s60, s60, s57
    s_mul_i32 s57, s41, 2560
    s_add_u32 s60, s60, s57
    s_add_u32 s60, s60, 4456448
    s_mul_i32 s61, s68, 6144
    s_mul_i32 s57, s38, 768
    s_waitcnt lgkmcnt(8)
    v_mfma_f32_32x32x16_bf16 v[48:63], a[28:31], a[44:47], v[48:63]
    ds_read_b64_tr_b16 a[24:25], v33 offset:23040
    ds_read_b64_tr_b16 a[26:27], v33 offset:23184
    ds_read_b128 a[40:43], v7 offset:320
    ds_read_b128 a[56:59], v28 offset:320
    v_mfma_f32_32x32x16_bf16 v[64:79], a[28:31], a[60:63], v[64:79]
    buffer_load_dwordx2 v[198:199], v203, s[4:7], s69 offen offset:48
    s_waitcnt lgkmcnt(8)
    v_mfma_f32_32x32x16_bf16 v[48:63], a[16:19], a[32:35], v[48:63]
    ds_read_b64_tr_b16 a[28:29], v33 offset:25344
    ds_read_b64_tr_b16 a[30:31], v33 offset:25488
    ds_read_b128 a[44:47], v7 offset:352
    ds_read_b128 a[60:63], v28 offset:352
    v_mfma_f32_32x32x16_bf16 v[64:79], a[16:19], a[48:51], v[64:79]
    s_add_u32 s61, s61, s57
    s_mul_i32 s57, s41, 384
    s_add_u32 s61, s61, s57
    s_add_u32 s61, s61, 1048576
    s_lshl_b32 s62, s68, 11
    s_lshl_b32 s57, s38, 8
    s_waitcnt lgkmcnt(8)
    v_mfma_f32_32x32x16_bf16 v[48:63], a[20:23], a[36:39], v[48:63]
    ds_read_b64_tr_b16 a[16:17], v33 offset:27648
    ds_read_b64_tr_b16 a[18:19], v33 offset:27792
    ds_read_b128 a[32:35], v7 offset:384
    ds_read_b128 a[48:51], v28 offset:384
    v_mfma_f32_32x32x16_bf16 v[64:79], a[20:23], a[52:55], v[64:79]
    buffer_load_dwordx2 v[200:201], v204, s[4:7], s70 offen
    s_waitcnt lgkmcnt(8)
    v_mfma_f32_32x32x16_bf16 v[48:63], a[24:27], a[40:43], v[48:63]
    ds_read_b64_tr_b16 a[20:21], v33 offset:29952
    ds_read_b64_tr_b16 a[22:23], v33 offset:30096
    ds_read_b128 a[36:39], v7 offset:416
    ds_read_b128 a[52:55], v28 offset:416
    v_mfma_f32_32x32x16_bf16 v[64:79], a[24:27], a[56:59], v[64:79]
    s_add_u32 s62, s62, s57
    s_lshl_b32 s57, s41, 7
    s_add_u32 s62, s62, s57
    s_add_u32 s62, s62, 655360
    v_min_u32 v208, 19, v1
    v_lshlrev_b32 v208, 7, v208
    s_waitcnt lgkmcnt(8)
    v_mfma_f32_32x32x16_bf16 v[48:63], a[28:31], a[44:47], v[48:63]
    ds_read_b64_tr_b16 a[24:25], v33 offset:32256
    ds_read_b64_tr_b16 a[26:27], v33 offset:32400
    ds_read_b128 a[40:43], v7 offset:448
    ds_read_b128 a[56:59], v28 offset:448
    v_mfma_f32_32x32x16_bf16 v[64:79], a[28:31], a[60:63], v[64:79]
    v_min_u32 v209, 2, v1
    v_lshlrev_b32 v209, 7, v209
    v_mov_b32 v210, 0
    s_bfe_u32 s51, s37, 65538
    s_mul_i32 s55, s51, 640
    s_lshl_b32 s57, s39, 6
    s_waitcnt lgkmcnt(8)
    v_mfma_f32_32x32x16_bf16 v[48:63], a[16:19], a[32:35], v[48:63]
    ds_read_b64_tr_b16 a[28:29], v33 offset:34560
    ds_read_b64_tr_b16 a[30:31], v33 offset:34704
    ds_read_b128 a[44:47], v7 offset:480
    ds_read_b128 a[60:63], v28 offset:480
    v_mfma_f32_32x32x16_bf16 v[64:79], a[16:19], a[48:51], v[64:79]
    s_add_u32 s55, s55, s57
    v_lshrrev_b32 v211, 5, v1
    v_lshl_add_u32 v211, v211, 3, s55
    v_and_b32 v212, 1, v1
    v_lshlrev_b32 v212, 2, v212
    v_bfe_u32 v213, v1, 1, 1
    s_waitcnt lgkmcnt(8)
    v_mfma_f32_32x32x16_bf16 v[48:63], a[20:23], a[36:39], v[48:63]
    ds_read_b64_tr_b16 a[16:17], v33 offset:36864
    ds_read_b64_tr_b16 a[18:19], v33 offset:37008
    ds_read_b128 a[32:35], v7 offset:512
    ds_read_b128 a[48:51], v28 offset:512
    v_mfma_f32_32x32x16_bf16 v[64:79], a[20:23], a[52:55], v[64:79]
    v_lshl_add_u32 v212, v213, 4, v212
    v_bfe_u32 v213, v1, 4, 1
    v_lshl_add_u32 v212, v213, 3, v212
    v_lshrrev_b32 v213, 5, v1
    v_lshl_add_u32 v212, v213, 5, v212
    s_lshl_b32 s57, s51, 6
    s_waitcnt lgkmcnt(8)
    v_mfma_f32_32x32x16_bf16 v[48:63], a[24:27], a[40:43], v[48:63]
    ds_read_b64_tr_b16 a[20:21], v33 offset:39168
    ds_read_b64_tr_b16 a[22:23], v33 offset:39312
    ds_read_b128 a[36:39], v7 offset:544
    ds_read_b128 a[52:55], v28 offset:544
    v_mfma_f32_32x32x16_bf16 v[64:79], a[24:27], a[56:59], v[64:79]
    v_add_u32 v212, s57, v212
    s_mul_i32 s55, s39, 1152
    s_mul_i32 s56, s51, 640
    s_add_u32 s56, s56, s55
    v_lshl_add_u32 v213, v0, 1, s56
    s_add_u32 s55, s55, s57
    v_lshlrev_b32 v39, 7, v0
    s_mov_b32 s46, 393216
    buffer_load_dwordx4 v[40:43], v39, s[20:23], s46 offen sc1
    s_waitcnt lgkmcnt(8)
    v_mfma_f32_32x32x16_bf16 v[48:63], a[28:31], a[44:47], v[48:63]
    ds_read_b64_tr_b16 a[24:25], v34 offset:0
    ds_read_b64_tr_b16 a[26:27], v34 offset:144
    ds_read_b128 a[40:43], v7 offset:576
    ds_read_b128 a[56:59], v28 offset:576
    v_mfma_f32_32x32x16_bf16 v[64:79], a[28:31], a[60:63], v[64:79]
    v_lshl_add_u32 v214, v3, 1, s55
    s_lshl_b32 s55, s39, 1
    s_add_u32 s55, s55, s51
    s_lshl_b32 s55, s55, 6
    s_add_u32 s55, s55, s40
    s_lshl_b32 s55, s55, 7
    s_waitcnt lgkmcnt(8)
    v_mfma_f32_32x32x16_bf16 v[48:63], a[16:19], a[32:35], v[48:63]
    ds_read_b64_tr_b16 a[28:29], v34 offset:2304
    ds_read_b64_tr_b16 a[30:31], v34 offset:2448
    ds_read_b128 a[44:47], v7 offset:608
    ds_read_b128 a[60:63], v28 offset:608
    v_mfma_f32_32x32x16_bf16 v[64:79], a[16:19], a[48:51], v[64:79]
    s_add_u32 s55, s55, 786432
    v_mov_b32 v210, s55
    s_lshl_b32 s55, s40, 1
    s_add_u32 s55, s55, s51
    s_lshl_b32 s55, s55, 3
    s_add_u32 s55, s55, s39
    s_waitcnt lgkmcnt(8)
    v_mfma_f32_32x32x16_bf16 v[48:63], a[20:23], a[36:39], v[48:63]
    ds_read_b64_tr_b16 a[16:17], v34 offset:4608
    ds_read_b64_tr_b16 a[18:19], v34 offset:4752
    ds_read_b128 a[32:35], v7 offset:640
    ds_read_b128 a[48:51], v28 offset:640
    v_mfma_f32_32x32x16_bf16 v[64:79], a[20:23], a[52:55], v[64:79]
    s_lshl_b32 s55, s55, 7
    s_add_u32 s55, s55, 196608
    v_writelane_b32 v210, s55, 1
    v_writelane_b32 v210, s62, 0
    s_lshl_b32 s55, s37, 5
    s_lshl_b32 s56, s38, 2
    s_waitcnt lgkmcnt(8)
    v_mfma_f32_32x32x16_bf16 v[48:63], a[24:27], a[40:43], v[48:63]
    ds_read_b64_tr_b16 a[20:21], v34 offset:6912
    ds_read_b64_tr_b16 a[22:23], v34 offset:7056
    ds_read_b128 a[36:39], v7 offset:672
    ds_read_b128 a[52:55], v28 offset:672
    v_mfma_f32_32x32x16_bf16 v[64:79], a[24:27], a[56:59], v[64:79]
    s_add_u32 s55, s55, s56
    s_add_u32 s55, s55, s36
    s_lshl_b32 s55, s55, 7
    s_add_u32 s55, s55, 524288
    v_writelane_b32 v210, s55, 2
    s_lshr_b32 s55, s36, 1
    s_waitcnt lgkmcnt(8)
    v_mfma_f32_32x32x16_bf16 v[48:63], a[28:31], a[44:47], v[48:63]
    ds_read_b64_tr_b16 a[24:25], v34 offset:9216
    ds_read_b64_tr_b16 a[26:27], v34 offset:9360
    ds_read_b128 a[40:43], v7 offset:704
    ds_read_b128 a[56:59], v28 offset:704
    v_mfma_f32_32x32x16_bf16 v[64:79], a[28:31], a[60:63], v[64:79]
    v_lshrrev_b32 v228, 5, v1
    v_bfe_u32 v229, v1, 2, 2
    v_and_b32 v230, 3, v1
    v_bfe_u32 v231, v1, 4, 1
    v_lshlrev_b32 v232, 2, v229
    v_lshl_add_u32 v233, v228, 1, v232
    s_waitcnt lgkmcnt(8)
    v_mfma_f32_32x32x16_bf16 v[48:63], a[16:19], a[32:35], v[48:63]
    ds_read_b64_tr_b16 a[28:29], v34 offset:11520
    ds_read_b64_tr_b16 a[30:31], v34 offset:11664
    ds_read_b128 a[44:47], v7 offset:736
    ds_read_b128 a[60:63], v28 offset:736
    v_mfma_f32_32x32x16_bf16 v[64:79], a[16:19], a[48:51], v[64:79]
    v_mul_u32_u24 v233, 144, v233
    v_lshl_add_u32 v234, v231, 2, v230
    v_lshl_add_u32 v233, v234, 3, v233
    s_lshl_b32 s56, s41, 6
    s_lshl_b32 s57, s67, 4
    s_add_u32 s56, s56, s57
    s_waitcnt lgkmcnt(8)
    v_mfma_f32_32x32x16_bf16 v[48:63], a[20:23], a[36:39], v[48:63]
    ds_read_b64_tr_b16 a[16:17], v34 offset:13824
    ds_read_b64_tr_b16 a[18:19], v34 offset:13968
    ds_read_b128 a[32:35], v7 offset:768
    ds_read_b128 a[48:51], v28 offset:768
    v_mfma_f32_32x32x16_bf16 v[64:79], a[20:23], a[52:55], v[64:79]
    v_add_u32 v216, s56, v233
    v_add_u32 v217, 41472, v216
    v_lshl_add_u32 v233, v231, 1, v232
    v_lshl_add_u32 v233, v228, 4, v233
    v_mul_u32_u24 v233, 144, v233
    v_lshl_add_u32 v233, v230, 3, v233
    s_waitcnt lgkmcnt(8)
    v_mfma_f32_32x32x16_bf16 v[48:63], a[24:27], a[40:43], v[48:63]
    ds_read_b64_tr_b16 a[20:21], v34 offset:16128
    ds_read_b64_tr_b16 a[22:23], v34 offset:16272
    ds_read_b128 a[36:39], v7 offset:800
    ds_read_b128 a[52:55], v28 offset:800
    v_mfma_f32_32x32x16_bf16 v[64:79], a[24:27], a[56:59], v[64:79]
    s_xor_b32 s56, s67, 1
    s_lshl_b32 s56, s56, 7
    v_add_u32 v218, s56, v233
    v_add_u32 v219, 41472, v218
    s_mul_i32 s57, s55, 36864
    s_add_u32 s57, s57, 83008
    s_waitcnt lgkmcnt(8)
    v_mfma_f32_32x32x16_bf16 v[48:63], a[28:31], a[44:47], v[48:63]
    ds_read_b64_tr_b16 a[24:25], v34 offset:18432
    ds_read_b64_tr_b16 a[26:27], v34 offset:18576
    ds_read_b128 a[40:43], v7 offset:832
    ds_read_b128 a[56:59], v28 offset:832
    v_mfma_f32_32x32x16_bf16 v[64:79], a[28:31], a[60:63], v[64:79]
    s_mov_b32 s3, 0x8000
M_KP:
    s_waitcnt vmcnt(0)
    v_cmp_ne_u32 vcc, s2, v40
    v_cmp_ne_u32 s[48:49], s2, v42
    s_nop 0
    s_or_b64 vcc, vcc, s[48:49]
    s_cbranch_scc0 M_KD
    s_sleep 2
    buffer_load_dwordx4 v[40:43], v39, s[20:23], s46 offen sc1
    s_sub_u32 s3, s3, 1
    s_cmp_lg_u32 s3, 0
    s_cbranch_scc1 M_KP
M_KD:
    v_mov_b32 v42, v41
    v_lshlrev_b32 v39, 3, v0
    v_add_u32 v39, 157696, v39
    ds_write_b64 v39, v[42:43]
    s_waitcnt lgkmcnt(0)
    s_barrier
    s_or_b32 s3, s37, s38
    s_or_b32 s3, s3, s36
    s_cbranch_scc1 M_NZ
    s_load_dwordx2 s[44:45], s[0:1], 88
    v_mov_b32 v39, 0
    s_waitcnt lgkmcnt(0)
    global_store_dword v39, v39, s[44:45] sc1
M_NZ:
    v_add_u32 v39, 157696, v5
    ds_read_b64 v[80:81], v39 offset:0
    ds_read_b64 v[82:83], v39 offset:512
    ds_read_b64 v[84:85], v39 offset:1024
    ds_read_b64 v[86:87], v39 offset:1536
    s_add_u32 m0, s42, 0
    s_nop 0
    buffer_load_dwordx4 v2, s[20:23], m0 offen sc1 lds
    s_waitcnt lgkmcnt(8)
    v_mfma_f32_32x32x16_bf16 v[48:63], a[16:19], a[32:35], v[48:63]
    ds_read_b64_tr_b16 a[28:29], v34 offset:20736
    ds_read_b64_tr_b16 a[30:31], v34 offset:20880
    ds_read_b128 a[44:47], v7 offset:864
    ds_read_b128 a[60:63], v28 offset:864
    v_mfma_f32_32x32x16_bf16 v[64:79], a[16:19], a[48:51], v[64:79]
    v_add_u32 v220, s57, v2
    v_and_b32 v234, 15, v1
    s_lshl_b32 s56, s41, 4
    s_add_u32 m0, s42, 4096
    s_nop 0
    buffer_load_dwordx4 v2, s[20:23], m0 offen sc1 lds
    s_waitcnt lgkmcnt(8)
    v_mfma_f32_32x32x16_bf16 v[48:63], a[20:23], a[36:39], v[48:63]
    ds_read_b64_tr_b16 a[16:17], v34 offset:23040
    ds_read_b64_tr_b16 a[18:19], v34 offset:23184
    ds_read_b128 a[32:35], v7 offset:896
    ds_read_b128 a[48:51], v28 offset:896
    v_mfma_f32_32x32x16_bf16 v[64:79], a[20:23], a[52:55], v[64:79]
    v_add_u32 v234, s56, v234
    v_lshl_add_u32 v222, v231, 5, v234
    v_lshlrev_b32 v222, 4, v222
    s_add_u32 m0, s42, 8192
    s_nop 0
    buffer_load_dwordx4 v2, s[20:23], m0 offen sc1 lds
    s_waitcnt lgkmcnt(8)
    v_mfma_f32_32x32x16_bf16 v[48:63], a[24:27], a[40:43], v[48:63]
    ds_read_b64_tr_b16 a[20:21], v34 offset:25344
    ds_read_b64_tr_b16 a[22:23], v34 offset:25488
    ds_read_b128 a[36:39], v7 offset:928
    ds_read_b128 a[52:55], v28 offset:928
    v_mfma_f32_32x32x16_bf16 v[64:79], a[24:27], a[56:59], v[64:79]
    v_lshl_add_u32 v221, v228, 10, v222
    v_add_u32 v221, s57, v221
    v_lshl_add_u32 v223, v228, 9, v4
    s_add_u32 m0, s42, 12288
    s_nop 0
    buffer_load_dwordx4 v2, s[20:23], m0 offen sc1 lds
    v_xor_b32 v40, s63, v80
    v_xor_b32 v41, s63, v82
    v_xor_b32 v42, s63, v84
    v_xor_b32 v43, s63, v86
    v_or3_b32 v40, v40, v41, v42
    v_or_b32 v40, v40, v43
    s_waitcnt lgkmcnt(8)
    v_mfma_f32_32x32x16_bf16 v[48:63], a[28:31], a[44:47], v[48:63]
    ds_read_b64_tr_b16 a[24:25], v34 offset:27648
    ds_read_b64_tr_b16 a[26:27], v34 offset:27792
    ds_read_b128 a[40:43], v7 offset:960
    ds_read_b128 a[56:59], v28 offset:960
    v_mfma_f32_32x32x16_bf16 v[64:79], a[28:31], a[60:63], v[64:79]
    v_add_u32 v223, s57, v223
    v_lshrrev_b32 v235, 4, v1
    v_lshlrev_b32 v235, 9, v235
    s_add_u32 m0, s43, 16384
    s_nop 0
    buffer_load_dwordx4 v2, s[20:23], m0 offen sc1 lds
    v_and_b32 v40, 15, v40
    v_cmp_ne_u32 vcc, 0, v40
    v_and_b32 v44, 7, v1
    s_lshr_b32 s3, s37, 2
    v_cmp_eq_u32 s[48:49], s3, v44
    s_nop 0
    s_and_b64 vcc, vcc, s[48:49]
    s_cselect_b32 s63, 1, 0
    s_waitcnt lgkmcnt(8)
    v_mfma_f32_32x32x16_bf16 v[48:63], a[16:19], a[32:35], v[48:63]
    ds_read_b64_tr_b16 a[28:29], v34 offset:29952
    ds_read_b64_tr_b16 a[30:31], v34 offset:30096
    ds_read_b128 a[44:47], v7 offset:992
    ds_read_b128 a[60:63], v28 offset:992
    v_mfma_f32_32x32x16_bf16 v[64:79], a[16:19], a[48:51], v[64:79]
    v_lshl_add_u32 v224, v234, 2, v235
    v_add_u32 v224, s57, v224
    v_lshlrev_b32 v225, 3, v234
    s_add_u32 m0, s42, 19456
    s_nop 0
    buffer_load_dwordx4 v2, s[20:23], m0 offen sc1 lds
    v_max3_f32 v88, v80, v82, v84
    v_max3_f32 v89, v81, v83, v85
    v_max_f32 v88, v88, v86
    v_max_f32 v89, v89, v87
    s_waitcnt lgkmcnt(8)
    v_mfma_f32_32x32x16_bf16 v[48:63], a[20:23], a[36:39], v[48:63]
    ds_read_b64_tr_b16 a[16:17], v34 offset:32256
    ds_read_b64_tr_b16 a[18:19], v34 offset:32400
    ds_read_b128 a[32:35], v7 offset:1024
    ds_read_b128 a[48:51], v28 offset:1024
    v_mfma_f32_32x32x16_bf16 v[64:79], a[20:23], a[52:55], v[64:79]
    v_lshlrev_b32 v226, 3, v3
    s_add_u32 m0, s42, 23552
    s_nop 0
    buffer_load_dwordx4 v2, s[20:23], m0 offen sc1 lds
    v_max_f32_dpp v88, v88, v88 quad_perm:[1,0,3,2] row_mask:0xf bank_mask:0xf
    v_max_f32_dpp v89, v89, v89 quad_perm:[1,0,3,2] row_mask:0xf bank_mask:0xf
    s_nop 0
    v_max_f32_dpp v88, v88, v88 quad_perm:[2,3,0,1] row_mask:0xf bank_mask:0xf
    v_max_f32_dpp v89, v89, v89 quad_perm:[2,3,0,1] row_mask:0xf bank_mask:0xf
    s_waitcnt lgkmcnt(8)
    v_mfma_f32_32x32x16_bf16 v[48:63], a[24:27], a[40:43], v[48:63]
    ds_read_b64_tr_b16 a[20:21], v34 offset:34560
    ds_read_b64_tr_b16 a[22:23], v34 offset:34704
    ds_read_b128 a[36:39], v7 offset:1056
    ds_read_b128 a[52:55], v28 offset:1056
    v_mfma_f32_32x32x16_bf16 v[64:79], a[24:27], a[56:59], v[64:79]
    s_add_u32 m0, s42, 27648
    s_nop 0
    buffer_load_dwordx4 v2, s[20:23], m0 offen sc1 lds
    v_max_f32_dpp v88, v88, v88 row_half_mirror row_mask:0xf bank_mask:0xf
    v_max_f32_dpp v89, v89, v89 row_half_mirror row_mask:0xf bank_mask:0xf
    s_nop 0
    v_max_f32_dpp v88, v88, v88 row_mirror row_mask:0xf bank_mask:0xf
    v_max_f32_dpp v89, v89, v89 row_mirror row_mask:0xf bank_mask:0xf
    s_waitcnt lgkmcnt(8)
    v_mfma_f32_32x32x16_bf16 v[48:63], a[28:31], a[44:47], v[48:63]
    ds_read_b64_tr_b16 a[24:25], v34 offset:36864
    ds_read_b64_tr_b16 a[26:27], v34 offset:37008
    ds_read_b128 a[40:43], v7 offset:1088
    ds_read_b128 a[56:59], v28 offset:1088
    v_mfma_f32_32x32x16_bf16 v[64:79], a[28:31], a[60:63], v[64:79]
    s_add_u32 m0, s42, 31744
    s_nop 0
    buffer_load_dwordx4 v2, s[20:23], m0 offen sc1 lds
    v_mov_b32 v40, v88
    v_mov_b32 v41, v89
    s_nop 0
    v_permlane16_swap_b32 v88, v40
    v_permlane16_swap_b32 v89, v41
    v_max_f32 v88, v88, v40
    v_max_f32 v89, v89, v41
    s_waitcnt lgkmcnt(8)
    v_mfma_f32_32x32x16_bf16 v[48:63], a[16:19], a[32:35], v[48:63]
    ds_read_b64_tr_b16 a[28:29], v34 offset:39168
    ds_read_b64_tr_b16 a[30:31], v34 offset:39312
    ds_read_b128 a[44:47], v7 offset:1120
    ds_read_b128 a[60:63], v28 offset:1120
    v_mfma_f32_32x32x16_bf16 v[64:79], a[16:19], a[48:51], v[64:79]
    s_add_u32 m0, s43, 35840
    s_nop 0
    buffer_load_dwordx4 v2, s[20:23], m0 offen sc1 lds
    v_mov_b32 v40, v88
    v_mov_b32 v41, v89
    s_nop 0
    v_permlane32_swap_b32 v88, v40
    v_permlane32_swap_b32 v89, v41
    v_max_f32 v88, v88, v40
    v_max_f32 v89, v89, v41
    s_waitcnt lgkmcnt(8)
    v_mfma_f32_32x32x16_bf16 v[48:63], a[20:23], a[36:39], v[48:63]
    v_mfma_f32_32x32x16_bf16 v[64:79], a[20:23], a[52:55], v[64:79]
    v_add_f32 v88, v88, v89
    s_waitcnt lgkmcnt(4)
    v_mfma_f32_32x32x16_bf16 v[48:63], a[24:27], a[40:43], v[48:63]
    v_mfma_f32_32x32x16_bf16 v[64:79], a[24:27], a[56:59], v[64:79]
    s_waitcnt lgkmcnt(0)
    v_mfma_f32_32x32x16_bf16 v[48:63], a[28:31], a[44:47], v[48:63]
    v_mfma_f32_32x32x16_bf16 v[64:79], a[28:31], a[60:63], v[64:79]
    v_mov_b32 v110, 0
    v_mov_b32 v111, 0
    v_mov_b32 v29, 0x00003f80
    v_mov_b32 v90, 0
    v_mov_b32 v92, 0
    s_lshl_b32 s46, s36, 2
    s_add_u32 s46, s46, 159744
    v_mov_b32 v94, s46
    v_and_b32 v95, 3, v1
    v_lshlrev_b32 v95, 2, v95
    v_add_u32 v95, 159744, v95
    s_nop 0
    s_cmp_eq_u32 s41, 1
    s_cbranch_scc1 M_QO
    v_cvt_pk_bf16_f32 v16, v56, v57
    v_cvt_pk_bf16_f32 v18, v72, v73
    v_mov_b32 v17, v16
    v_mov_b32 v19, v18
    v_cvt_pk_bf16_f32 v8, v48, v49
    v_cvt_pk_bf16_f32 v9, v50, v51
    v_cvt_pk_bf16_f32 v10, v52, v53
    v_cvt_pk_bf16_f32 v11, v54, v55
    v_cvt_pk_bf16_f32 v12, v64, v65
    v_cvt_pk_bf16_f32 v13, v66, v67
    v_cvt_pk_bf16_f32 v14, v68, v69
    v_cvt_pk_bf16_f32 v15, v70, v71
    v_permlane32_swap_b32 v16, v17
    v_permlane32_swap_b32 v18, v19
    s_branch M_QD
M_QO:
    v_cvt_pk_bf16_f32 v16, v62, v63
    v_cvt_pk_bf16_f32 v18, v78, v79
    v_mov_b32 v17, v16
    v_mov_b32 v19, v18
    v_cvt_pk_bf16_f32 v8, v50, v51
    v_cvt_pk_bf16_f32 v9, v52, v53
    v_cvt_pk_bf16_f32 v10, v58, v59
    v_cvt_pk_bf16_f32 v11, v60, v61
    v_cvt_pk_bf16_f32 v12, v66, v67
    v_cvt_pk_bf16_f32 v13, v68, v69
    v_cvt_pk_bf16_f32 v14, v74, v75
    v_cvt_pk_bf16_f32 v15, v76, v77
    v_permlane32_swap_b32 v17, v16
    v_permlane32_swap_b32 v19, v18
M_QD:
    v_dot2_f32_bf16 v90, v8, v8, v90
    v_dot2_f32_bf16 v92, v12, v12, v92
    v_dot2_f32_bf16 v90, v9, v9, v90
    v_dot2_f32_bf16 v92, v13, v13, v92
    v_dot2_f32_bf16 v90, v10, v10, v90
    v_dot2_f32_bf16 v92, v14, v14, v92
    v_dot2_f32_bf16 v90, v11, v11, v90
    v_dot2_f32_bf16 v92, v15, v15, v92
    v_dot2_f32_bf16 v96, v16, v16, 0
    v_dot2_f32_bf16 v97, v18, v18, 0
    v_mov_b32 v91, v90
    v_mov_b32 v93, v92
    s_nop 0
    v_permlane32_swap_b32 v90, v91
    v_permlane32_swap_b32 v92, v93
    v_add_f32 v90, v90, v91
    v_add_f32 v92, v92, v93
    v_add_f32 v90, v90, v96
    v_add_f32 v92, v92, v97
    v_mul_f32 v90, v90, v88
    v_mul_f32 v92, v92, v88
    v_sqrt_f32 v90, v90
    v_sqrt_f32 v92, v92
    v_mul_f32 v90, 0x3f8147ae, v90
    v_mul_f32 v92, 0x3f8147ae, v92
    v_cmp_nge_f32 vcc, 0x42200000, v90
    s_nop 0
    s_mov_b64 s[44:45], vcc
    v_cmp_nge_f32 vcc, 0x42200000, v92
    s_nop 0
    s_or_b64 s[44:45], s[44:45], vcc
    s_or_b32 s44, s44, s45
    v_mov_b32 v41, s44
    ds_write_b32 v94, v41
    v_add_u32 v90, 0xffff, v90
    v_add_u32 v92, 0xffff, v92
    v_lshrrev_b32 v90, 16, v90
    v_lshrrev_b32 v92, 16, v92
    v_or_b32 v17, 0x8000, v90
    v_or_b32 v19, 0x8000, v92
    s_waitcnt vmcnt(0) lgkmcnt(0)
    s_barrier
    ds_read_b32 v41, v95
    ds_read_b32 v28, v179 offset:0
    ds_read_b128 v[20:23], v176 offset:0
    ds_read_b128 v[24:27], v176 offset:1024
    s_waitcnt lgkmcnt(3)
    v_cmp_ne_u32 vcc, 0, v41
    s_cbranch_vccnz M_SLOW
    s_waitcnt lgkmcnt(0)
    v_mfma_f32_32x32x4_2b_bf16 v[48:79], v[28:29], v[16:17], 0
    v_mov_b32 v32, 0
    v_mov_b32 v33, 0
    v_mov_b32 v34, 0
    v_mov_b32 v35, 0
    v_mov_b32 v36, 0
    v_mov_b32 v37, 0
    v_mov_b32 v38, 0
    v_mov_b32 v39, 0
    v_mov_b32 v40, 0
    v_mov_b32 v41, 0
    v_mov_b32 v42, 0
    v_mov_b32 v43, 0
    v_mov_b32 v44, 0
    v_mov_b32 v45, 0
    v_mov_b32 v46, 0
    v_mov_b32 v47, 0
    s_nop 1
    v_mfma_f32_32x32x16_bf16 v[48:63], v[20:23], v[8:11], v[48:63]
    v_mfma_f32_32x32x16_bf16 v[64:79], v[24:27], v[8:11], v[64:79]
    buffer_load_dwordx2 a[184:185], v211, s[28:31], 0 offen offset:0
    buffer_load_dwordx2 a[186:187], v211, s[28:31], 0 offen offset:16
    buffer_load_dwordx2 a[188:189], v211, s[28:31], 0 offen offset:32
    buffer_load_dwordx2 a[190:191], v211, s[28:31], 0 offen offset:48
    buffer_load_dword a193, v212, s[28:31], 0 offen offset:512
    buffer_load_ushort a194, v213, s[24:27], 0 offen
    buffer_load_ushort a195, v214, s[24:27], 0 offen offset:512
    s_nop 1
    s_add_u32 s47, s42, 38912
    s_mov_b32 s46, 2
.p2align 5
M_LA:
    v_exp_f32 v48, v48
    v_cvt_pk_bf16_f32 v143, v110, v111
    v_mfma_f32_32x32x4_2b_bf16 v[80:111], v[28:29], v[18:19], 0
    v_exp_f32 v49, v49
    v_exp_f32 v50, v50
    v_cvt_pk_bf16_f32 v112, v48, v49
    v_exp_f32 v51, v51
    v_exp_f32 v52, v52
    v_cvt_pk_bf16_f32 v113, v50, v51
    v_exp_f32 v53, v53
    v_exp_f32 v54, v54
    v_cvt_pk_bf16_f32 v114, v52, v53
    v_exp_f32 v55, v55
    v_mfma_f32_32x32x16_bf16 v[160:175], v[32:35], v[128:131], v[160:175]
    s_add_u32 m0, s47, 0
    ds_read_b32 v28, v179 offset:4864
    ds_read_b128 v[32:35], v182 offset:0
    v_exp_f32 v56, v56
    v_cvt_pk_bf16_f32 v115, v54, v55
    v_exp_f32 v57, v57
    v_exp_f32 v58, v58
    v_cvt_pk_bf16_f32 v116, v56, v57
    v_exp_f32 v59, v59
    v_mfma_f32_32x32x16_bf16 v[160:175], v[36:39], v[132:135], v[160:175]
    ds_read_b128 v[36:39], v182 offset:640
    buffer_load_dwordx4 v2, s[20:23], m0 offen sc1 lds
    v_exp_f32 v60, v60
    v_cvt_pk_bf16_f32 v117, v58, v59
    v_exp_f32 v61, v61
    v_exp_f32 v62, v62
    v_cvt_pk_bf16_f32 v118, v60, v61
    v_exp_f32 v63, v63
    v_mfma_f32_32x32x16_bf16 v[80:95], v[20:23], v[12:15], v[80:95]
    s_add_u32 m0, s47, 4096
    ds_read_b128 v[20:23], v176 offset:4864
    v_exp_f32 v64, v64
    v_cvt_pk_bf16_f32 v119, v62, v63
    v_exp_f32 v65, v65
    v_exp_f32 v66, v66
    v_cvt_pk_bf16_f32 v120, v64, v65
    v_exp_f32 v67, v67
    v_mfma_f32_32x32x16_bf16 v[96:111], v[24:27], v[12:15], v[96:111]
    ds_read_b128 v[24:27], v176 offset:5888
    buffer_load_dwordx4 v2, s[20:23], m0 offen sc1 lds
    v_exp_f32 v68, v68
    v_cvt_pk_bf16_f32 v121, v66, v67
    v_exp_f32 v69, v69
    v_exp_f32 v70, v70
    v_cvt_pk_bf16_f32 v122, v68, v69
    v_exp_f32 v71, v71
    v_mfma_f32_32x32x16_bf16 v[160:175], v[40:43], v[136:139], v[160:175]
    s_add_u32 m0, s47, 8192
    ds_read_b128 v[40:43], v182 offset:1280
    v_exp_f32 v72, v72
    v_cvt_pk_bf16_f32 v123, v70, v71
    v_exp_f32 v73, v73
    v_exp_f32 v74, v74
    v_cvt_pk_bf16_f32 v124, v72, v73
    v_exp_f32 v75, v75
    v_mfma_f32_32x32x16_bf16 v[160:175], v[44:47], v[140:143], v[160:175]
    s_waitcnt lgkmcnt(3)
    ds_read_b128 v[44:47], v182 offset:1920
    v_exp_f32 v76, v76
    v_cvt_pk_bf16_f32 v125, v74, v75
    v_exp_f32 v77, v77
    v_exp_f32 v78, v78
    v_cvt_pk_bf16_f32 v126, v76, v77
    v_exp_f32 v79, v79
    v_exp_f32 v80, v80
    v_cvt_pk_bf16_f32 v127, v78, v79
    v_mfma_f32_32x32x4_2b_bf16 v[48:79], v[28:29], v[16:17], 0
    v_exp_f32 v81, v81
    v_exp_f32 v82, v82
    v_cvt_pk_bf16_f32 v128, v80, v81
    v_exp_f32 v83, v83
    v_exp_f32 v84, v84
    v_cvt_pk_bf16_f32 v129, v82, v83
    v_exp_f32 v85, v85
    v_exp_f32 v86, v86
    v_cvt_pk_bf16_f32 v130, v84, v85
    v_exp_f32 v87, v87
    v_mfma_f32_32x32x16_bf16 v[144:159], v[32:35], v[112:115], v[144:159]
    buffer_load_dwordx4 v2, s[20:23], m0 offen sc1 lds
    v_exp_f32 v88, v88
    v_cvt_pk_bf16_f32 v131, v86, v87
    v_exp_f32 v89, v89
    v_exp_f32 v90, v90
    v_cvt_pk_bf16_f32 v132, v88, v89
    v_exp_f32 v91, v91
    v_mfma_f32_32x32x16_bf16 v[144:159], v[36:39], v[116:119], v[144:159]
    s_waitcnt lgkmcnt(0)
    v_exp_f32 v92, v92
    v_cvt_pk_bf16_f32 v133, v90, v91
    v_exp_f32 v93, v93
    v_exp_f32 v94, v94
    v_cvt_pk_bf16_f32 v134, v92, v93
    v_exp_f32 v95, v95
    v_mfma_f32_32x32x16_bf16 v[48:63], v[20:23], v[8:11], v[48:63]
    s_add_u32 m0, s47, 12288
    v_exp_f32 v96, v96
    v_cvt_pk_bf16_f32 v135, v94, v95
    v_exp_f32 v97, v97
    v_exp_f32 v98, v98
    v_cvt_pk_bf16_f32 v136, v96, v97
    v_exp_f32 v99, v99
    v_mfma_f32_32x32x16_bf16 v[64:79], v[24:27], v[8:11], v[64:79]
    buffer_load_dwordx4 v2, s[20:23], m0 offen sc1 lds
    v_exp_f32 v100, v100
    v_cvt_pk_bf16_f32 v137, v98, v99
    v_exp_f32 v101, v101
    v_exp_f32 v102, v102
    v_cvt_pk_bf16_f32 v138, v100, v101
    v_exp_f32 v103, v103
    v_mfma_f32_32x32x16_bf16 v[144:159], v[40:43], v[120:123], v[144:159]
    s_add_u32 m0, s47, 16384
    v_exp_f32 v104, v104
    v_cvt_pk_bf16_f32 v139, v102, v103
    v_exp_f32 v105, v105
    v_exp_f32 v106, v106
    v_cvt_pk_bf16_f32 v140, v104, v105
    v_exp_f32 v107, v107
    v_mfma_f32_32x32x16_bf16 v[144:159], v[44:47], v[124:127], v[144:159]
    buffer_load_dwordx4 v2, s[20:23], m0 offen sc1 lds
    v_exp_f32 v108, v108
    v_cvt_pk_bf16_f32 v141, v106, v107
    v_exp_f32 v109, v109
    v_exp_f32 v110, v110
    v_cvt_pk_bf16_f32 v142, v108, v109
    v_exp_f32 v111, v111
    v_exp_f32 v48, v48
    v_cvt_pk_bf16_f32 v143, v110, v111
    v_mfma_f32_32x32x4_2b_bf16 v[80:111], v[28:29], v[18:19], 0
    v_exp_f32 v49, v49
    v_exp_f32 v50, v50
    v_cvt_pk_bf16_f32 v112, v48, v49
    v_exp_f32 v51, v51
    v_exp_f32 v52, v52
    v_cvt_pk_bf16_f32 v113, v50, v51
    v_exp_f32 v53, v53
    v_exp_f32 v54, v54
    v_cvt_pk_bf16_f32 v114, v52, v53
    v_exp_f32 v55, v55
    v_mfma_f32_32x32x16_bf16 v[160:175], v[32:35], v[128:131], v[160:175]
    s_add_u32 m0, s47, 20480
    ds_read_b32 v28, v179 offset:9728
    ds_read_b128 v[32:35], v182 offset:4864
    v_exp_f32 v56, v56
    v_cvt_pk_bf16_f32 v115, v54, v55
    v_exp_f32 v57, v57
    v_exp_f32 v58, v58
    v_cvt_pk_bf16_f32 v116, v56, v57
    v_exp_f32 v59, v59
    v_mfma_f32_32x32x16_bf16 v[160:175], v[36:39], v[132:135], v[160:175]
    ds_read_b128 v[36:39], v182 offset:5504
    buffer_load_dwordx4 v2, s[20:23], m0 offen sc1 lds
    v_exp_f32 v60, v60
    v_cvt_pk_bf16_f32 v117, v58, v59
    v_exp_f32 v61, v61
    v_exp_f32 v62, v62
    v_cvt_pk_bf16_f32 v118, v60, v61
    v_exp_f32 v63, v63
    v_mfma_f32_32x32x16_bf16 v[80:95], v[20:23], v[12:15], v[80:95]
    s_add_u32 m0, s47, 24576
    ds_read_b128 v[20:23], v176 offset:9728
    v_exp_f32 v64, v64
    v_cvt_pk_bf16_f32 v119, v62, v63
    v_exp_f32 v65, v65
    v_exp_f32 v66, v66
    v_cvt_pk_bf16_f32 v120, v64, v65
    v_exp_f32 v67, v67
    v_mfma_f32_32x32x16_bf16 v[96:111], v[24:27], v[12:15], v[96:111]
    ds_read_b128 v[24:27], v176 offset:10752
    buffer_load_dwordx4 v2, s[20:23], m0 offen sc1 lds
    v_exp_f32 v68, v68
    v_cvt_pk_bf16_f32 v121, v66, v67
    v_exp_f32 v69, v69
    v_exp_f32 v70, v70
    v_cvt_pk_bf16_f32 v122, v68, v69
    v_exp_f32 v71, v71
    v_mfma_f32_32x32x16_bf16 v[160:175], v[40:43], v[136:139], v[160:175]
    s_add_u32 m0, s47, 28672
    ds_read_b128 v[40:43], v182 offset:6144
    v_exp_f32 v72, v72
    v_cvt_pk_bf16_f32 v123, v70, v71
    v_exp_f32 v73, v73
    v_exp_f32 v74, v74
    v_cvt_pk_bf16_f32 v124, v72, v73
    v_exp_f32 v75, v75
    v_mfma_f32_32x32x16_bf16 v[160:175], v[44:47], v[140:143], v[160:175]
    s_waitcnt lgkmcnt(3)
    ds_read_b128 v[44:47], v182 offset:6784
    v_exp_f32 v76, v76
    v_cvt_pk_bf16_f32 v125, v74, v75
    v_exp_f32 v77, v77
    v_exp_f32 v78, v78
    v_cvt_pk_bf16_f32 v126, v76, v77
    v_exp_f32 v79, v79
    v_exp_f32 v80, v80
    v_cvt_pk_bf16_f32 v127, v78, v79
    v_mfma_f32_32x32x4_2b_bf16 v[48:79], v[28:29], v[16:17], 0
    v_exp_f32 v81, v81
    v_exp_f32 v82, v82
    v_cvt_pk_bf16_f32 v128, v80, v81
    v_exp_f32 v83, v83
    v_exp_f32 v84, v84
    v_cvt_pk_bf16_f32 v129, v82, v83
    v_exp_f32 v85, v85
    v_exp_f32 v86, v86
    v_cvt_pk_bf16_f32 v130, v84, v85
    v_exp_f32 v87, v87
    v_mfma_f32_32x32x16_bf16 v[144:159], v[32:35], v[112:115], v[144:159]
    buffer_load_dwordx4 v2, s[20:23], m0 offen sc1 lds
    v_exp_f32 v88, v88
    v_cvt_pk_bf16_f32 v131, v86, v87
    v_exp_f32 v89, v89
    v_exp_f32 v90, v90
    v_cvt_pk_bf16_f32 v132, v88, v89
    v_exp_f32 v91, v91
    v_mfma_f32_32x32x16_bf16 v[144:159], v[36:39], v[116:119], v[144:159]
    s_waitcnt lgkmcnt(0)
    v_exp_f32 v92, v92
    v_cvt_pk_bf16_f32 v133, v90, v91
    v_exp_f32 v93, v93
    v_exp_f32 v94, v94
    v_cvt_pk_bf16_f32 v134, v92, v93
    v_exp_f32 v95, v95
    v_mfma_f32_32x32x16_bf16 v[48:63], v[20:23], v[8:11], v[48:63]
    s_add_u32 m0, s47, 32768
    v_exp_f32 v96, v96
    v_cvt_pk_bf16_f32 v135, v94, v95
    v_exp_f32 v97, v97
    v_exp_f32 v98, v98
    v_cvt_pk_bf16_f32 v136, v96, v97
    v_exp_f32 v99, v99
    v_mfma_f32_32x32x16_bf16 v[64:79], v[24:27], v[8:11], v[64:79]
    buffer_load_dwordx4 v2, s[20:23], m0 offen sc1 lds
    v_exp_f32 v100, v100
    v_cvt_pk_bf16_f32 v137, v98, v99
    v_exp_f32 v101, v101
    v_exp_f32 v102, v102
    v_cvt_pk_bf16_f32 v138, v100, v101
    v_exp_f32 v103, v103
    v_mfma_f32_32x32x16_bf16 v[144:159], v[40:43], v[120:123], v[144:159]
    s_add_u32 m0, s47, 36864
    v_exp_f32 v104, v104
    v_cvt_pk_bf16_f32 v139, v102, v103
    v_exp_f32 v105, v105
    v_exp_f32 v106, v106
    v_cvt_pk_bf16_f32 v140, v104, v105
    v_exp_f32 v107, v107
    v_mfma_f32_32x32x16_bf16 v[144:159], v[44:47], v[124:127], v[144:159]
    buffer_load_dwordx4 v2, s[20:23], m0 offen sc1 lds
    v_exp_f32 v108, v108
    v_cvt_pk_bf16_f32 v141, v106, v107
    v_exp_f32 v109, v109
    v_exp_f32 v110, v110
    v_cvt_pk_bf16_f32 v142, v108, v109
    v_exp_f32 v111, v111
    v_exp_f32 v48, v48
    v_cvt_pk_bf16_f32 v143, v110, v111
    v_mfma_f32_32x32x4_2b_bf16 v[80:111], v[28:29], v[18:19], 0
    v_exp_f32 v49, v49
    v_exp_f32 v50, v50
    v_cvt_pk_bf16_f32 v112, v48, v49
    v_exp_f32 v51, v51
    v_exp_f32 v52, v52
    v_cvt_pk_bf16_f32 v113, v50, v51
    v_exp_f32 v53, v53
    v_exp_f32 v54, v54
    v_cvt_pk_bf16_f32 v114, v52, v53
    v_exp_f32 v55, v55
    v_mfma_f32_32x32x16_bf16 v[160:175], v[32:35], v[128:131], v[160:175]
    s_add_u32 m0, s47, 40960
    ds_read_b32 v28, v179 offset:14592
    ds_read_b128 v[32:35], v182 offset:9728
    v_exp_f32 v56, v56
    v_cvt_pk_bf16_f32 v115, v54, v55
    v_exp_f32 v57, v57
    v_exp_f32 v58, v58
    v_cvt_pk_bf16_f32 v116, v56, v57
    v_exp_f32 v59, v59
    v_mfma_f32_32x32x16_bf16 v[160:175], v[36:39], v[132:135], v[160:175]
    ds_read_b128 v[36:39], v182 offset:10368
    buffer_load_dwordx4 v2, s[20:23], m0 offen sc1 lds
    v_exp_f32 v60, v60
    v_cvt_pk_bf16_f32 v117, v58, v59
    v_exp_f32 v61, v61
    v_exp_f32 v62, v62
    v_cvt_pk_bf16_f32 v118, v60, v61
    v_exp_f32 v63, v63
    v_mfma_f32_32x32x16_bf16 v[80:95], v[20:23], v[12:15], v[80:95]
    s_add_u32 m0, s47, 45056
    ds_read_b128 v[20:23], v176 offset:14592
    v_exp_f32 v64, v64
    v_cvt_pk_bf16_f32 v119, v62, v63
    v_exp_f32 v65, v65
    v_exp_f32 v66, v66
    v_cvt_pk_bf16_f32 v120, v64, v65
    v_exp_f32 v67, v67
    v_mfma_f32_32x32x16_bf16 v[96:111], v[24:27], v[12:15], v[96:111]
    ds_read_b128 v[24:27], v176 offset:15616
    buffer_load_dwordx4 v2, s[20:23], m0 offen sc1 lds
    v_exp_f32 v68, v68
    v_cvt_pk_bf16_f32 v121, v66, v67
    v_exp_f32 v69, v69
    v_exp_f32 v70, v70
    v_cvt_pk_bf16_f32 v122, v68, v69
    v_exp_f32 v71, v71
    v_mfma_f32_32x32x16_bf16 v[160:175], v[40:43], v[136:139], v[160:175]
    s_add_u32 m0, s47, 49152
    ds_read_b128 v[40:43], v182 offset:11008
    v_exp_f32 v72, v72
    v_cvt_pk_bf16_f32 v123, v70, v71
    v_exp_f32 v73, v73
    v_exp_f32 v74, v74
    v_cvt_pk_bf16_f32 v124, v72, v73
    v_exp_f32 v75, v75
    v_mfma_f32_32x32x16_bf16 v[160:175], v[44:47], v[140:143], v[160:175]
    s_waitcnt lgkmcnt(3)
    ds_read_b128 v[44:47], v182 offset:11648
    v_exp_f32 v76, v76
    v_cvt_pk_bf16_f32 v125, v74, v75
    v_exp_f32 v77, v77
    v_exp_f32 v78, v78
    v_cvt_pk_bf16_f32 v126, v76, v77
    v_exp_f32 v79, v79
    v_exp_f32 v80, v80
    v_cvt_pk_bf16_f32 v127, v78, v79
    v_mfma_f32_32x32x4_2b_bf16 v[48:79], v[28:29], v[16:17], 0
    v_exp_f32 v81, v81
    v_exp_f32 v82, v82
    v_cvt_pk_bf16_f32 v128, v80, v81
    v_exp_f32 v83, v83
    v_exp_f32 v84, v84
    v_cvt_pk_bf16_f32 v129, v82, v83
    v_exp_f32 v85, v85
    v_exp_f32 v86, v86
    v_cvt_pk_bf16_f32 v130, v84, v85
    v_exp_f32 v87, v87
    v_mfma_f32_32x32x16_bf16 v[144:159], v[32:35], v[112:115], v[144:159]
    buffer_load_dwordx4 v2, s[20:23], m0 offen sc1 lds
    v_exp_f32 v88, v88
    v_cvt_pk_bf16_f32 v131, v86, v87
    v_exp_f32 v89, v89
    v_exp_f32 v90, v90
    v_cvt_pk_bf16_f32 v132, v88, v89
    v_exp_f32 v91, v91
    v_mfma_f32_32x32x16_bf16 v[144:159], v[36:39], v[116:119], v[144:159]
    s_waitcnt lgkmcnt(0)
    v_exp_f32 v92, v92
    v_cvt_pk_bf16_f32 v133, v90, v91
    v_exp_f32 v93, v93
    v_exp_f32 v94, v94
    v_cvt_pk_bf16_f32 v134, v92, v93
    v_exp_f32 v95, v95
    v_mfma_f32_32x32x16_bf16 v[48:63], v[20:23], v[8:11], v[48:63]
    s_add_u32 m0, s47, 53248
    v_exp_f32 v96, v96
    v_cvt_pk_bf16_f32 v135, v94, v95
    v_exp_f32 v97, v97
    v_exp_f32 v98, v98
    v_cvt_pk_bf16_f32 v136, v96, v97
    v_exp_f32 v99, v99
    v_mfma_f32_32x32x16_bf16 v[64:79], v[24:27], v[8:11], v[64:79]
    buffer_load_dwordx4 v2, s[20:23], m0 offen sc1 lds
    v_exp_f32 v100, v100
    v_cvt_pk_bf16_f32 v137, v98, v99
    v_exp_f32 v101, v101
    v_exp_f32 v102, v102
    v_cvt_pk_bf16_f32 v138, v100, v101
    v_exp_f32 v103, v103
    v_mfma_f32_32x32x16_bf16 v[144:159], v[40:43], v[120:123], v[144:159]
    s_add_u32 m0, s47, 57344
    v_exp_f32 v104, v104
    v_cvt_pk_bf16_f32 v139, v102, v103
    v_exp_f32 v105, v105
    v_exp_f32 v106, v106
    v_cvt_pk_bf16_f32 v140, v104, v105
    v_exp_f32 v107, v107
    v_mfma_f32_32x32x16_bf16 v[144:159], v[44:47], v[124:127], v[144:159]
    buffer_load_dwordx4 v2, s[20:23], m0 offen sc1 lds
    v_exp_f32 v108, v108
    v_cvt_pk_bf16_f32 v141, v106, v107
    v_exp_f32 v109, v109
    v_exp_f32 v110, v110
    v_cvt_pk_bf16_f32 v142, v108, v109
    v_exp_f32 v111, v111
    v_exp_f32 v48, v48
    v_cvt_pk_bf16_f32 v143, v110, v111
    v_mfma_f32_32x32x4_2b_bf16 v[80:111], v[28:29], v[18:19], 0
    v_exp_f32 v49, v49
    v_exp_f32 v50, v50
    v_cvt_pk_bf16_f32 v112, v48, v49
    v_exp_f32 v51, v51
    v_exp_f32 v52, v52
    v_cvt_pk_bf16_f32 v113, v50, v51
    v_exp_f32 v53, v53
    v_exp_f32 v54, v54
    v_cvt_pk_bf16_f32 v114, v52, v53
    v_exp_f32 v55, v55
    v_mfma_f32_32x32x16_bf16 v[160:175], v[32:35], v[128:131], v[160:175]
    s_add_u32 s47, s47, 61440
    ds_read_b32 v28, v179 offset:19456
    ds_read_b128 v[32:35], v182 offset:14592
    v_exp_f32 v56, v56
    v_cvt_pk_bf16_f32 v115, v54, v55
    v_exp_f32 v57, v57
    v_exp_f32 v58, v58
    v_cvt_pk_bf16_f32 v116, v56, v57
    v_exp_f32 v59, v59
    v_mfma_f32_32x32x16_bf16 v[160:175], v[36:39], v[132:135], v[160:175]
    ds_read_b128 v[36:39], v182 offset:15232
    v_exp_f32 v60, v60
    v_cvt_pk_bf16_f32 v117, v58, v59
    v_exp_f32 v61, v61
    v_exp_f32 v62, v62
    v_cvt_pk_bf16_f32 v118, v60, v61
    v_exp_f32 v63, v63
    v_mfma_f32_32x32x16_bf16 v[80:95], v[20:23], v[12:15], v[80:95]
    ds_read_b128 v[20:23], v176 offset:19456
    v_exp_f32 v64, v64
    v_cvt_pk_bf16_f32 v119, v62, v63
    v_exp_f32 v65, v65
    v_exp_f32 v66, v66
    v_cvt_pk_bf16_f32 v120, v64, v65
    v_exp_f32 v67, v67
    v_mfma_f32_32x32x16_bf16 v[96:111], v[24:27], v[12:15], v[96:111]
    ds_read_b128 v[24:27], v176 offset:20480
    v_exp_f32 v68, v68
    v_cvt_pk_bf16_f32 v121, v66, v67
    v_exp_f32 v69, v69
    v_exp_f32 v70, v70
    v_cvt_pk_bf16_f32 v122, v68, v69
    v_exp_f32 v71, v71
    v_mfma_f32_32x32x16_bf16 v[160:175], v[40:43], v[136:139], v[160:175]
    ds_read_b128 v[40:43], v182 offset:15872
    v_exp_f32 v72, v72
    v_cvt_pk_bf16_f32 v123, v70, v71
    v_exp_f32 v73, v73
    v_exp_f32 v74, v74
    v_cvt_pk_bf16_f32 v124, v72, v73
    v_exp_f32 v75, v75
    v_mfma_f32_32x32x16_bf16 v[160:175], v[44:47], v[140:143], v[160:175]
    s_waitcnt lgkmcnt(3)
    ds_read_b128 v[44:47], v182 offset:16512
    v_exp_f32 v76, v76
    v_cvt_pk_bf16_f32 v125, v74, v75
    v_exp_f32 v77, v77
    v_exp_f32 v78, v78
    v_cvt_pk_bf16_f32 v126, v76, v77
    v_exp_f32 v79, v79
    v_exp_f32 v80, v80
    v_cvt_pk_bf16_f32 v127, v78, v79
    v_mfma_f32_32x32x4_2b_bf16 v[48:79], v[28:29], v[16:17], 0
    v_add_u32 v176, 19456, v176
    v_add_u32 v179, 19456, v179
    v_add_u32 v182, 19456, v182
    v_exp_f32 v81, v81
    v_exp_f32 v82, v82
    v_cvt_pk_bf16_f32 v128, v80, v81
    v_exp_f32 v83, v83
    v_exp_f32 v84, v84
    v_cvt_pk_bf16_f32 v129, v82, v83
    v_exp_f32 v85, v85
    v_exp_f32 v86, v86
    v_cvt_pk_bf16_f32 v130, v84, v85
    v_exp_f32 v87, v87
    v_mfma_f32_32x32x16_bf16 v[144:159], v[32:35], v[112:115], v[144:159]
    v_exp_f32 v88, v88
    v_cvt_pk_bf16_f32 v131, v86, v87
    v_exp_f32 v89, v89
    v_exp_f32 v90, v90
    v_cvt_pk_bf16_f32 v132, v88, v89
    v_exp_f32 v91, v91
    v_mfma_f32_32x32x16_bf16 v[144:159], v[36:39], v[116:119], v[144:159]
    s_waitcnt lgkmcnt(0)
    v_exp_f32 v92, v92
    v_cvt_pk_bf16_f32 v133, v90, v91
    v_exp_f32 v93, v93
    v_exp_f32 v94, v94
    v_cvt_pk_bf16_f32 v134, v92, v93
    v_exp_f32 v95, v95
    v_mfma_f32_32x32x16_bf16 v[48:63], v[20:23], v[8:11], v[48:63]
    v_exp_f32 v96, v96
    v_cvt_pk_bf16_f32 v135, v94, v95
    v_exp_f32 v97, v97
    v_exp_f32 v98, v98
    v_cvt_pk_bf16_f32 v136, v96, v97
    v_exp_f32 v99, v99
    v_mfma_f32_32x32x16_bf16 v[64:79], v[24:27], v[8:11], v[64:79]
    s_sub_u32 s46, s46, 1
    v_exp_f32 v100, v100
    v_cvt_pk_bf16_f32 v137, v98, v99
    v_exp_f32 v101, v101
    v_exp_f32 v102, v102
    v_cvt_pk_bf16_f32 v138, v100, v101
    v_exp_f32 v103, v103
    v_mfma_f32_32x32x16_bf16 v[144:159], v[40:43], v[120:123], v[144:159]
    s_waitcnt vmcnt(0)
    v_exp_f32 v104, v104
    v_cvt_pk_bf16_f32 v139, v102, v103
    v_exp_f32 v105, v105
    v_exp_f32 v106, v106
    v_cvt_pk_bf16_f32 v140, v104, v105
    v_exp_f32 v107, v107
    v_mfma_f32_32x32x16_bf16 v[144:159], v[44:47], v[124:127], v[144:159]
    s_cmp_lg_u32 s46, 0
    v_exp_f32 v108, v108
    v_cvt_pk_bf16_f32 v141, v106, v107
    v_exp_f32 v109, v109
    v_exp_f32 v110, v110
    v_cvt_pk_bf16_f32 v142, v108, v109
    v_exp_f32 v111, v111
    s_barrier
    s_cbranch_scc1 M_LA
    s_mov_b32 s52, s36
    s_mov_b32 s54, s73
    s_lshr_b32 s53, s37, 4
    s_mul_i32 s53, s53, 4608
    s_add_u32 s73, s73, s53
    s_mov_b32 s46, 3
.p2align 5
M_LP:
    v_exp_f32 v48, v48
    v_cvt_pk_bf16_f32 v143, v110, v111
    v_mfma_f32_32x32x4_2b_bf16 v[80:111], v[28:29], v[18:19], 0
    v_exp_f32 v49, v49
    v_exp_f32 v50, v50
    v_cvt_pk_bf16_f32 v112, v48, v49
    v_exp_f32 v51, v51
    v_exp_f32 v52, v52
    v_cvt_pk_bf16_f32 v113, v50, v51
    v_exp_f32 v53, v53
    v_exp_f32 v54, v54
    v_cvt_pk_bf16_f32 v114, v52, v53
    v_exp_f32 v55, v55
    v_mfma_f32_32x32x16_bf16 v[160:175], v[32:35], v[128:131], v[160:175]
    s_min_u32 s53, s52, 17
    ds_read_b32 v28, v179 offset:4864
    ds_read_b128 v[32:35], v182 offset:0
    v_exp_f32 v56, v56
    v_cvt_pk_bf16_f32 v115, v54, v55
    v_exp_f32 v57, v57
    v_exp_f32 v58, v58
    v_cvt_pk_bf16_f32 v116, v56, v57
    v_exp_f32 v59, v59
    v_mfma_f32_32x32x16_bf16 v[160:175], v[36:39], v[132:135], v[160:175]
    s_mul_i32 s54, s53, 9216
    ds_read_b128 v[36:39], v182 offset:640
    v_exp_f32 v60, v60
    v_cvt_pk_bf16_f32 v117, v58, v59
    v_exp_f32 v61, v61
    v_exp_f32 v62, v62
    v_cvt_pk_bf16_f32 v118, v60, v61
    v_exp_f32 v63, v63
    v_mfma_f32_32x32x16_bf16 v[80:95], v[20:23], v[12:15], v[80:95]
    s_add_u32 s54, s54, s71
    ds_read_b128 v[20:23], v176 offset:4864
    v_exp_f32 v64, v64
    v_cvt_pk_bf16_f32 v119, v62, v63
    v_exp_f32 v65, v65
    v_exp_f32 v66, v66
    v_cvt_pk_bf16_f32 v120, v64, v65
    v_exp_f32 v67, v67
    v_mfma_f32_32x32x16_bf16 v[96:111], v[24:27], v[12:15], v[96:111]
    ds_read_b128 v[24:27], v176 offset:5888
    buffer_load_dword v202, v205, s[12:15], s54 offen
    v_exp_f32 v68, v68
    v_cvt_pk_bf16_f32 v121, v66, v67
    v_exp_f32 v69, v69
    v_exp_f32 v70, v70
    v_cvt_pk_bf16_f32 v122, v68, v69
    v_exp_f32 v71, v71
    v_mfma_f32_32x32x16_bf16 v[160:175], v[40:43], v[136:139], v[160:175]
    s_min_u32 s53, s52, 8
    ds_read_b128 v[40:43], v182 offset:1280
    v_exp_f32 v72, v72
    v_cvt_pk_bf16_f32 v123, v70, v71
    v_exp_f32 v73, v73
    v_exp_f32 v74, v74
    v_cvt_pk_bf16_f32 v124, v72, v73
    v_exp_f32 v75, v75
    v_mfma_f32_32x32x16_bf16 v[160:175], v[44:47], v[140:143], v[160:175]
    s_waitcnt lgkmcnt(3)
    ds_read_b128 v[44:47], v182 offset:1920
    v_exp_f32 v76, v76
    v_cvt_pk_bf16_f32 v125, v74, v75
    v_exp_f32 v77, v77
    v_exp_f32 v78, v78
    v_cvt_pk_bf16_f32 v126, v76, v77
    v_exp_f32 v79, v79
    v_exp_f32 v80, v80
    v_cvt_pk_bf16_f32 v127, v78, v79
    v_mfma_f32_32x32x4_2b_bf16 v[48:79], v[28:29], v[16:17], 0
    v_exp_f32 v81, v81
    v_exp_f32 v82, v82
    v_cvt_pk_bf16_f32 v128, v80, v81
    v_exp_f32 v83, v83
    v_exp_f32 v84, v84
    v_cvt_pk_bf16_f32 v129, v82, v83
    v_exp_f32 v85, v85
    v_exp_f32 v86, v86
    v_cvt_pk_bf16_f32 v130, v84, v85
    v_exp_f32 v87, v87
    v_mfma_f32_32x32x16_bf16 v[144:159], v[32:35], v[112:115], v[144:159]
    s_mul_i32 s54, s53, 9216
    v_exp_f32 v88, v88
    v_cvt_pk_bf16_f32 v131, v86, v87
    v_exp_f32 v89, v89
    v_exp_f32 v90, v90
    v_cvt_pk_bf16_f32 v132, v88, v89
    v_exp_f32 v91, v91
    v_mfma_f32_32x32x16_bf16 v[144:159], v[36:39], v[116:119], v[144:159]
    s_waitcnt lgkmcnt(0)
    v_exp_f32 v92, v92
    v_cvt_pk_bf16_f32 v133, v90, v91
    v_exp_f32 v93, v93
    v_exp_f32 v94, v94
    v_cvt_pk_bf16_f32 v134, v92, v93
    v_exp_f32 v95, v95
    v_mfma_f32_32x32x16_bf16 v[48:63], v[20:23], v[8:11], v[48:63]
    s_add_u32 s54, s54, s73
    v_exp_f32 v96, v96
    v_cvt_pk_bf16_f32 v135, v94, v95
    v_exp_f32 v97, v97
    v_exp_f32 v98, v98
    v_cvt_pk_bf16_f32 v136, v96, v97
    v_exp_f32 v99, v99
    v_mfma_f32_32x32x16_bf16 v[64:79], v[24:27], v[8:11], v[64:79]
    s_add_u32 s52, s52, 4
    v_exp_f32 v100, v100
    v_cvt_pk_bf16_f32 v137, v98, v99
    v_exp_f32 v101, v101
    v_exp_f32 v102, v102
    v_cvt_pk_bf16_f32 v138, v100, v101
    v_exp_f32 v103, v103
    v_mfma_f32_32x32x16_bf16 v[144:159], v[40:43], v[120:123], v[144:159]
    buffer_load_dword v202, v205, s[16:19], s54 offen
    v_exp_f32 v104, v104
    v_cvt_pk_bf16_f32 v139, v102, v103
    v_exp_f32 v105, v105
    v_exp_f32 v106, v106
    v_cvt_pk_bf16_f32 v140, v104, v105
    v_exp_f32 v107, v107
    v_mfma_f32_32x32x16_bf16 v[144:159], v[44:47], v[124:127], v[144:159]
    v_exp_f32 v108, v108
    v_cvt_pk_bf16_f32 v141, v106, v107
    v_exp_f32 v109, v109
    v_exp_f32 v110, v110
    v_cvt_pk_bf16_f32 v142, v108, v109
    v_exp_f32 v111, v111
    v_exp_f32 v48, v48
    v_cvt_pk_bf16_f32 v143, v110, v111
    v_mfma_f32_32x32x4_2b_bf16 v[80:111], v[28:29], v[18:19], 0
    v_exp_f32 v49, v49
    v_exp_f32 v50, v50
    v_cvt_pk_bf16_f32 v112, v48, v49
    v_exp_f32 v51, v51
    v_exp_f32 v52, v52
    v_cvt_pk_bf16_f32 v113, v50, v51
    v_exp_f32 v53, v53
    v_exp_f32 v54, v54
    v_cvt_pk_bf16_f32 v114, v52, v53
    v_exp_f32 v55, v55
    v_mfma_f32_32x32x16_bf16 v[160:175], v[32:35], v[128:131], v[160:175]
    ds_read_b32 v28, v179 offset:9728
    ds_read_b128 v[32:35], v182 offset:4864
    v_exp_f32 v56, v56
    v_cvt_pk_bf16_f32 v115, v54, v55
    v_exp_f32 v57, v57
    v_exp_f32 v58, v58
    v_cvt_pk_bf16_f32 v116, v56, v57
    v_exp_f32 v59, v59
    v_mfma_f32_32x32x16_bf16 v[160:175], v[36:39], v[132:135], v[160:175]
    ds_read_b128 v[36:39], v182 offset:5504
    v_exp_f32 v60, v60
    v_cvt_pk_bf16_f32 v117, v58, v59
    v_exp_f32 v61, v61
    v_exp_f32 v62, v62
    v_cvt_pk_bf16_f32 v118, v60, v61
    v_exp_f32 v63, v63
    v_mfma_f32_32x32x16_bf16 v[80:95], v[20:23], v[12:15], v[80:95]
    ds_read_b128 v[20:23], v176 offset:9728
    v_exp_f32 v64, v64
    v_cvt_pk_bf16_f32 v119, v62, v63
    v_exp_f32 v65, v65
    v_exp_f32 v66, v66
    v_cvt_pk_bf16_f32 v120, v64, v65
    v_exp_f32 v67, v67
    v_mfma_f32_32x32x16_bf16 v[96:111], v[24:27], v[12:15], v[96:111]
    ds_read_b128 v[24:27], v176 offset:10752
    buffer_load_dword v202, v206, s[20:23], s58 offen
    v_exp_f32 v68, v68
    v_cvt_pk_bf16_f32 v121, v66, v67
    v_exp_f32 v69, v69
    v_exp_f32 v70, v70
    v_cvt_pk_bf16_f32 v122, v68, v69
    v_exp_f32 v71, v71
    v_mfma_f32_32x32x16_bf16 v[160:175], v[40:43], v[136:139], v[160:175]
    ds_read_b128 v[40:43], v182 offset:6144
    v_exp_f32 v72, v72
    v_cvt_pk_bf16_f32 v123, v70, v71
    v_exp_f32 v73, v73
    v_exp_f32 v74, v74
    v_cvt_pk_bf16_f32 v124, v72, v73
    v_exp_f32 v75, v75
    v_mfma_f32_32x32x16_bf16 v[160:175], v[44:47], v[140:143], v[160:175]
    s_waitcnt lgkmcnt(3)
    ds_read_b128 v[44:47], v182 offset:6784
    v_exp_f32 v76, v76
    v_cvt_pk_bf16_f32 v125, v74, v75
    v_exp_f32 v77, v77
    v_exp_f32 v78, v78
    v_cvt_pk_bf16_f32 v126, v76, v77
    v_exp_f32 v79, v79
    v_exp_f32 v80, v80
    v_cvt_pk_bf16_f32 v127, v78, v79
    v_mfma_f32_32x32x4_2b_bf16 v[48:79], v[28:29], v[16:17], 0
    v_exp_f32 v81, v81
    v_exp_f32 v82, v82
    v_cvt_pk_bf16_f32 v128, v80, v81
    v_exp_f32 v83, v83
    v_exp_f32 v84, v84
    v_cvt_pk_bf16_f32 v129, v82, v83
    v_exp_f32 v85, v85
    v_exp_f32 v86, v86
    v_cvt_pk_bf16_f32 v130, v84, v85
    v_exp_f32 v87, v87
    v_mfma_f32_32x32x16_bf16 v[144:159], v[32:35], v[112:115], v[144:159]
    v_exp_f32 v88, v88
    v_cvt_pk_bf16_f32 v131, v86, v87
    v_exp_f32 v89, v89
    v_exp_f32 v90, v90
    v_cvt_pk_bf16_f32 v132, v88, v89
    v_exp_f32 v91, v91
    v_mfma_f32_32x32x16_bf16 v[144:159], v[36:39], v[116:119], v[144:159]
    s_waitcnt lgkmcnt(0)
    v_exp_f32 v92, v92
    v_cvt_pk_bf16_f32 v133, v90, v91
    v_exp_f32 v93, v93
    v_exp_f32 v94, v94
    v_cvt_pk_bf16_f32 v134, v92, v93
    v_exp_f32 v95, v95
    v_mfma_f32_32x32x16_bf16 v[48:63], v[20:23], v[8:11], v[48:63]
    v_exp_f32 v96, v96
    v_cvt_pk_bf16_f32 v135, v94, v95
    v_exp_f32 v97, v97
    v_exp_f32 v98, v98
    v_cvt_pk_bf16_f32 v136, v96, v97
    v_exp_f32 v99, v99
    v_mfma_f32_32x32x16_bf16 v[64:79], v[24:27], v[8:11], v[64:79]
    v_exp_f32 v100, v100
    v_cvt_pk_bf16_f32 v137, v98, v99
    v_exp_f32 v101, v101
    v_exp_f32 v102, v102
    v_cvt_pk_bf16_f32 v138, v100, v101
    v_exp_f32 v103, v103
    v_mfma_f32_32x32x16_bf16 v[144:159], v[40:43], v[120:123], v[144:159]
    buffer_load_dword v202, v207, s[20:23], s59 offen
    v_exp_f32 v104, v104
    v_cvt_pk_bf16_f32 v139, v102, v103
    v_exp_f32 v105, v105
    v_exp_f32 v106, v106
    v_cvt_pk_bf16_f32 v140, v104, v105
    v_exp_f32 v107, v107
    v_mfma_f32_32x32x16_bf16 v[144:159], v[44:47], v[124:127], v[144:159]
    v_exp_f32 v108, v108
    v_cvt_pk_bf16_f32 v141, v106, v107
    v_exp_f32 v109, v109
    v_exp_f32 v110, v110
    v_cvt_pk_bf16_f32 v142, v108, v109
    v_exp_f32 v111, v111
    v_exp_f32 v48, v48
    v_cvt_pk_bf16_f32 v143, v110, v111
    v_mfma_f32_32x32x4_2b_bf16 v[80:111], v[28:29], v[18:19], 0
    v_exp_f32 v49, v49
    v_exp_f32 v50, v50
    v_cvt_pk_bf16_f32 v112, v48, v49
    v_exp_f32 v51, v51
    v_exp_f32 v52, v52
    v_cvt_pk_bf16_f32 v113, v50, v51
    v_exp_f32 v53, v53
    v_exp_f32 v54, v54
    v_cvt_pk_bf16_f32 v114, v52, v53
    v_exp_f32 v55, v55
    v_mfma_f32_32x32x16_bf16 v[160:175], v[32:35], v[128:131], v[160:175]
    ds_read_b32 v28, v179 offset:14592
    ds_read_b128 v[32:35], v182 offset:9728
    v_exp_f32 v56, v56
    v_cvt_pk_bf16_f32 v115, v54, v55
    v_exp_f32 v57, v57
    v_exp_f32 v58, v58
    v_cvt_pk_bf16_f32 v116, v56, v57
    v_exp_f32 v59, v59
    v_mfma_f32_32x32x16_bf16 v[160:175], v[36:39], v[132:135], v[160:175]
    ds_read_b128 v[36:39], v182 offset:10368
    v_exp_f32 v60, v60
    v_cvt_pk_bf16_f32 v117, v58, v59
    v_exp_f32 v61, v61
    v_exp_f32 v62, v62
    v_cvt_pk_bf16_f32 v118, v60, v61
    v_exp_f32 v63, v63
    v_mfma_f32_32x32x16_bf16 v[80:95], v[20:23], v[12:15], v[80:95]
    ds_read_b128 v[20:23], v176 offset:14592
    v_exp_f32 v64, v64
    v_cvt_pk_bf16_f32 v119, v62, v63
    v_exp_f32 v65, v65
    v_exp_f32 v66, v66
    v_cvt_pk_bf16_f32 v120, v64, v65
    v_exp_f32 v67, v67
    v_mfma_f32_32x32x16_bf16 v[96:111], v[24:27], v[12:15], v[96:111]
    ds_read_b128 v[24:27], v176 offset:15616
    buffer_load_dword v202, v208, s[20:23], s60 offen
    v_exp_f32 v68, v68
    v_cvt_pk_bf16_f32 v121, v66, v67
    v_exp_f32 v69, v69
    v_exp_f32 v70, v70
    v_cvt_pk_bf16_f32 v122, v68, v69
    v_exp_f32 v71, v71
    v_mfma_f32_32x32x16_bf16 v[160:175], v[40:43], v[136:139], v[160:175]
    ds_read_b128 v[40:43], v182 offset:11008
    v_exp_f32 v72, v72
    v_cvt_pk_bf16_f32 v123, v70, v71
    v_exp_f32 v73, v73
    v_exp_f32 v74, v74
    v_cvt_pk_bf16_f32 v124, v72, v73
    v_exp_f32 v75, v75
    v_mfma_f32_32x32x16_bf16 v[160:175], v[44:47], v[140:143], v[160:175]
    s_waitcnt lgkmcnt(3)
    ds_read_b128 v[44:47], v182 offset:11648
    v_exp_f32 v76, v76
    v_cvt_pk_bf16_f32 v125, v74, v75
    v_exp_f32 v77, v77
    v_exp_f32 v78, v78
    v_cvt_pk_bf16_f32 v126, v76, v77
    v_exp_f32 v79, v79
    v_exp_f32 v80, v80
    v_cvt_pk_bf16_f32 v127, v78, v79
    v_mfma_f32_32x32x4_2b_bf16 v[48:79], v[28:29], v[16:17], 0
    v_exp_f32 v81, v81
    v_exp_f32 v82, v82
    v_cvt_pk_bf16_f32 v128, v80, v81
    v_exp_f32 v83, v83
    v_exp_f32 v84, v84
    v_cvt_pk_bf16_f32 v129, v82, v83
    v_exp_f32 v85, v85
    v_exp_f32 v86, v86
    v_cvt_pk_bf16_f32 v130, v84, v85
    v_exp_f32 v87, v87
    v_mfma_f32_32x32x16_bf16 v[144:159], v[32:35], v[112:115], v[144:159]
    v_exp_f32 v88, v88
    v_cvt_pk_bf16_f32 v131, v86, v87
    v_exp_f32 v89, v89
    v_exp_f32 v90, v90
    v_cvt_pk_bf16_f32 v132, v88, v89
    v_exp_f32 v91, v91
    v_mfma_f32_32x32x16_bf16 v[144:159], v[36:39], v[116:119], v[144:159]
    s_waitcnt lgkmcnt(0)
    v_exp_f32 v92, v92
    v_cvt_pk_bf16_f32 v133, v90, v91
    v_exp_f32 v93, v93
    v_exp_f32 v94, v94
    v_cvt_pk_bf16_f32 v134, v92, v93
    v_exp_f32 v95, v95
    v_mfma_f32_32x32x16_bf16 v[48:63], v[20:23], v[8:11], v[48:63]
    v_exp_f32 v96, v96
    v_cvt_pk_bf16_f32 v135, v94, v95
    v_exp_f32 v97, v97
    v_exp_f32 v98, v98
    v_cvt_pk_bf16_f32 v136, v96, v97
    v_exp_f32 v99, v99
    v_mfma_f32_32x32x16_bf16 v[64:79], v[24:27], v[8:11], v[64:79]
    v_exp_f32 v100, v100
    v_cvt_pk_bf16_f32 v137, v98, v99
    v_exp_f32 v101, v101
    v_exp_f32 v102, v102
    v_cvt_pk_bf16_f32 v138, v100, v101
    v_exp_f32 v103, v103
    v_mfma_f32_32x32x16_bf16 v[144:159], v[40:43], v[120:123], v[144:159]
    buffer_load_dword v202, v209, s[20:23], s61 offen
    v_exp_f32 v104, v104
    v_cvt_pk_bf16_f32 v139, v102, v103
    v_exp_f32 v105, v105
    v_exp_f32 v106, v106
    v_cvt_pk_bf16_f32 v140, v104, v105
    v_exp_f32 v107, v107
    v_mfma_f32_32x32x16_bf16 v[144:159], v[44:47], v[124:127], v[144:159]
    v_exp_f32 v108, v108
    v_cvt_pk_bf16_f32 v141, v106, v107
    v_exp_f32 v109, v109
    v_exp_f32 v110, v110
    v_cvt_pk_bf16_f32 v142, v108, v109
    v_exp_f32 v111, v111
    v_exp_f32 v48, v48
    v_cvt_pk_bf16_f32 v143, v110, v111
    v_mfma_f32_32x32x4_2b_bf16 v[80:111], v[28:29], v[18:19], 0
    v_exp_f32 v49, v49
    v_exp_f32 v50, v50
    v_cvt_pk_bf16_f32 v112, v48, v49
    v_exp_f32 v51, v51
    v_exp_f32 v52, v52
    v_cvt_pk_bf16_f32 v113, v50, v51
    v_exp_f32 v53, v53
    v_exp_f32 v54, v54
    v_cvt_pk_bf16_f32 v114, v52, v53
    v_exp_f32 v55, v55
    v_mfma_f32_32x32x16_bf16 v[160:175], v[32:35], v[128:131], v[160:175]
    ds_read_b32 v28, v179 offset:19456
    ds_read_b128 v[32:35], v182 offset:14592
    v_exp_f32 v56, v56
    v_cvt_pk_bf16_f32 v115, v54, v55
    v_exp_f32 v57, v57
    v_exp_f32 v58, v58
    v_cvt_pk_bf16_f32 v116, v56, v57
    v_exp_f32 v59, v59
    v_mfma_f32_32x32x16_bf16 v[160:175], v[36:39], v[132:135], v[160:175]
    ds_read_b128 v[36:39], v182 offset:15232
    v_exp_f32 v60, v60
    v_cvt_pk_bf16_f32 v117, v58, v59
    v_exp_f32 v61, v61
    v_exp_f32 v62, v62
    v_cvt_pk_bf16_f32 v118, v60, v61
    v_exp_f32 v63, v63
    v_mfma_f32_32x32x16_bf16 v[80:95], v[20:23], v[12:15], v[80:95]
    ds_read_b128 v[20:23], v176 offset:19456
    v_exp_f32 v64, v64
    v_cvt_pk_bf16_f32 v119, v62, v63
    v_exp_f32 v65, v65
    v_exp_f32 v66, v66
    v_cvt_pk_bf16_f32 v120, v64, v65
    v_exp_f32 v67, v67
    v_mfma_f32_32x32x16_bf16 v[96:111], v[24:27], v[12:15], v[96:111]
    ds_read_b128 v[24:27], v176 offset:20480
    buffer_load_dword v202, v210, s[20:23], 0 offen
    v_exp_f32 v68, v68
    v_cvt_pk_bf16_f32 v121, v66, v67
    v_exp_f32 v69, v69
    v_exp_f32 v70, v70
    v_cvt_pk_bf16_f32 v122, v68, v69
    v_exp_f32 v71, v71
    v_mfma_f32_32x32x16_bf16 v[160:175], v[40:43], v[136:139], v[160:175]
    ds_read_b128 v[40:43], v182 offset:15872
    v_exp_f32 v72, v72
    v_cvt_pk_bf16_f32 v123, v70, v71
    v_exp_f32 v73, v73
    v_exp_f32 v74, v74
    v_cvt_pk_bf16_f32 v124, v72, v73
    v_exp_f32 v75, v75
    v_mfma_f32_32x32x16_bf16 v[160:175], v[44:47], v[140:143], v[160:175]
    s_waitcnt lgkmcnt(3)
    ds_read_b128 v[44:47], v182 offset:16512
    v_exp_f32 v76, v76
    v_cvt_pk_bf16_f32 v125, v74, v75
    v_exp_f32 v77, v77
    v_exp_f32 v78, v78
    v_cvt_pk_bf16_f32 v126, v76, v77
    v_exp_f32 v79, v79
    v_exp_f32 v80, v80
    v_cvt_pk_bf16_f32 v127, v78, v79
    v_mfma_f32_32x32x4_2b_bf16 v[48:79], v[28:29], v[16:17], 0
    v_add_u32 v176, 19456, v176
    v_add_u32 v179, 19456, v179
    v_add_u32 v182, 19456, v182
    v_exp_f32 v81, v81
    v_exp_f32 v82, v82
    v_cvt_pk_bf16_f32 v128, v80, v81
    v_exp_f32 v83, v83
    v_exp_f32 v84, v84
    v_cvt_pk_bf16_f32 v129, v82, v83
    v_exp_f32 v85, v85
    v_exp_f32 v86, v86
    v_cvt_pk_bf16_f32 v130, v84, v85
    v_exp_f32 v87, v87
    v_mfma_f32_32x32x16_bf16 v[144:159], v[32:35], v[112:115], v[144:159]
    v_exp_f32 v88, v88
    v_cvt_pk_bf16_f32 v131, v86, v87
    v_exp_f32 v89, v89
    v_exp_f32 v90, v90
    v_cvt_pk_bf16_f32 v132, v88, v89
    v_exp_f32 v91, v91
    v_mfma_f32_32x32x16_bf16 v[144:159], v[36:39], v[116:119], v[144:159]
    s_waitcnt lgkmcnt(0)
    v_exp_f32 v92, v92
    v_cvt_pk_bf16_f32 v133, v90, v91
    v_exp_f32 v93, v93
    v_exp_f32 v94, v94
    v_cvt_pk_bf16_f32 v134, v92, v93
    v_exp_f32 v95, v95
    v_mfma_f32_32x32x16_bf16 v[48:63], v[20:23], v[8:11], v[48:63]
    v_exp_f32 v96, v96
    v_cvt_pk_bf16_f32 v135, v94, v95
    v_exp_f32 v97, v97
    v_exp_f32 v98, v98
    v_cvt_pk_bf16_f32 v136, v96, v97
    v_exp_f32 v99, v99
    v_mfma_f32_32x32x16_bf16 v[64:79], v[24:27], v[8:11], v[64:79]
    s_sub_u32 s46, s46, 1
    v_exp_f32 v100, v100
    v_cvt_pk_bf16_f32 v137, v98, v99
    v_exp_f32 v101, v101
    v_exp_f32 v102, v102
    v_cvt_pk_bf16_f32 v138, v100, v101
    v_exp_f32 v103, v103
    v_mfma_f32_32x32x16_bf16 v[144:159], v[40:43], v[120:123], v[144:159]
    v_exp_f32 v104, v104
    v_cvt_pk_bf16_f32 v139, v102, v103
    v_exp_f32 v105, v105
    v_exp_f32 v106, v106
    v_cvt_pk_bf16_f32 v140, v104, v105
    v_exp_f32 v107, v107
    v_mfma_f32_32x32x16_bf16 v[144:159], v[44:47], v[124:127], v[144:159]
    s_cmp_lg_u32 s46, 0
    v_exp_f32 v108, v108
    v_cvt_pk_bf16_f32 v141, v106, v107
    v_exp_f32 v109, v109
    v_exp_f32 v110, v110
    v_cvt_pk_bf16_f32 v142, v108, v109
    v_exp_f32 v111, v111
    s_cbranch_scc1 M_LP
    s_barrier
    s_mov_b32 s47, s42
    s_mov_b32 s48, s64
    s_add_u32 s49, s64, 165888
    s_add_u32 s50, s66, 8192
    s_mov_b32 s51, s65
    v_mov_b32 v177, v185
    v_mov_b32 v178, v187
    v_mov_b32 v180, v189
    s_getpc_b64 s[56:57]
M_PC2:
    s_lshl_b32 s3, s38, 2
    s_add_u32 s3, s3, s36
    s_lshl_b32 s3, s3, 11
    v_and_b32 v227, 15, v1
    v_lshl_add_u32 v227, v227, 7, s3
    v_min_u32 v227, M_CODE_END-M_PC2-4, v227
    s_mov_b32 s46, 3
.p2align 5
M_LB:
    v_exp_f32 v48, v48
    v_cvt_pk_bf16_f32 v143, v110, v111
    v_mfma_f32_32x32x4_2b_bf16 v[80:111], v[28:29], v[18:19], 0
    v_exp_f32 v49, v49
    v_exp_f32 v50, v50
    v_cvt_pk_bf16_f32 v112, v48, v49
    v_exp_f32 v51, v51
    v_exp_f32 v52, v52
    v_cvt_pk_bf16_f32 v113, v50, v51
    v_exp_f32 v53, v53
    v_exp_f32 v54, v54
    v_cvt_pk_bf16_f32 v114, v52, v53
    v_exp_f32 v55, v55
    v_mfma_f32_32x32x16_bf16 v[160:175], v[32:35], v[128:131], v[160:175]
    s_min_u32 s53, s52, 17
    ds_read_b32 v28, v179 offset:4864
    ds_read_b128 v[32:35], v182 offset:0
    v_exp_f32 v56, v56
    v_cvt_pk_bf16_f32 v115, v54, v55
    v_exp_f32 v57, v57
    v_exp_f32 v58, v58
    v_cvt_pk_bf16_f32 v116, v56, v57
    v_exp_f32 v59, v59
    v_mfma_f32_32x32x16_bf16 v[160:175], v[36:39], v[132:135], v[160:175]
    s_mul_i32 s54, s53, 9216
    ds_read_b128 v[36:39], v182 offset:640
    v_exp_f32 v60, v60
    v_cvt_pk_bf16_f32 v117, v58, v59
    v_exp_f32 v61, v61
    v_exp_f32 v62, v62
    v_cvt_pk_bf16_f32 v118, v60, v61
    v_exp_f32 v63, v63
    v_mfma_f32_32x32x16_bf16 v[80:95], v[20:23], v[12:15], v[80:95]
    s_add_u32 s54, s54, s71
    ds_read_b128 v[20:23], v176 offset:4864
    v_exp_f32 v64, v64
    v_cvt_pk_bf16_f32 v119, v62, v63
    v_exp_f32 v65, v65
    v_exp_f32 v66, v66
    v_cvt_pk_bf16_f32 v120, v64, v65
    v_exp_f32 v67, v67
    v_mfma_f32_32x32x16_bf16 v[96:111], v[24:27], v[12:15], v[96:111]
    ds_read_b128 v[24:27], v176 offset:5888
    buffer_load_dword v202, v205, s[12:15], s54 offen
    v_exp_f32 v68, v68
    v_cvt_pk_bf16_f32 v121, v66, v67
    v_exp_f32 v69, v69
    v_exp_f32 v70, v70
    v_cvt_pk_bf16_f32 v122, v68, v69
    v_exp_f32 v71, v71
    v_mfma_f32_32x32x16_bf16 v[160:175], v[40:43], v[136:139], v[160:175]
    s_min_u32 s53, s52, 8
    ds_read_b128 v[40:43], v182 offset:1280
    v_exp_f32 v72, v72
    v_cvt_pk_bf16_f32 v123, v70, v71
    v_exp_f32 v73, v73
    v_exp_f32 v74, v74
    v_cvt_pk_bf16_f32 v124, v72, v73
    v_exp_f32 v75, v75
    v_mfma_f32_32x32x16_bf16 v[160:175], v[44:47], v[140:143], v[160:175]
    s_waitcnt lgkmcnt(3)
    ds_read_b128 v[44:47], v182 offset:1920
    v_exp_f32 v76, v76
    v_cvt_pk_bf16_f32 v125, v74, v75
    v_exp_f32 v77, v77
    v_exp_f32 v78, v78
    v_cvt_pk_bf16_f32 v126, v76, v77
    v_exp_f32 v79, v79
    v_exp_f32 v80, v80
    v_cvt_pk_bf16_f32 v127, v78, v79
    v_mfma_f32_32x32x4_2b_bf16 v[48:79], v[28:29], v[16:17], 0
    v_exp_f32 v81, v81
    v_exp_f32 v82, v82
    v_cvt_pk_bf16_f32 v128, v80, v81
    v_exp_f32 v83, v83
    v_exp_f32 v84, v84
    v_cvt_pk_bf16_f32 v129, v82, v83
    v_exp_f32 v85, v85
    v_exp_f32 v86, v86
    v_cvt_pk_bf16_f32 v130, v84, v85
    v_exp_f32 v87, v87
    v_mfma_f32_32x32x16_bf16 v[144:159], v[32:35], v[112:115], v[144:159]
    s_mul_i32 s54, s53, 9216
    v_exp_f32 v88, v88
    v_cvt_pk_bf16_f32 v131, v86, v87
    v_exp_f32 v89, v89
    v_exp_f32 v90, v90
    v_cvt_pk_bf16_f32 v132, v88, v89
    v_exp_f32 v91, v91
    v_mfma_f32_32x32x16_bf16 v[144:159], v[36:39], v[116:119], v[144:159]
    s_waitcnt lgkmcnt(0)
    v_exp_f32 v92, v92
    v_cvt_pk_bf16_f32 v133, v90, v91
    v_exp_f32 v93, v93
    v_exp_f32 v94, v94
    v_cvt_pk_bf16_f32 v134, v92, v93
    v_exp_f32 v95, v95
    v_mfma_f32_32x32x16_bf16 v[48:63], v[20:23], v[8:11], v[48:63]
    s_add_u32 s54, s54, s73
    v_exp_f32 v96, v96
    v_cvt_pk_bf16_f32 v135, v94, v95
    v_exp_f32 v97, v97
    v_exp_f32 v98, v98
    v_cvt_pk_bf16_f32 v136, v96, v97
    v_exp_f32 v99, v99
    v_mfma_f32_32x32x16_bf16 v[64:79], v[24:27], v[8:11], v[64:79]
    s_add_u32 s52, s52, 4
    v_exp_f32 v100, v100
    v_cvt_pk_bf16_f32 v137, v98, v99
    v_exp_f32 v101, v101
    v_exp_f32 v102, v102
    v_cvt_pk_bf16_f32 v138, v100, v101
    v_exp_f32 v103, v103
    v_mfma_f32_32x32x16_bf16 v[144:159], v[40:43], v[120:123], v[144:159]
    buffer_load_dword v202, v205, s[16:19], s54 offen
    v_exp_f32 v104, v104
    v_cvt_pk_bf16_f32 v139, v102, v103
    v_exp_f32 v105, v105
    v_exp_f32 v106, v106
    v_cvt_pk_bf16_f32 v140, v104, v105
    v_exp_f32 v107, v107
    v_mfma_f32_32x32x16_bf16 v[144:159], v[44:47], v[124:127], v[144:159]
    s_add_u32 m0, s47, 0
    v_exp_f32 v108, v108
    v_cvt_pk_bf16_f32 v141, v106, v107
    v_exp_f32 v109, v109
    v_exp_f32 v110, v110
    v_cvt_pk_bf16_f32 v142, v108, v109
    v_exp_f32 v111, v111
    v_exp_f32 v48, v48
    v_cvt_pk_bf16_f32 v143, v110, v111
    v_mfma_f32_32x32x4_2b_bf16 v[80:111], v[28:29], v[18:19], 0
    v_exp_f32 v49, v49
    v_exp_f32 v50, v50
    v_cvt_pk_bf16_f32 v112, v48, v49
    v_exp_f32 v51, v51
    v_exp_f32 v52, v52
    v_cvt_pk_bf16_f32 v113, v50, v51
    v_exp_f32 v53, v53
    v_exp_f32 v54, v54
    v_cvt_pk_bf16_f32 v114, v52, v53
    v_exp_f32 v55, v55
    v_mfma_f32_32x32x16_bf16 v[160:175], v[32:35], v[128:131], v[160:175]
    s_add_u32 s72, s48, 0
    ds_read_b32 v28, v179 offset:9728
    ds_read_b128 v[32:35], v182 offset:4864
    v_exp_f32 v56, v56
    v_cvt_pk_bf16_f32 v115, v54, v55
    v_exp_f32 v57, v57
    v_exp_f32 v58, v58
    v_cvt_pk_bf16_f32 v116, v56, v57
    v_exp_f32 v59, v59
    v_mfma_f32_32x32x16_bf16 v[160:175], v[36:39], v[132:135], v[160:175]
    ds_read_b128 v[36:39], v182 offset:5504
    buffer_load_dwordx4 v185, s[8:11], s72 offen lds
    v_exp_f32 v60, v60
    v_cvt_pk_bf16_f32 v117, v58, v59
    v_exp_f32 v61, v61
    v_exp_f32 v62, v62
    v_cvt_pk_bf16_f32 v118, v60, v61
    v_exp_f32 v63, v63
    v_mfma_f32_32x32x16_bf16 v[80:95], v[20:23], v[12:15], v[80:95]
    s_add_u32 m0, s47, 4096
    ds_read_b128 v[20:23], v176 offset:9728
    v_exp_f32 v64, v64
    v_cvt_pk_bf16_f32 v119, v62, v63
    v_exp_f32 v65, v65
    v_exp_f32 v66, v66
    v_cvt_pk_bf16_f32 v120, v64, v65
    v_exp_f32 v67, v67
    v_mfma_f32_32x32x16_bf16 v[96:111], v[24:27], v[12:15], v[96:111]
    ds_read_b128 v[24:27], v176 offset:10752
    v_exp_f32 v68, v68
    v_cvt_pk_bf16_f32 v121, v66, v67
    v_exp_f32 v69, v69
    v_exp_f32 v70, v70
    v_cvt_pk_bf16_f32 v122, v68, v69
    v_exp_f32 v71, v71
    v_mfma_f32_32x32x16_bf16 v[160:175], v[40:43], v[136:139], v[160:175]
    s_add_u32 s72, s48, 0
    ds_read_b128 v[40:43], v182 offset:6144
    v_exp_f32 v72, v72
    v_cvt_pk_bf16_f32 v123, v70, v71
    v_exp_f32 v73, v73
    v_exp_f32 v74, v74
    v_cvt_pk_bf16_f32 v124, v72, v73
    v_exp_f32 v75, v75
    v_mfma_f32_32x32x16_bf16 v[160:175], v[44:47], v[140:143], v[160:175]
    s_waitcnt lgkmcnt(3)
    ds_read_b128 v[44:47], v182 offset:6784
    v_exp_f32 v76, v76
    v_cvt_pk_bf16_f32 v125, v74, v75
    v_exp_f32 v77, v77
    v_exp_f32 v78, v78
    v_cvt_pk_bf16_f32 v126, v76, v77
    v_exp_f32 v79, v79
    v_exp_f32 v80, v80
    v_cvt_pk_bf16_f32 v127, v78, v79
    v_mfma_f32_32x32x4_2b_bf16 v[48:79], v[28:29], v[16:17], 0
    v_exp_f32 v81, v81
    v_exp_f32 v82, v82
    v_cvt_pk_bf16_f32 v128, v80, v81
    v_exp_f32 v83, v83
    v_exp_f32 v84, v84
    v_cvt_pk_bf16_f32 v129, v82, v83
    v_exp_f32 v85, v85
    v_exp_f32 v86, v86
    v_cvt_pk_bf16_f32 v130, v84, v85
    v_exp_f32 v87, v87
    v_mfma_f32_32x32x16_bf16 v[144:159], v[32:35], v[112:115], v[144:159]
    buffer_load_dwordx4 v187, s[8:11], s72 offen lds
    v_exp_f32 v88, v88
    v_cvt_pk_bf16_f32 v131, v86, v87
    v_exp_f32 v89, v89
    v_exp_f32 v90, v90
    v_cvt_pk_bf16_f32 v132, v88, v89
    v_exp_f32 v91, v91
    v_mfma_f32_32x32x16_bf16 v[144:159], v[36:39], v[116:119], v[144:159]
    s_waitcnt lgkmcnt(0)
    v_exp_f32 v92, v92
    v_cvt_pk_bf16_f32 v133, v90, v91
    v_exp_f32 v93, v93
    v_exp_f32 v94, v94
    v_cvt_pk_bf16_f32 v134, v92, v93
    v_exp_f32 v95, v95
    v_mfma_f32_32x32x16_bf16 v[48:63], v[20:23], v[8:11], v[48:63]
    s_add_u32 m0, s47, 9216
    v_exp_f32 v96, v96
    v_cvt_pk_bf16_f32 v135, v94, v95
    v_exp_f32 v97, v97
    v_exp_f32 v98, v98
    v_cvt_pk_bf16_f32 v136, v96, v97
    v_exp_f32 v99, v99
    v_mfma_f32_32x32x16_bf16 v[64:79], v[24:27], v[8:11], v[64:79]
    s_add_u32 s72, s48, 82944
    v_exp_f32 v100, v100
    v_cvt_pk_bf16_f32 v137, v98, v99
    v_exp_f32 v101, v101
    v_exp_f32 v102, v102
    v_cvt_pk_bf16_f32 v138, v100, v101
    v_exp_f32 v103, v103
    v_mfma_f32_32x32x16_bf16 v[144:159], v[40:43], v[120:123], v[144:159]
    buffer_load_dwordx4 v185, s[8:11], s72 offen lds
    v_exp_f32 v104, v104
    v_cvt_pk_bf16_f32 v139, v102, v103
    v_exp_f32 v105, v105
    v_exp_f32 v106, v106
    v_cvt_pk_bf16_f32 v140, v104, v105
    v_exp_f32 v107, v107
    v_mfma_f32_32x32x16_bf16 v[144:159], v[44:47], v[124:127], v[144:159]
    s_add_u32 m0, s47, 13312
    v_exp_f32 v108, v108
    v_cvt_pk_bf16_f32 v141, v106, v107
    v_exp_f32 v109, v109
    v_exp_f32 v110, v110
    v_cvt_pk_bf16_f32 v142, v108, v109
    v_exp_f32 v111, v111
    v_exp_f32 v48, v48
    v_cvt_pk_bf16_f32 v143, v110, v111
    v_mfma_f32_32x32x4_2b_bf16 v[80:111], v[28:29], v[18:19], 0
    v_exp_f32 v49, v49
    v_exp_f32 v50, v50
    v_cvt_pk_bf16_f32 v112, v48, v49
    v_exp_f32 v51, v51
    v_exp_f32 v52, v52
    v_cvt_pk_bf16_f32 v113, v50, v51
    v_exp_f32 v53, v53
    v_exp_f32 v54, v54
    v_cvt_pk_bf16_f32 v114, v52, v53
    v_exp_f32 v55, v55
    v_mfma_f32_32x32x16_bf16 v[160:175], v[32:35], v[128:131], v[160:175]
    s_add_u32 s72, s48, 82944
    ds_read_b32 v28, v179 offset:14592
    ds_read_b128 v[32:35], v182 offset:9728
    v_exp_f32 v56, v56
    v_cvt_pk_bf16_f32 v115, v54, v55
    v_exp_f32 v57, v57
    v_exp_f32 v58, v58
    v_cvt_pk_bf16_f32 v116, v56, v57
    v_exp_f32 v59, v59
    v_mfma_f32_32x32x16_bf16 v[160:175], v[36:39], v[132:135], v[160:175]
    ds_read_b128 v[36:39], v182 offset:10368
    buffer_load_dwordx4 v187, s[8:11], s72 offen lds
    v_exp_f32 v60, v60
    v_cvt_pk_bf16_f32 v117, v58, v59
    v_exp_f32 v61, v61
    v_exp_f32 v62, v62
    v_cvt_pk_bf16_f32 v118, v60, v61
    v_exp_f32 v63, v63
    v_mfma_f32_32x32x16_bf16 v[80:95], v[20:23], v[12:15], v[80:95]
    s_add_u32 m0, s47, 18432
    ds_read_b128 v[20:23], v176 offset:14592
    v_exp_f32 v64, v64
    v_cvt_pk_bf16_f32 v119, v62, v63
    v_exp_f32 v65, v65
    v_exp_f32 v66, v66
    v_cvt_pk_bf16_f32 v120, v64, v65
    v_exp_f32 v67, v67
    v_mfma_f32_32x32x16_bf16 v[96:111], v[24:27], v[12:15], v[96:111]
    ds_read_b128 v[24:27], v176 offset:15616
    buffer_load_dwordx4 v177, s[8:11], s49 offen lds
    v_exp_f32 v68, v68
    v_cvt_pk_bf16_f32 v121, v66, v67
    v_exp_f32 v69, v69
    v_exp_f32 v70, v70
    v_cvt_pk_bf16_f32 v122, v68, v69
    v_exp_f32 v71, v71
    v_mfma_f32_32x32x16_bf16 v[160:175], v[40:43], v[136:139], v[160:175]
    s_add_u32 m0, s47, 22528
    ds_read_b128 v[40:43], v182 offset:11008
    v_exp_f32 v72, v72
    v_cvt_pk_bf16_f32 v123, v70, v71
    v_exp_f32 v73, v73
    v_exp_f32 v74, v74
    v_cvt_pk_bf16_f32 v124, v72, v73
    v_exp_f32 v75, v75
    v_mfma_f32_32x32x16_bf16 v[160:175], v[44:47], v[140:143], v[160:175]
    s_waitcnt lgkmcnt(3)
    ds_read_b128 v[44:47], v182 offset:11648
    v_exp_f32 v76, v76
    v_cvt_pk_bf16_f32 v125, v74, v75
    v_exp_f32 v77, v77
    v_exp_f32 v78, v78
    v_cvt_pk_bf16_f32 v126, v76, v77
    v_exp_f32 v79, v79
    v_exp_f32 v80, v80
    v_cvt_pk_bf16_f32 v127, v78, v79
    v_mfma_f32_32x32x4_2b_bf16 v[48:79], v[28:29], v[16:17], 0
    v_exp_f32 v81, v81
    v_exp_f32 v82, v82
    v_cvt_pk_bf16_f32 v128, v80, v81
    v_exp_f32 v83, v83
    v_exp_f32 v84, v84
    v_cvt_pk_bf16_f32 v129, v82, v83
    v_exp_f32 v85, v85
    v_exp_f32 v86, v86
    v_cvt_pk_bf16_f32 v130, v84, v85
    v_exp_f32 v87, v87
    v_mfma_f32_32x32x16_bf16 v[144:159], v[32:35], v[112:115], v[144:159]
    buffer_load_dwordx4 v178, s[8:11], s49 offen lds
    v_exp_f32 v88, v88
    v_cvt_pk_bf16_f32 v131, v86, v87
    v_exp_f32 v89, v89
    v_exp_f32 v90, v90
    v_cvt_pk_bf16_f32 v132, v88, v89
    v_exp_f32 v91, v91
    v_mfma_f32_32x32x16_bf16 v[144:159], v[36:39], v[116:119], v[144:159]
    s_waitcnt lgkmcnt(0)
    v_exp_f32 v92, v92
    v_cvt_pk_bf16_f32 v133, v90, v91
    v_exp_f32 v93, v93
    v_exp_f32 v94, v94
    v_cvt_pk_bf16_f32 v134, v92, v93
    v_exp_f32 v95, v95
    v_mfma_f32_32x32x16_bf16 v[48:63], v[20:23], v[8:11], v[48:63]
    s_mov_b32 m0, s50
    v_exp_f32 v96, v96
    v_cvt_pk_bf16_f32 v135, v94, v95
    v_exp_f32 v97, v97
    v_exp_f32 v98, v98
    v_cvt_pk_bf16_f32 v136, v96, v97
    v_exp_f32 v99, v99
    v_mfma_f32_32x32x16_bf16 v[64:79], v[24:27], v[8:11], v[64:79]
    buffer_load_dwordx4 v180, s[8:11], s51 offen lds
    v_exp_f32 v100, v100
    v_cvt_pk_bf16_f32 v137, v98, v99
    v_exp_f32 v101, v101
    v_exp_f32 v102, v102
    v_cvt_pk_bf16_f32 v138, v100, v101
    v_exp_f32 v103, v103
    v_mfma_f32_32x32x16_bf16 v[144:159], v[40:43], v[120:123], v[144:159]
    global_load_dword v202, v227, s[56:57] sc1
    v_exp_f32 v104, v104
    v_cvt_pk_bf16_f32 v139, v102, v103
    v_exp_f32 v105, v105
    v_exp_f32 v106, v106
    v_cvt_pk_bf16_f32 v140, v104, v105
    v_exp_f32 v107, v107
    v_mfma_f32_32x32x16_bf16 v[144:159], v[44:47], v[124:127], v[144:159]
    s_add_u32 s47, s47, 27648
    v_exp_f32 v108, v108
    v_cvt_pk_bf16_f32 v141, v106, v107
    v_exp_f32 v109, v109
    v_exp_f32 v110, v110
    v_cvt_pk_bf16_f32 v142, v108, v109
    v_exp_f32 v111, v111
    v_exp_f32 v48, v48
    v_cvt_pk_bf16_f32 v143, v110, v111
    v_mfma_f32_32x32x4_2b_bf16 v[80:111], v[28:29], v[18:19], 0
    v_exp_f32 v49, v49
    v_exp_f32 v50, v50
    v_cvt_pk_bf16_f32 v112, v48, v49
    v_exp_f32 v51, v51
    v_exp_f32 v52, v52
    v_cvt_pk_bf16_f32 v113, v50, v51
    v_exp_f32 v53, v53
    v_exp_f32 v54, v54
    v_cvt_pk_bf16_f32 v114, v52, v53
    v_exp_f32 v55, v55
    v_mfma_f32_32x32x16_bf16 v[160:175], v[32:35], v[128:131], v[160:175]
    s_add_u32 s48, s48, 248832
    ds_read_b32 v28, v179 offset:19456
    ds_read_b128 v[32:35], v182 offset:14592
    v_exp_f32 v56, v56
    v_cvt_pk_bf16_f32 v115, v54, v55
    v_exp_f32 v57, v57
    v_exp_f32 v58, v58
    v_cvt_pk_bf16_f32 v116, v56, v57
    v_exp_f32 v59, v59
    v_mfma_f32_32x32x16_bf16 v[160:175], v[36:39], v[132:135], v[160:175]
    s_add_u32 s49, s49, 248832
    ds_read_b128 v[36:39], v182 offset:15232
    v_exp_f32 v60, v60
    v_cvt_pk_bf16_f32 v117, v58, v59
    v_exp_f32 v61, v61
    v_exp_f32 v62, v62
    v_cvt_pk_bf16_f32 v118, v60, v61
    v_exp_f32 v63, v63
    v_mfma_f32_32x32x16_bf16 v[80:95], v[20:23], v[12:15], v[80:95]
    s_add_u32 s50, s50, 36864
    ds_read_b128 v[20:23], v176 offset:19456
    v_exp_f32 v64, v64
    v_cvt_pk_bf16_f32 v119, v62, v63
    v_exp_f32 v65, v65
    v_exp_f32 v66, v66
    v_cvt_pk_bf16_f32 v120, v64, v65
    v_exp_f32 v67, v67
    v_mfma_f32_32x32x16_bf16 v[96:111], v[24:27], v[12:15], v[96:111]
    ds_read_b128 v[24:27], v176 offset:20480
    v_exp_f32 v68, v68
    v_cvt_pk_bf16_f32 v121, v66, v67
    v_exp_f32 v69, v69
    v_exp_f32 v70, v70
    v_cvt_pk_bf16_f32 v122, v68, v69
    v_exp_f32 v71, v71
    v_mfma_f32_32x32x16_bf16 v[160:175], v[40:43], v[136:139], v[160:175]
    s_add_u32 s51, s51, 331776
    ds_read_b128 v[40:43], v182 offset:15872
    v_exp_f32 v72, v72
    v_cvt_pk_bf16_f32 v123, v70, v71
    v_exp_f32 v73, v73
    v_exp_f32 v74, v74
    v_cvt_pk_bf16_f32 v124, v72, v73
    v_exp_f32 v75, v75
    v_mfma_f32_32x32x16_bf16 v[160:175], v[44:47], v[140:143], v[160:175]
    s_waitcnt lgkmcnt(3)
    ds_read_b128 v[44:47], v182 offset:16512
    v_exp_f32 v76, v76
    v_cvt_pk_bf16_f32 v125, v74, v75
    v_exp_f32 v77, v77
    v_exp_f32 v78, v78
    v_cvt_pk_bf16_f32 v126, v76, v77
    v_exp_f32 v79, v79
    v_exp_f32 v80, v80
    v_cvt_pk_bf16_f32 v127, v78, v79
    v_mfma_f32_32x32x4_2b_bf16 v[48:79], v[28:29], v[16:17], 0
    v_add_u32 v176, 19456, v176
    v_add_u32 v179, 19456, v179
    v_add_u32 v182, 19456, v182
    v_exp_f32 v81, v81
    v_exp_f32 v82, v82
    v_cvt_pk_bf16_f32 v128, v80, v81
    v_exp_f32 v83, v83
    v_exp_f32 v84, v84
    v_cvt_pk_bf16_f32 v129, v82, v83
    v_exp_f32 v85, v85
    v_exp_f32 v86, v86
    v_cvt_pk_bf16_f32 v130, v84, v85
    v_exp_f32 v87, v87
    v_mfma_f32_32x32x16_bf16 v[144:159], v[32:35], v[112:115], v[144:159]
    v_exp_f32 v88, v88
    v_cvt_pk_bf16_f32 v131, v86, v87
    v_exp_f32 v89, v89
    v_exp_f32 v90, v90
    v_cvt_pk_bf16_f32 v132, v88, v89
    v_exp_f32 v91, v91
    v_mfma_f32_32x32x16_bf16 v[144:159], v[36:39], v[116:119], v[144:159]
    s_waitcnt lgkmcnt(0)
    v_exp_f32 v92, v92
    v_cvt_pk_bf16_f32 v133, v90, v91
    v_exp_f32 v93, v93
    v_exp_f32 v94, v94
    v_cvt_pk_bf16_f32 v134, v92, v93
    v_exp_f32 v95, v95
    v_mfma_f32_32x32x16_bf16 v[48:63], v[20:23], v[8:11], v[48:63]
    s_cmp_eq_u32 s46, 2
    s_cselect_b32 s49, s64, s49
    s_cselect_b32 s51, s64, s51
    s_cselect_b32 s50, 81920, s50
    s_cselect_b64 vcc, -1, 0
    v_cndmask_b32 v177, v177, v186, vcc
    v_cndmask_b32 v178, v178, v188, vcc
    v_cndmask_b32 v180, v180, v190, vcc
    v_exp_f32 v96, v96
    v_cvt_pk_bf16_f32 v135, v94, v95
    v_exp_f32 v97, v97
    v_exp_f32 v98, v98
    v_cvt_pk_bf16_f32 v136, v96, v97
    v_exp_f32 v99, v99
    v_mfma_f32_32x32x16_bf16 v[64:79], v[24:27], v[8:11], v[64:79]
    s_sub_u32 s46, s46, 1
    v_exp_f32 v100, v100
    v_cvt_pk_bf16_f32 v137, v98, v99
    v_exp_f32 v101, v101
    v_exp_f32 v102, v102
    v_cvt_pk_bf16_f32 v138, v100, v101
    v_exp_f32 v103, v103
    v_mfma_f32_32x32x16_bf16 v[144:159], v[40:43], v[120:123], v[144:159]
    v_exp_f32 v104, v104
    v_cvt_pk_bf16_f32 v139, v102, v103
    v_exp_f32 v105, v105
    v_exp_f32 v106, v106
    v_cvt_pk_bf16_f32 v140, v104, v105
    v_exp_f32 v107, v107
    v_mfma_f32_32x32x16_bf16 v[144:159], v[44:47], v[124:127], v[144:159]
    s_cmp_lg_u32 s46, 0
    v_exp_f32 v108, v108
    v_cvt_pk_bf16_f32 v141, v106, v107
    v_exp_f32 v109, v109
    v_exp_f32 v110, v110
    v_cvt_pk_bf16_f32 v142, v108, v109
    v_exp_f32 v111, v111
    s_cbranch_scc1 M_LB
    v_cvt_pk_bf16_f32 v143, v110, v111
    v_mfma_f32_32x32x16_bf16 v[160:175], v[32:35], v[128:131], v[160:175]
    v_mfma_f32_32x32x16_bf16 v[160:175], v[36:39], v[132:135], v[160:175]
    v_mfma_f32_32x32x16_bf16 v[160:175], v[40:43], v[136:139], v[160:175]
    v_mfma_f32_32x32x16_bf16 v[160:175], v[44:47], v[140:143], v[160:175]
M_EPI:
    s_waitcnt vmcnt(0)
    s_barrier
    v_mov_b32 v8, v216
    v_mov_b32 v9, v217
    v_mov_b32 v10, v218
    v_mov_b32 v11, v219
    v_mov_b32 v12, v220
    v_mov_b32 v13, v221
    v_mov_b32 v14, v222
    v_mov_b32 v15, v223
    v_mov_b32 v16, v224
    v_mov_b32 v17, v225
    v_mov_b32 v18, v226
    s_mul_i32 s46, s37, 73728
    s_add_u32 s46, s46, 2097152
    s_lshl_b32 s47, s38, 2
    s_add_u32 s47, s47, s36
    s_lshl_b32 s48, s47, 10
    s_add_u32 s48, s48, s46
    s_lshl_b32 s49, s47, 7
    s_add_u32 s49, s49, s46
    s_add_u32 s49, s49, 32768
    s_add_u32 s50, s48, 36864
    s_add_u32 s51, s49, 36864
    v_rcp_f32 v154, v154
    s_nop 0
    v_mul_f32 v144, v144, v154
    v_mul_f32 v145, v145, v154
    v_mul_f32 v146, v146, v154
    v_mul_f32 v147, v147, v154
    v_mul_f32 v148, v148, v154
    v_mul_f32 v149, v149, v154
    v_mul_f32 v150, v150, v154
    v_mul_f32 v151, v151, v154
    v_mul_f32 v152, v152, v154
    v_mul_f32 v153, v153, v154
    v_cvt_pk_bf16_f32 v48, v144, v145
    v_cvt_pk_bf16_f32 v49, v146, v147
    v_cvt_pk_bf16_f32 v50, v148, v149
    v_cvt_pk_bf16_f32 v51, v150, v151
    v_cvt_pk_bf16_f32 v52, v152, v153
    v_rcp_f32 v170, v170
    s_nop 0
    v_mul_f32 v160, v160, v170
    v_mul_f32 v161, v161, v170
    v_mul_f32 v162, v162, v170
    v_mul_f32 v163, v163, v170
    v_mul_f32 v164, v164, v170
    v_mul_f32 v165, v165, v170
    v_mul_f32 v166, v166, v170
    v_mul_f32 v167, v167, v170
    v_mul_f32 v168, v168, v170
    v_mul_f32 v169, v169, v170
    v_cvt_pk_bf16_f32 v56, v160, v161
    v_cvt_pk_bf16_f32 v57, v162, v163
    v_cvt_pk_bf16_f32 v58, v164, v165
    v_cvt_pk_bf16_f32 v59, v166, v167
    v_cvt_pk_bf16_f32 v60, v168, v169
    s_cmp_eq_u32 s63, 0
    s_cbranch_scc1 M_OL
    buffer_store_dwordx4 v[48:51], v2, s[20:23], s48 offen sc1
    buffer_store_dwordx4 v[56:59], v2, s[20:23], s50 offen sc1
    s_mov_b32 exec_hi, 0
    buffer_store_dword v52, v4, s[20:23], s49 offen sc1
    buffer_store_dword v60, v4, s[20:23], s51 offen sc1
    s_mov_b32 exec_hi, -1
    s_branch M_OD
M_OL:
    buffer_store_dwordx4 v[48:51], v2, s[20:23], s48 offen
    buffer_store_dwordx4 v[56:59], v2, s[20:23], s50 offen
    s_mov_b32 exec_hi, 0
    buffer_store_dword v52, v4, s[20:23], s49 offen
    buffer_store_dword v60, v4, s[20:23], s51 offen
    s_mov_b32 exec_hi, -1
M_OD:
    s_lshl_b32 s52, s37, 12
    s_add_u32 s52, s52, 524288
    s_lshl_b32 s3, s47, 7
    v_mov_b32 v64, s3
    v_mov_b32 v65, s2
    v_lshlrev_b32 v67, 7, v3
    s_and_b32 s53, s36, 1
    s_lshr_b32 s54, s36, 1
    s_mul_i32 s55, s54, 36864
    s_add_u32 s55, s55, 83008
    ds_read_b64_tr_b16 a[0:1], v8 offset:0
    ds_read_b64_tr_b16 a[2:3], v8 offset:144
    ds_read_b64_tr_b16 a[4:5], v8 offset:2304
    ds_read_b64_tr_b16 a[6:7], v8 offset:2448
    ds_read_b64_tr_b16 a[144:145], v10 offset:0
    ds_read_b64_tr_b16 a[146:147], v10 offset:144
    s_waitcnt lgkmcnt(8)
    ds_read_b64_tr_b16 a[8:9], v8 offset:4608
    ds_read_b64_tr_b16 a[10:11], v8 offset:4752
    ds_read_b64_tr_b16 a[12:13], v8 offset:6912
    ds_read_b64_tr_b16 a[14:15], v8 offset:7056
    ds_read_b64_tr_b16 a[148:149], v10 offset:4608
    ds_read_b64_tr_b16 a[150:151], v10 offset:4752
    s_waitcnt lgkmcnt(8)
    ds_read_b64_tr_b16 a[16:17], v8 offset:9216
    ds_read_b64_tr_b16 a[18:19], v8 offset:9360
    ds_read_b64_tr_b16 a[20:21], v8 offset:11520
    ds_read_b64_tr_b16 a[22:23], v8 offset:11664
    ds_read_b64_tr_b16 a[152:153], v10 offset:9216
    ds_read_b64_tr_b16 a[154:155], v10 offset:9360
    s_waitcnt lgkmcnt(8)
    ds_read_b64_tr_b16 a[24:25], v8 offset:13824
    ds_read_b64_tr_b16 a[26:27], v8 offset:13968
    ds_read_b64_tr_b16 a[28:29], v8 offset:16128
    ds_read_b64_tr_b16 a[30:31], v8 offset:16272
    ds_read_b64_tr_b16 a[156:157], v10 offset:13824
    ds_read_b64_tr_b16 a[158:159], v10 offset:13968
    s_waitcnt lgkmcnt(8)
    ds_read_b64_tr_b16 a[32:33], v8 offset:18432
    ds_read_b64_tr_b16 a[34:35], v8 offset:18576
    ds_read_b64_tr_b16 a[36:37], v8 offset:20736
    ds_read_b64_tr_b16 a[38:39], v8 offset:20880
    ds_read_b64_tr_b16 a[160:161], v10 offset:18432
    ds_read_b64_tr_b16 a[162:163], v10 offset:18576
    s_waitcnt lgkmcnt(8)
    ds_read_b64_tr_b16 a[40:41], v8 offset:23040
    ds_read_b64_tr_b16 a[42:43], v8 offset:23184
    ds_read_b64_tr_b16 a[44:45], v8 offset:25344
    ds_read_b64_tr_b16 a[46:47], v8 offset:25488
    ds_read_b64_tr_b16 a[164:165], v10 offset:23040
    ds_read_b64_tr_b16 a[166:167], v10 offset:23184
    s_waitcnt lgkmcnt(8)
    ds_read_b64_tr_b16 a[48:49], v8 offset:27648
    ds_read_b64_tr_b16 a[50:51], v8 offset:27792
    ds_read_b64_tr_b16 a[52:53], v8 offset:29952
    ds_read_b64_tr_b16 a[54:55], v8 offset:30096
    ds_read_b64_tr_b16 a[168:169], v10 offset:27648
    ds_read_b64_tr_b16 a[170:171], v10 offset:27792
    s_waitcnt lgkmcnt(8)
    s_waitcnt vmcnt(0)
    s_mov_b64 exec, 1
    s_cmp_eq_u32 s63, 0
    s_cbranch_scc1 M_FL
    buffer_store_dword v65, v64, s[20:23], s52 offen sc1
    s_branch M_FD
M_FL:
    buffer_store_dword v65, v64, s[20:23], s52 offen
M_FD:
    s_mov_b64 exec, -1
    ds_read_b64_tr_b16 a[56:57], v8 offset:32256
    ds_read_b64_tr_b16 a[58:59], v8 offset:32400
    ds_read_b64_tr_b16 a[60:61], v8 offset:34560
    ds_read_b64_tr_b16 a[62:63], v8 offset:34704
    ds_read_b64_tr_b16 a[172:173], v10 offset:32256
    ds_read_b64_tr_b16 a[174:175], v10 offset:32400
    s_waitcnt lgkmcnt(8)
    ds_read_b64_tr_b16 a[64:65], v8 offset:36864
    ds_read_b64_tr_b16 a[66:67], v8 offset:37008
    ds_read_b64_tr_b16 a[68:69], v8 offset:39168
    ds_read_b64_tr_b16 a[70:71], v8 offset:39312
    ds_read_b64_tr_b16 a[196:197], v10 offset:36864
    ds_read_b64_tr_b16 a[198:199], v10 offset:37008
    s_waitcnt lgkmcnt(8)
    ds_read_b64_tr_b16 a[72:73], v9 offset:0
    ds_read_b64_tr_b16 a[74:75], v9 offset:144
    ds_read_b64_tr_b16 a[76:77], v9 offset:2304
    ds_read_b64_tr_b16 a[78:79], v9 offset:2448
    ds_read_b64_tr_b16 a[200:201], v11 offset:0
    ds_read_b64_tr_b16 a[202:203], v11 offset:144
    s_waitcnt lgkmcnt(8)
    ds_read_b64_tr_b16 a[80:81], v9 offset:4608
    ds_read_b64_tr_b16 a[82:83], v9 offset:4752
    ds_read_b64_tr_b16 a[84:85], v9 offset:6912
    ds_read_b64_tr_b16 a[86:87], v9 offset:7056
    ds_read_b64_tr_b16 a[204:205], v11 offset:4608
    ds_read_b64_tr_b16 a[206:207], v11 offset:4752
    s_waitcnt lgkmcnt(8)
    ds_read_b64_tr_b16 a[88:89], v9 offset:9216
    ds_read_b64_tr_b16 a[90:91], v9 offset:9360
    buffer_load_dword v66, v67, s[20:23], s52 offen sc1
    ds_read_b64_tr_b16 a[92:93], v9 offset:11520
    ds_read_b64_tr_b16 a[94:95], v9 offset:11664
    ds_read_b64_tr_b16 a[208:209], v11 offset:9216
    ds_read_b64_tr_b16 a[210:211], v11 offset:9360
    s_waitcnt lgkmcnt(8)
    ds_read_b64_tr_b16 a[96:97], v9 offset:13824
    ds_read_b64_tr_b16 a[98:99], v9 offset:13968
    ds_read_b64_tr_b16 a[100:101], v9 offset:16128
    ds_read_b64_tr_b16 a[102:103], v9 offset:16272
    ds_read_b64_tr_b16 a[212:213], v11 offset:13824
    ds_read_b64_tr_b16 a[214:215], v11 offset:13968
    s_waitcnt lgkmcnt(8)
    ds_read_b64_tr_b16 a[104:105], v9 offset:18432
    ds_read_b64_tr_b16 a[106:107], v9 offset:18576
    ds_read_b64_tr_b16 a[108:109], v9 offset:20736
    ds_read_b64_tr_b16 a[110:111], v9 offset:20880
    ds_read_b64_tr_b16 a[216:217], v11 offset:18432
    ds_read_b64_tr_b16 a[218:219], v11 offset:18576
    s_waitcnt lgkmcnt(8)
    ds_read_b64_tr_b16 a[112:113], v9 offset:23040
    ds_read_b64_tr_b16 a[114:115], v9 offset:23184
    ds_read_b64_tr_b16 a[116:117], v9 offset:25344
    ds_read_b64_tr_b16 a[118:119], v9 offset:25488
    ds_read_b64_tr_b16 a[220:221], v11 offset:23040
    ds_read_b64_tr_b16 a[222:223], v11 offset:23184
    s_waitcnt lgkmcnt(8)
    ds_read_b64_tr_b16 a[120:121], v9 offset:27648
    ds_read_b64_tr_b16 a[122:123], v9 offset:27792
    ds_read_b64_tr_b16 a[124:125], v9 offset:29952
    ds_read_b64_tr_b16 a[126:127], v9 offset:30096
    ds_read_b64_tr_b16 a[224:225], v11 offset:27648
    ds_read_b64_tr_b16 a[226:227], v11 offset:27792
    s_waitcnt lgkmcnt(8)
    s_waitcnt vmcnt(0)
    v_cmp_ne_u32 vcc, s2, v66
    s_cbranch_vccz M_PO_D
    s_mov_b32 s3, 0x8000
M_PO_P:
    buffer_load_dword v66, v67, s[20:23], s52 offen sc1
    s_waitcnt vmcnt(0)
    v_cmp_ne_u32 vcc, s2, v66
    s_cbranch_vccz M_PO_D
    s_sub_u32 s3, s3, 1
    s_cmp_eq_u32 s3, 0
    s_cbranch_scc1 M_PO_D
    s_sleep 2
    s_branch M_PO_P
M_PO_D:
    s_mul_i32 s56, s53, 3072
    s_add_u32 s57, s55, s56
    s_mul_i32 s58, s68, 36864
    s_add_u32 s58, s58, s56
    s_add_u32 s58, s58, 2097152
    s_add_u32 m0, s57, 0
    s_add_u32 s59, s58, 0
    buffer_load_dwordx4 v2, s[20:23], s59 offen sc1 lds
    s_add_u32 m0, s57, 1024
    s_add_u32 s59, s58, 1024
    buffer_load_dwordx4 v2, s[20:23], s59 offen sc1 lds
    s_add_u32 m0, s57, 2048
    s_add_u32 s59, s58, 2048
    buffer_load_dwordx4 v2, s[20:23], s59 offen sc1 lds
    s_add_u32 m0, s57, 6144
    s_add_u32 s59, s58, 6144
    buffer_load_dwordx4 v2, s[20:23], s59 offen sc1 lds
    s_add_u32 m0, s57, 7168
    s_add_u32 s59, s58, 7168
    buffer_load_dwordx4 v2, s[20:23], s59 offen sc1 lds
    s_add_u32 m0, s57, 8192
    s_add_u32 s59, s58, 8192
    buffer_load_dwordx4 v2, s[20:23], s59 offen sc1 lds
    s_add_u32 m0, s57, 12288
    s_add_u32 s59, s58, 12288
    buffer_load_dwordx4 v2, s[20:23], s59 offen sc1 lds
    s_add_u32 m0, s57, 13312
    s_add_u32 s59, s58, 13312
    buffer_load_dwordx4 v2, s[20:23], s59 offen sc1 lds
    s_add_u32 m0, s57, 14336
    s_add_u32 s59, s58, 14336
    buffer_load_dwordx4 v2, s[20:23], s59 offen sc1 lds
    s_add_u32 m0, s57, 18432
    s_add_u32 s59, s58, 18432
    buffer_load_dwordx4 v2, s[20:23], s59 offen sc1 lds
    s_add_u32 m0, s57, 19456
    s_add_u32 s59, s58, 19456
    buffer_load_dwordx4 v2, s[20:23], s59 offen sc1 lds
    s_add_u32 m0, s57, 20480
    s_add_u32 s59, s58, 20480
    buffer_load_dwordx4 v2, s[20:23], s59 offen sc1 lds
    ds_read_b64_tr_b16 a[128:129], v9 offset:32256
    ds_read_b64_tr_b16 a[130:131], v9 offset:32400
    ds_read_b64_tr_b16 a[132:133], v9 offset:34560
    ds_read_b64_tr_b16 a[134:135], v9 offset:34704
    ds_read_b64_tr_b16 a[228:229], v11 offset:32256
    ds_read_b64_tr_b16 a[230:231], v11 offset:32400
    s_waitcnt lgkmcnt(8)
    ds_read_b64_tr_b16 a[136:137], v9 offset:36864
    ds_read_b64_tr_b16 a[138:139], v9 offset:37008
    ds_read_b64_tr_b16 a[140:141], v9 offset:39168
    ds_read_b64_tr_b16 a[142:143], v9 offset:39312
    ds_read_b64_tr_b16 a[232:233], v11 offset:36864
    ds_read_b64_tr_b16 a[234:235], v11 offset:37008
    s_waitcnt lgkmcnt(8)
    s_waitcnt lgkmcnt(0)
    v_lshrrev_b32 v9, 4, v1
    v_bfe_u32 v10, v1, 3, 1
    v_lshl_add_u32 v9, v9, 2, v10
    v_mul_u32_u24 v9, 9216, v9
    v_and_b32 v10, 7, v1
    v_lshl_add_u32 v9, v10, 4, v9
    s_bfe_u32 s43, s37, 65538
    s_lshr_b32 s60, s36, 1
    s_and_b32 s61, s36, 1
    s_lshl_b32 s62, s60, 3
    s_add_u32 s62, s62, s61
    s_mul_i32 s62, s62, 18432
    s_mul_i32 s42, s39, 1152
    s_mul_i32 s43, s43, 640
    s_add_u32 s42, s42, s43
    s_add_u32 s42, s42, s62
    s_lshl_b32 s60, s60, 10
    s_mul_i32 s61, s61, 18496
    s_add_u32 s60, s60, s61
    s_add_u32 s60, s60, 1280
    s_waitcnt vmcnt(6)
    s_barrier
    ds_read_b128 v[96:99], v12 offset:0
    ds_read_b128 v[100:103], v12 offset:1024
    ds_read_b128 v[120:123], v13 offset:0
    ds_read_b128 v[104:107], v12 offset:2048
    s_waitcnt lgkmcnt(3)
    v_mfma_f32_32x32x16_bf16 v[128:143], a[0:3], v[96:99], 0
    s_add_u32 m0, s57, 24576
    s_add_u32 s59, s58, 24576
    buffer_load_dwordx4 v2, s[20:23], s59 offen sc1 lds
    ds_read_b128 v[108:111], v12 offset:3072
    s_waitcnt lgkmcnt(3)
    v_mfma_f32_32x32x16_bf16 v[128:143], a[4:7], v[100:103], v[128:143]
    s_add_u32 m0, s57, 25600
    s_add_u32 s59, s58, 25600
    buffer_load_dwordx4 v2, s[20:23], s59 offen sc1 lds
    ds_read_b128 v[124:127], v13 offset:2048
    s_waitcnt lgkmcnt(3)
    v_mfma_f32_16x16x32_bf16 v[144:147], a[144:147], v[120:123], 0
    ds_read_b128 v[96:99], v12 offset:4096
    s_waitcnt lgkmcnt(3)
    v_mfma_f32_32x32x16_bf16 v[128:143], a[8:11], v[104:107], v[128:143]
    s_add_u32 m0, s57, 26624
    s_add_u32 s59, s58, 26624
    buffer_load_dwordx4 v2, s[20:23], s59 offen sc1 lds
    ds_read_b128 v[100:103], v12 offset:5120
    s_waitcnt lgkmcnt(3)
    v_mfma_f32_32x32x16_bf16 v[128:143], a[12:15], v[108:111], v[128:143]
    s_add_u32 m0, s57, 30720
    s_add_u32 s59, s58, 30720
    buffer_load_dwordx4 v2, s[20:23], s59 offen sc1 lds
    ds_read_b128 v[120:123], v13 offset:4096
    s_waitcnt lgkmcnt(3)
    v_mfma_f32_16x16x32_bf16 v[144:147], a[148:151], v[124:127], v[144:147]
    ds_read_b128 v[104:107], v12 offset:6144
    s_waitcnt lgkmcnt(3)
    v_mfma_f32_32x32x16_bf16 v[128:143], a[16:19], v[96:99], v[128:143]
    s_add_u32 m0, s57, 31744
    s_add_u32 s59, s58, 31744
    buffer_load_dwordx4 v2, s[20:23], s59 offen sc1 lds
    ds_read_b128 v[108:111], v12 offset:7168
    s_waitcnt lgkmcnt(3)
    v_mfma_f32_32x32x16_bf16 v[128:143], a[20:23], v[100:103], v[128:143]
    s_add_u32 m0, s57, 32768
    s_add_u32 s59, s58, 32768
    buffer_load_dwordx4 v2, s[20:23], s59 offen sc1 lds
    ds_read_b128 v[124:127], v13 offset:6144
    s_waitcnt lgkmcnt(3)
    v_mfma_f32_16x16x32_bf16 v[144:147], a[152:155], v[120:123], v[144:147]
    ds_read_b128 v[96:99], v12 offset:8192
    s_waitcnt lgkmcnt(3)
    v_mfma_f32_32x32x16_bf16 v[128:143], a[24:27], v[104:107], v[128:143]
    s_add_u32 m0, s60, 0
    s_add_u32 s43, s42, 0
    buffer_load_dwordx4 v9, s[12:15], s43 offen lds
    ds_read_b128 v[100:103], v12 offset:9216
    s_waitcnt lgkmcnt(3)
    v_mfma_f32_32x32x16_bf16 v[128:143], a[28:31], v[108:111], v[128:143]
    s_add_u32 m0, s60, 2048
    s_add_u32 s43, s42, 294912
    buffer_load_dwordx4 v9, s[12:15], s43 offen lds
    ds_read_b128 v[120:123], v13 offset:8192
    s_waitcnt lgkmcnt(3)
    v_mfma_f32_16x16x32_bf16 v[144:147], a[156:159], v[124:127], v[144:147]
    ds_read_b128 v[104:107], v12 offset:10240
    s_waitcnt lgkmcnt(3)
    v_mfma_f32_32x32x16_bf16 v[128:143], a[32:35], v[96:99], v[128:143]
    s_add_u32 m0, s60, 4096
    s_add_u32 s43, s42, 589824
    buffer_load_dwordx4 v9, s[12:15], s43 offen lds
    ds_read_b128 v[108:111], v12 offset:11264
    s_waitcnt lgkmcnt(3)
    v_mfma_f32_32x32x16_bf16 v[128:143], a[36:39], v[100:103], v[128:143]
    s_add_u32 m0, s60, 6144
    s_add_u32 s43, s42, 884736
    buffer_load_dwordx4 v9, s[12:15], s43 offen lds
    ds_read_b128 v[124:127], v13 offset:10240
    s_waitcnt lgkmcnt(3)
    v_mfma_f32_16x16x32_bf16 v[144:147], a[160:163], v[120:123], v[144:147]
    s_waitcnt vmcnt(10)
    s_barrier
    ds_read_b128 v[96:99], v12 offset:12288
    s_waitcnt lgkmcnt(3)
    v_mfma_f32_32x32x16_bf16 v[128:143], a[40:43], v[104:107], v[128:143]
    s_add_u32 m0, s60, 8192
    s_add_u32 s43, s42, 1179648
    buffer_load_dwordx4 v9, s[12:15], s43 offen lds
    ds_read_b128 v[100:103], v12 offset:13312
    s_waitcnt lgkmcnt(3)
    v_mfma_f32_32x32x16_bf16 v[128:143], a[44:47], v[108:111], v[128:143]
    s_add_u32 m0, s60, 10240
    s_add_u32 s43, s42, 1474560
    buffer_load_dwordx4 v9, s[12:15], s43 offen lds
    ds_read_b128 v[120:123], v13 offset:12288
    s_waitcnt lgkmcnt(3)
    v_mfma_f32_16x16x32_bf16 v[144:147], a[164:167], v[124:127], v[144:147]
    ds_read_b128 v[104:107], v12 offset:14336
    s_waitcnt lgkmcnt(3)
    v_mfma_f32_32x32x16_bf16 v[128:143], a[48:51], v[96:99], v[128:143]
    s_add_u32 m0, s60, 12288
    s_add_u32 s43, s42, 1769472
    buffer_load_dwordx4 v9, s[12:15], s43 offen lds
    ds_read_b128 v[108:111], v12 offset:15360
    s_waitcnt lgkmcnt(3)
    v_mfma_f32_32x32x16_bf16 v[128:143], a[52:55], v[100:103], v[128:143]
    s_add_u32 m0, s60, 14336
    s_add_u32 s43, s42, 2064384
    buffer_load_dwordx4 v9, s[12:15], s43 offen lds
    ds_read_b128 v[124:127], v13 offset:14336
    s_waitcnt lgkmcnt(3)
    v_mfma_f32_16x16x32_bf16 v[144:147], a[168:171], v[120:123], v[144:147]
    ds_read_b128 v[96:99], v12 offset:16384
    s_waitcnt lgkmcnt(3)
    v_mfma_f32_32x32x16_bf16 v[128:143], a[56:59], v[104:107], v[128:143]
    s_add_u32 m0, s60, 16384
    s_add_u32 s43, s42, 2359296
    buffer_load_dwordx4 v9, s[12:15], s43 offen lds
    ds_read_b128 v[100:103], v12 offset:17408
    s_waitcnt lgkmcnt(3)
    v_mfma_f32_32x32x16_bf16 v[128:143], a[60:63], v[108:111], v[128:143]
    s_add_u32 m0, s60, 36992
    s_add_u32 s43, s42, 2654208
    buffer_load_dwordx4 v9, s[12:15], s43 offen lds
    ds_read_b128 v[120:123], v13 offset:16384
    s_waitcnt lgkmcnt(3)
    v_mfma_f32_16x16x32_bf16 v[144:147], a[172:175], v[124:127], v[144:147]
    ds_read_b128 v[104:107], v12 offset:18432
    s_waitcnt lgkmcnt(3)
    v_mfma_f32_32x32x16_bf16 v[128:143], a[64:67], v[96:99], v[128:143]
    s_add_u32 m0, s60, 39040
    s_add_u32 s43, s42, 2949120
    buffer_load_dwordx4 v9, s[12:15], s43 offen lds
    ds_read_b128 v[108:111], v12 offset:19456
    s_waitcnt lgkmcnt(3)
    v_mfma_f32_32x32x16_bf16 v[128:143], a[68:71], v[100:103], v[128:143]
    s_add_u32 m0, s60, 41088
    s_add_u32 s43, s42, 3244032
    buffer_load_dwordx4 v9, s[12:15], s43 offen lds
    ds_read_b128 v[124:127], v13 offset:18432
    s_waitcnt lgkmcnt(3)
    v_mfma_f32_16x16x32_bf16 v[144:147], a[196:199], v[120:123], v[144:147]
    ds_read_b128 v[96:99], v12 offset:20480
    s_waitcnt lgkmcnt(3)
    v_mfma_f32_32x32x16_bf16 v[128:143], a[72:75], v[104:107], v[128:143]
    s_add_u32 m0, s60, 43136
    s_add_u32 s43, s42, 3538944
    buffer_load_dwordx4 v9, s[12:15], s43 offen lds
    ds_read_b128 v[100:103], v12 offset:21504
    s_waitcnt lgkmcnt(3)
    v_mfma_f32_32x32x16_bf16 v[128:143], a[76:79], v[108:111], v[128:143]
    s_add_u32 m0, s60, 45184
    s_add_u32 s43, s42, 3833856
    buffer_load_dwordx4 v9, s[12:15], s43 offen lds
    ds_read_b128 v[120:123], v13 offset:20480
    s_waitcnt lgkmcnt(3)
    v_mfma_f32_16x16x32_bf16 v[144:147], a[200:203], v[124:127], v[144:147]
    ds_read_b128 v[104:107], v12 offset:22528
    s_waitcnt lgkmcnt(3)
    v_mfma_f32_32x32x16_bf16 v[128:143], a[80:83], v[96:99], v[128:143]
    s_add_u32 m0, s60, 47232
    s_add_u32 s43, s42, 4128768
    buffer_load_dwordx4 v9, s[12:15], s43 offen lds
    ds_read_b128 v[108:111], v12 offset:23552
    s_waitcnt lgkmcnt(3)
    v_mfma_f32_32x32x16_bf16 v[128:143], a[84:87], v[100:103], v[128:143]
    s_add_u32 m0, s60, 49280
    s_add_u32 s43, s42, 4423680
    buffer_load_dwordx4 v9, s[12:15], s43 offen lds
    ds_read_b128 v[124:127], v13 offset:22528
    s_waitcnt lgkmcnt(3)
    v_mfma_f32_16x16x32_bf16 v[144:147], a[204:207], v[120:123], v[144:147]
    s_waitcnt vmcnt(16)
    s_barrier
    ds_read_b128 v[96:99], v12 offset:24576
    s_waitcnt lgkmcnt(3)
    v_mfma_f32_32x32x16_bf16 v[128:143], a[88:91], v[104:107], v[128:143]
    s_add_u32 m0, s60, 51328
    s_add_u32 s43, s42, 4718592
    buffer_load_dwordx4 v9, s[12:15], s43 offen lds
    ds_read_b128 v[100:103], v12 offset:25600
    s_waitcnt lgkmcnt(3)
    v_mfma_f32_32x32x16_bf16 v[128:143], a[92:95], v[108:111], v[128:143]
    s_add_u32 m0, s60, 53376
    s_add_u32 s43, s42, 5013504
    buffer_load_dwordx4 v9, s[12:15], s43 offen lds
    ds_read_b128 v[120:123], v13 offset:24576
    s_waitcnt lgkmcnt(3)
    v_mfma_f32_16x16x32_bf16 v[144:147], a[208:211], v[124:127], v[144:147]
    ds_read_b128 v[104:107], v12 offset:26624
    s_waitcnt lgkmcnt(3)
    v_mfma_f32_32x32x16_bf16 v[128:143], a[96:99], v[96:99], v[128:143]
    ds_read_b128 v[108:111], v12 offset:27648
    s_waitcnt lgkmcnt(3)
    v_mfma_f32_32x32x16_bf16 v[128:143], a[100:103], v[100:103], v[128:143]
    ds_read_b128 v[124:127], v13 offset:26624
    s_waitcnt lgkmcnt(3)
    v_mfma_f32_16x16x32_bf16 v[144:147], a[212:215], v[120:123], v[144:147]
    ds_read_b128 v[96:99], v12 offset:28672
    s_waitcnt lgkmcnt(3)
    v_mfma_f32_32x32x16_bf16 v[128:143], a[104:107], v[104:107], v[128:143]
    ds_read_b128 v[100:103], v12 offset:29696
    s_waitcnt lgkmcnt(3)
    v_mfma_f32_32x32x16_bf16 v[128:143], a[108:111], v[108:111], v[128:143]
    ds_read_b128 v[120:123], v13 offset:28672
    s_waitcnt lgkmcnt(3)
    v_mfma_f32_16x16x32_bf16 v[144:147], a[216:219], v[124:127], v[144:147]
    ds_read_b128 v[104:107], v12 offset:30720
    s_waitcnt lgkmcnt(3)
    v_mfma_f32_32x32x16_bf16 v[128:143], a[112:115], v[96:99], v[128:143]
    ds_read_b128 v[108:111], v12 offset:31744
    s_waitcnt lgkmcnt(3)
    v_mfma_f32_32x32x16_bf16 v[128:143], a[116:119], v[100:103], v[128:143]
    ds_read_b128 v[124:127], v13 offset:30720
    s_waitcnt lgkmcnt(3)
    v_mfma_f32_16x16x32_bf16 v[144:147], a[220:223], v[120:123], v[144:147]
    s_waitcnt lgkmcnt(2)
    ds_read_b32 v96, v15 offset:32768
    ds_read_b32 v97, v15 offset:32896
    ds_read_b32 v98, v15 offset:33024
    ds_read_b32 v99, v15 offset:33152
    v_mfma_f32_32x32x16_bf16 v[128:143], a[120:123], v[104:107], v[128:143]
    ds_read_b32 v100, v15 offset:33792
    ds_read_b32 v101, v15 offset:33920
    ds_read_b32 v102, v15 offset:34048
    ds_read_b32 v103, v15 offset:34176
    s_waitcnt lgkmcnt(9)
    v_mfma_f32_32x32x16_bf16 v[128:143], a[124:127], v[108:111], v[128:143]
    s_waitcnt lgkmcnt(8)
    ds_read_b32 v120, v16 offset:32768
    ds_read_b32 v121, v16 offset:32896
    ds_read_b32 v122, v16 offset:33024
    ds_read_b32 v123, v16 offset:33152
    v_mfma_f32_16x16x32_bf16 v[144:147], a[224:227], v[124:127], v[144:147]
    s_waitcnt lgkmcnt(8)
    ds_read_b32 v104, v15 offset:34816
    ds_read_b32 v105, v15 offset:34944
    ds_read_b32 v106, v15 offset:35072
    ds_read_b32 v107, v15 offset:35200
    v_mfma_f32_32x32x16_bf16 v[128:143], a[128:131], v[96:99], v[128:143]
    ds_read_b32 v108, v15 offset:35840
    ds_read_b32 v109, v15 offset:35968
    ds_read_b32 v110, v15 offset:36096
    ds_read_b32 v111, v15 offset:36224
    s_waitcnt lgkmcnt(12)
    v_mfma_f32_32x32x16_bf16 v[128:143], a[132:135], v[100:103], v[128:143]
    s_waitcnt lgkmcnt(8)
    ds_read_b32 v124, v16 offset:34816
    ds_read_b32 v125, v16 offset:34944
    ds_read_b32 v126, v16 offset:35072
    ds_read_b32 v127, v16 offset:35200
    v_mfma_f32_16x16x32_bf16 v[144:147], a[228:231], v[120:123], v[144:147]
    s_waitcnt lgkmcnt(8)
    v_mfma_f32_32x32x16_bf16 v[128:143], a[136:139], v[104:107], v[128:143]
    s_waitcnt lgkmcnt(4)
    v_mfma_f32_32x32x16_bf16 v[128:143], a[140:143], v[108:111], v[128:143]
    s_waitcnt lgkmcnt(0)
    v_mfma_f32_16x16x32_bf16 v[144:147], a[232:235], v[124:127], v[144:147]
    s_mov_b32 s44, 0x3f803f80
    s_mov_b32 s45, 0x00003f80
    s_mov_b32 s46, 0x3f800000
    s_mul_i32 s47, s68, 36864
    s_add_u32 s47, s47, 4456448
    s_mul_i32 s48, s38, 9
    s_add_u32 s49, s48, s67
    s_lshr_b32 s49, s49, 1
    s_lshl_b32 s3, s53, 1
    s_add_u32 s49, s49, s3
    s_lshl_b32 s49, s49, 10
    s_add_u32 s49, s49, s47
    s_xor_b32 s3, s67, 1
    s_lshl_b32 s3, s3, 3
    s_add_u32 s50, s48, s3
    s_lshr_b32 s50, s50, 1
    s_lshl_b32 s50, s50, 10
    s_lshl_b32 s3, s67, 3
    s_add_u32 s50, s50, s3
    s_add_u32 s50, s50, s47
    s_mul_i32 s51, s68, 6144
    s_mul_i32 s3, s38, 768
    s_add_u32 s51, s51, s3
    s_add_u32 s51, s51, 1048576
    s_add_u32 s52, s51, 512
    s_lshl_b32 s3, s53, 8
    s_add_u32 s51, s51, s3
    v_mov_b32 v64, 0
    v_mov_b32 v65, 0
    v_mov_b32 v66, 0
    v_mov_b32 v67, 0
    v_dot2_f32_bf16 v128, v192, s45, v128
    v_dot2_f32_bf16 v129, v192, s46, v129
    v_dot2_f32_bf16 v130, v193, s45, v130
    v_dot2_f32_bf16 v131, v193, s46, v131
    v_dot2_f32_bf16 v132, v194, s45, v132
    v_dot2_f32_bf16 v133, v194, s46, v133
    v_dot2_f32_bf16 v134, v195, s45, v134
    v_dot2_f32_bf16 v135, v195, s46, v135
    v_dot2_f32_bf16 v136, v196, s45, v136
    v_dot2_f32_bf16 v137, v196, s46, v137
    v_dot2_f32_bf16 v138, v197, s45, v138
    v_dot2_f32_bf16 v139, v197, s46, v139
    v_dot2_f32_bf16 v140, v198, s45, v140
    v_dot2_f32_bf16 v141, v198, s46, v141
    v_dot2_f32_bf16 v142, v199, s45, v142
    v_dot2_f32_bf16 v143, v199, s46, v143
    v_dot2_f32_bf16 v144, v200, s45, v144
    v_dot2_f32_bf16 v145, v200, s46, v145
    v_dot2_f32_bf16 v146, v201, s45, v146
    v_dot2_f32_bf16 v147, v201, s46, v147
    v_cvt_pk_bf16_f32 v48, v128, v129
    v_cvt_pk_bf16_f32 v49, v130, v131
    v_cvt_pk_bf16_f32 v50, v132, v133
    v_cvt_pk_bf16_f32 v51, v134, v135
    v_cvt_pk_bf16_f32 v52, v136, v137
    v_cvt_pk_bf16_f32 v53, v138, v139
    v_cvt_pk_bf16_f32 v54, v140, v141
    v_cvt_pk_bf16_f32 v55, v142, v143
    v_cvt_pk_bf16_f32 v56, v144, v145
    v_cvt_pk_bf16_f32 v57, v146, v147
    buffer_store_dwordx4 v[48:51], v2, s[20:23], s49 offen offset:0 sc1
    buffer_store_dwordx4 v[52:55], v2, s[20:23], s49 offen offset:1024 sc1
    v_dot2_f32_bf16 v64, v48, s44, v64
    v_dot2_f32_bf16 v65, v48, v48, v65
    v_dot2_f32_bf16 v64, v49, s44, v64
    v_dot2_f32_bf16 v65, v49, v49, v65
    v_dot2_f32_bf16 v64, v50, s44, v64
    v_dot2_f32_bf16 v65, v50, v50, v65
    v_dot2_f32_bf16 v64, v51, s44, v64
    v_dot2_f32_bf16 v65, v51, v51, v65
    v_dot2_f32_bf16 v64, v52, s44, v64
    v_dot2_f32_bf16 v65, v52, v52, v65
    v_dot2_f32_bf16 v64, v53, s44, v64
    v_dot2_f32_bf16 v65, v53, v53, v65
    v_dot2_f32_bf16 v64, v54, s44, v64
    v_dot2_f32_bf16 v65, v54, v54, v65
    v_dot2_f32_bf16 v64, v55, s44, v64
    v_dot2_f32_bf16 v65, v55, v55, v65
    v_dot2_f32_bf16 v66, v56, s44, v66
    v_dot2_f32_bf16 v67, v56, v56, v67
    v_dot2_f32_bf16 v66, v57, s44, v66
    v_dot2_f32_bf16 v67, v57, v57, v67
    v_mov_b32 v68, v64
    v_mov_b32 v69, v65
    v_mov_b32 v70, v66
    v_mov_b32 v71, v67
    v_permlane32_swap_b32 v64, v68
    v_permlane32_swap_b32 v65, v69
    v_permlane16_swap_b32 v66, v70
    v_permlane16_swap_b32 v67, v71
    v_add_f32 v64, v64, v68
    v_add_f32 v65, v65, v69
    v_add_f32 v66, v66, v70
    v_add_f32 v67, v67, v71
    s_mov_b32 exec_hi, 0
    buffer_store_dwordx2 v[56:57], v14, s[20:23], s50 offen sc1
    buffer_store_dwordx2 v[64:65], v18, s[20:23], s51 offen sc1
    s_mov_b64 exec, 0xffff
    buffer_store_dwordx2 v[66:67], v17, s[20:23], s52 offen sc1
    s_mov_b64 exec, -1
    s_lshl_b32 s72, s68, 11
    s_add_u32 s72, s72, 655360
    s_lshl_b32 s3, s38, 1
    s_add_u32 s3, s3, s53
    s_lshl_b32 s3, s3, 7
    v_mov_b32 v44, s3
    v_mov_b32 v45, s2
    s_barrier
    s_bfe_u32 s41, s37, 65538
    s_mov_b32 s37, s63
    v_lshrrev_b32 v20, 4, v1
    v_bfe_u32 v22, v1, 3, 1
    v_lshl_add_u32 v20, v20, 2, v22
    v_and_b32 v21, 7, v1
    v_lshlrev_b32 v21, 4, v21
    s_lshr_b32 s67, s36, 1
    s_and_b32 s70, s36, 1
    s_lshl_b32 s68, s67, 4
    s_lshl_b32 s3, s70, 1
    s_add_u32 s68, s68, s3
    v_mul_u32_u24 v9, 9216, v20
    v_add_u32 v9, v9, v21
    s_lshl_b32 s45, s39, 1
    s_add_u32 s45, s45, s41
    s_mul_i32 s71, s45, 576
    s_lshl_b32 s3, s41, 6
    s_add_u32 s42, s71, s3
    s_mul_i32 s3, s68, 9216
    s_add_u32 s42, s42, s3
    s_lshl_b32 s44, s67, 10
    s_mul_i32 s3, s70, 18496
    s_add_u32 s44, s44, s3
    s_add_u32 s44, s44, 1280
    s_mov_b32 s73, s72
    s_waitcnt vmcnt(0)
    s_mov_b64 exec, 1
    buffer_store_dword v45, v44, s[20:23], s73 offen sc1
    s_mov_b64 exec, -1
    s_lshl_b32 s3, s41, 6
    s_add_u32 s53, s71, s3
    s_xor_b32 s3, s41, 1
    s_lshl_b32 s3, s3, 9
    s_add_u32 s43, s71, s3
    v_lshlrev_b32 v24, 1, v0
    v_lshlrev_b32 v25, 1, v3
    s_add_u32 m0, s44, 73984
    s_add_u32 s58, s42, 128
    buffer_load_dwordx4 v9, s[12:15], s58 offen lds
    s_add_u32 m0, s44, 76032
    s_add_u32 s58, s42, 295040
    buffer_load_dwordx4 v9, s[12:15], s58 offen lds
    s_add_u32 m0, s44, 78080
    s_add_u32 s58, s42, 589952
    buffer_load_dwordx4 v9, s[12:15], s58 offen lds
    s_add_u32 m0, s44, 80128
    s_add_u32 s58, s42, 884864
    buffer_load_dwordx4 v9, s[12:15], s58 offen lds
    s_add_u32 m0, s44, 82176
    s_add_u32 s58, s42, 1179776
    buffer_load_dwordx4 v9, s[12:15], s58 offen lds
    s_add_u32 m0, s44, 84224
    s_add_u32 s58, s42, 1474688
    buffer_load_dwordx4 v9, s[12:15], s58 offen lds
    s_add_u32 m0, s44, 86272
    s_add_u32 s58, s42, 1769600
    buffer_load_dwordx4 v9, s[12:15], s58 offen lds
    s_add_u32 m0, s44, 88320
    s_add_u32 s58, s42, 2064512
    buffer_load_dwordx4 v9, s[12:15], s58 offen lds
    s_add_u32 m0, s44, 90368
    s_add_u32 s58, s42, 2359424
    buffer_load_dwordx4 v9, s[12:15], s58 offen lds
    s_mul_i32 s3, s36, 147456
    s_add_u32 s43, s43, s3
    s_lshl_b32 s48, s36, 10
    s_add_u32 s48, s48, 1280
    v_mul_u32_u24 v11, 1152, v20
    v_add_u32 v11, v11, v21
    v_lshrrev_b32 v20, 2, v1
    v_and_b32 v21, 3, v1
    v_lshlrev_b32 v21, 4, v21
    v_mul_u32_u24 v10, 9216, v20
    v_add_u32 v10, v10, v21
    v_mul_u32_u24 v12, 1152, v20
    v_add_u32 v12, v12, v21
    s_mul_i32 s54, s39, 663552
    s_mul_i32 s53, s41, 640
    s_add_u32 s53, s53, s54
    s_mul_i32 s3, s68, 1152
    s_add_u32 s53, s53, s3
    s_xor_b32 s3, s41, 0
    s_mul_i32 s49, s3, 368640
    s_add_u32 s49, s49, s53
    s_mul_i32 s51, s3, 36864
    s_add_u32 s51, s51, s53
    s_add_u32 s51, s51, 294912
    s_xor_b32 s3, s41, 1
    s_mul_i32 s50, s3, 368640
    s_add_u32 s50, s50, s53
    s_mul_i32 s52, s3, 36864
    s_add_u32 s52, s52, s53
    s_add_u32 s52, s52, 294912
    s_lshl_b32 s3, s41, 6
    s_add_u32 s54, s54, s3
    s_add_u32 s54, s54, 512
    s_mul_i32 s3, s70, 18432
    s_add_u32 s54, s54, s3
    s_xor_b32 s3, s41, s67
    s_mul_i32 s53, s3, 36864
    s_add_u32 s53, s53, s54
    s_add_u32 s53, s53, 294912
    s_mul_i32 s3, s3, 368640
    s_add_u32 s54, s54, s3
    s_mul_i32 s67, s40, 36864
    s_add_u32 s46, s67, 4456448
    s_mul_i32 s3, s41, 20480
    s_add_u32 s67, s67, s3
    s_add_u32 s67, s67, 16777216
    s_mul_i32 s47, s39, 2359296
    s_add_u32 s47, s47, s67
    s_lshl_b32 s66, s39, 11
    s_add_u32 s66, s66, s67
    s_mul_i32 s57, s40, 6144
    s_add_u32 s57, s57, 1048576
    s_lshl_b32 s72, s40, 11
    s_add_u32 s72, s72, 655360
    s_lshr_b32 s64, s39, 1
    s_xor_b32 s3, s64, 2
    s_lshl_b32 s3, s3, 7
    v_add_u32 v42, s3, v11
    s_xor_b32 s3, s64, 3
    s_lshl_b32 s3, s3, 7
    v_add_u32 v43, s3, v11
    s_xor_b32 s3, s64, 1
    s_lshl_b32 s3, s3, 7
    v_add_u32 v46, s3, v11
    s_xor_b32 s3, s64, 0
    s_lshl_b32 s3, s3, 7
    v_add_u32 v47, s3, v11
    s_lshl_b32 s3, s45, 6
    s_add_u32 s3, s3, s40
    s_mul_i32 s55, s3, 18432
    s_add_u32 s55, s55, 35651584
    s_lshl_b32 s56, s3, 7
    s_add_u32 s56, s56, 786432
    s_mov_b32 s59, 0xbeeff558
    s_mov_b32 s60, 0x409d30fc
    s_mov_b32 s61, 0x00003f80
    s_mov_b32 s62, 0x3f800000
    s_mov_b32 s69, 0xffff0000
    v_lshrrev_b32 v23, 5, v1
    v_bfe_u32 v20, v1, 2, 1
    v_lshl_add_u32 v20, v23, 1, v20
    v_lshlrev_b32 v20, 7, v20
    v_bfe_u32 v21, v1, 4, 1
    v_and_b32 v22, 3, v1
    v_lshlrev_b32 v22, 3, v22
    v_lshl_add_u32 v21, v21, 5, v22
    v_bfe_u32 v22, v1, 3, 1
    v_mul_u32_u24 v22, 18496, v22
    v_add3_u32 v20, v20, v21, v22
    v_add_u32 v4, 1280, v20
    v_add_u32 v5, 38272, v20
    v_add_u32 v6, 75264, v20
    v_add_u32 v7, 112256, v20
    v_bfe_u32 v20, v1, 2, 2
    v_lshl_add_u32 v20, v23, 2, v20
    v_lshl_add_u32 v8, v20, 6, v21
    v_add_u32 v8, 1280, v8
    s_and_b32 s3, s39, 1
    s_lshl_b32 s3, s3, 6
    v_add_u32 v40, s3, v4
    v_add_u32 v41, s3, v5
    s_xor_b32 s3, s3, 64
    v_add_u32 v38, s3, v4
    v_add_u32 v39, s3, v5
    v_lshlrev_b32 v15, 4, v23
    v_and_b32 v14, 15, v1
    v_lshlrev_b32 v14, 7, v14
    v_mov_b32 v19, 0
    v_mov_b32 v37, s2
    v_mul_u32_u24 v22, 3072, v23
    v_lshl_add_u32 v22, v3, 3, v22
    v_accvgpr_read_b32 v26, a194
    v_accvgpr_read_b32 v27, a195
    v_lshlrev_b32 v26, 16, v26
    v_lshlrev_b32 v27, 16, v27
    v_mul_f32 v26, s59, v26
    v_mul_f32 v27, s59, v27
    v_lshlrev_b32 v24, 1, v24
    v_lshlrev_b32 v25, 1, v25
    ds_write_b32 v24, v26 offset:0
    ds_write_b32 v25, v27 offset:1024
    s_mov_b32 s3, 0x8000
M_PH_P:
    buffer_load_dword v23, v14, s[20:23], s72 offen sc1
    s_waitcnt vmcnt(0)
    v_cmp_ne_u32 vcc, s2, v23
    s_cbranch_vccz M_PH_D
    s_sub_u32 s3, s3, 1
    s_cmp_eq_u32 s3, 0
    s_cbranch_scc1 M_PH_D
    s_sleep 2
    s_branch M_PH_P
M_PH_D:
    buffer_load_dwordx2 v[48:49], v22, s[20:23], s57 offen offset:0 sc1
    buffer_load_dwordx2 v[50:51], v22, s[20:23], s57 offen offset:256 sc1
    buffer_load_dwordx2 v[52:53], v22, s[20:23], s57 offen offset:512 sc1
    buffer_load_dwordx2 v[54:55], v22, s[20:23], s57 offen offset:768 sc1
    buffer_load_dwordx2 v[56:57], v22, s[20:23], s57 offen offset:1024 sc1
    buffer_load_dwordx2 v[58:59], v22, s[20:23], s57 offen offset:1280 sc1
    buffer_load_dwordx2 v[60:61], v22, s[20:23], s57 offen offset:1536 sc1
    buffer_load_dwordx2 v[62:63], v22, s[20:23], s57 offen offset:1792 sc1
    buffer_load_dwordx2 v[64:65], v22, s[20:23], s57 offen offset:2048 sc1
    buffer_load_dwordx2 v[66:67], v22, s[20:23], s57 offen offset:2304 sc1
    buffer_load_dwordx2 v[68:69], v22, s[20:23], s57 offen offset:2560 sc1
    buffer_load_dwordx2 v[70:71], v22, s[20:23], s57 offen offset:2816 sc1
    s_add_u32 s73, s46, 0
    buffer_load_dwordx4 v[112:115], v2, s[20:23], s73 offen offset:0 sc1
    buffer_load_dwordx4 v[116:119], v2, s[20:23], s73 offen offset:1024 sc1
    buffer_load_dwordx4 v[120:123], v2, s[20:23], s73 offen offset:2048 sc1
    buffer_load_dwordx4 v[124:127], v2, s[20:23], s73 offen offset:3072 sc1
    s_add_u32 s73, s46, 4096
    buffer_load_dwordx4 v[128:131], v2, s[20:23], s73 offen offset:0 sc1
    buffer_load_dwordx4 v[132:135], v2, s[20:23], s73 offen offset:1024 sc1
    buffer_load_dwordx4 v[136:139], v2, s[20:23], s73 offen offset:2048 sc1
    buffer_load_dwordx4 v[140:143], v2, s[20:23], s73 offen offset:3072 sc1
    s_add_u32 s73, s46, 8192
    buffer_load_dwordx4 v[144:147], v2, s[20:23], s73 offen offset:0 sc1
    buffer_load_dwordx4 v[148:151], v2, s[20:23], s73 offen offset:1024 sc1
    v_lshrrev_b32 v14, 5, v14
    s_lshl_b32 s57, s40, 1
    s_add_u32 s57, s57, s41
    s_lshl_b32 s57, s57, 10
    s_add_u32 s57, s57, 196608
    s_lshl_b32 s65, s39, 7
    s_add_u32 s65, s65, s57
    s_waitcnt lgkmcnt(0)
    s_barrier
    s_waitcnt vmcnt(10)
    v_add_f32 v48, v48, v50
    v_add_f32 v49, v49, v51
    v_add_f32 v48, v48, v52
    v_add_f32 v49, v49, v53
    v_add_f32 v48, v48, v54
    v_add_f32 v49, v49, v55
    v_add_f32 v48, v48, v56
    v_add_f32 v49, v49, v57
    v_add_f32 v48, v48, v58
    v_add_f32 v49, v49, v59
    v_add_f32 v48, v48, v60
    v_add_f32 v49, v49, v61
    v_add_f32 v48, v48, v62
    v_add_f32 v49, v49, v63
    v_add_f32 v48, v48, v64
    v_add_f32 v49, v49, v65
    v_add_f32 v48, v48, v66
    v_add_f32 v49, v49, v67
    v_add_f32 v48, v48, v68
    v_add_f32 v49, v49, v69
    v_add_f32 v48, v48, v70
    v_add_f32 v49, v49, v71
    v_mov_b32 v50, v48
    v_mov_b32 v51, v49
    s_nop 0
    v_permlane32_swap_b32 v48, v50
    v_permlane32_swap_b32 v49, v51
    v_add_f32 v48, v48, v50
    v_add_f32 v49, v49, v51
    v_mul_f32 v48, 0x3ae38e39, v48
    v_mul_f32 v49, 0x3ae38e39, v49
    v_fma_f32 v49, -v48, v48, v49
    v_max_f32 v49, 0, v49
    v_add_f32 v50, 0x3727c5ac, v49
    v_rsq_f32 v50, v50
    s_nop 0
    v_mul_f32 v49, v49, v50
    v_mul_f32 v49, v49, v50
    v_add_f32 v49, 0x3727c5ac, v49
    v_rsq_f32 v49, v49
    s_nop 0
    v_mul_f32 v49, v49, v50
    v_mul_f32 v16, s59, v49
    v_mul_f32 v48, v48, v16
    v_sub_f32 v17, 0, v48
    s_xor_b32 s3, s41, 1
    s_sub_u32 s3, s3, s41
    s_mul_i32 s3, s3, 1179648
    s_add_u32 s68, s55, s3
    ds_read_b128 v[48:51], v15 offset:0
    ds_read_b128 v[52:55], v15 offset:32
    ds_read_b128 v[56:59], v15 offset:64
    ds_read_b128 v[60:63], v15 offset:96
    ds_read_b128 v[64:67], v15 offset:128
    ds_read_b128 v[68:71], v15 offset:160
    ds_read_b128 v[72:75], v15 offset:192
    ds_read_b128 v[76:79], v15 offset:224
    ds_read_b64_tr_b16 a[144:145], v4 offset:0
    ds_read_b64_tr_b16 a[146:147], v4 offset:512
    ds_read_b64_tr_b16 a[148:149], v4 offset:64
    ds_read_b64_tr_b16 a[150:151], v4 offset:576
    ds_read_b64_tr_b16 a[152:153], v4 offset:1024
    ds_read_b64_tr_b16 a[154:155], v4 offset:1536
    s_waitcnt lgkmcnt(6)
    ds_read_b64_tr_b16 a[156:157], v4 offset:1088
    ds_read_b64_tr_b16 a[158:159], v4 offset:1600
    ds_read_b64_tr_b16 a[160:161], v4 offset:2048
    ds_read_b64_tr_b16 a[162:163], v4 offset:2560
    ds_read_b64_tr_b16 a[164:165], v4 offset:2112
    ds_read_b64_tr_b16 a[166:167], v4 offset:2624
    v_mov_b32 v44, v17
    s_waitcnt vmcnt(8)
    v_lshlrev_b32 v20, 16, v112
    v_and_b32 v21, s69, v112
    v_lshlrev_b32 v22, 16, v113
    v_and_b32 v23, s69, v113
    v_lshlrev_b32 v24, 16, v114
    v_and_b32 v25, s69, v114
    v_lshlrev_b32 v26, 16, v115
    v_and_b32 v27, s69, v115
    v_fma_f32 v20, v20, v16, v17
    v_fma_f32 v21, v21, v16, v17
    v_fma_f32 v22, v22, v16, v17
    v_fma_f32 v23, v23, v16, v17
    v_fma_f32 v24, v24, v16, v17
    v_fma_f32 v25, v25, v16, v17
    v_fma_f32 v26, v26, v16, v17
    v_fma_f32 v27, v27, v16, v17
    v_cvt_pk_bf16_f32 v112, v20, v21
    v_cvt_pk_bf16_f32 v113, v22, v23
    v_cvt_pk_bf16_f32 v114, v24, v25
    v_cvt_pk_bf16_f32 v115, v26, v27
    s_waitcnt lgkmcnt(10)
    s_nop 0
    v_mfma_f32_32x32x16_bf16 v[48:63], a[144:147], v[112:115], v[48:63]
    ds_read_b64_tr_b16 a[168:169], v4 offset:3072
    ds_read_b64_tr_b16 a[170:171], v4 offset:3584
    buffer_load_dwordx4 v[152:155], v2, s[20:23], s73 offen offset:2048 sc1
    v_lshlrev_b32 v20, 16, v116
    v_and_b32 v21, s69, v116
    v_lshlrev_b32 v22, 16, v117
    s_waitcnt lgkmcnt(10)
    v_mfma_f32_32x32x16_bf16 v[64:79], a[148:151], v[112:115], v[64:79]
    s_waitcnt lgkmcnt(6)
    ds_read_b64_tr_b16 a[172:173], v4 offset:3136
    ds_read_b64_tr_b16 a[174:175], v4 offset:3648
    buffer_load_dwordx4 v[156:159], v2, s[20:23], s73 offen offset:3072 sc1
    v_and_b32 v23, s69, v117
    v_lshlrev_b32 v24, 16, v118
    v_and_b32 v25, s69, v118
    v_lshlrev_b32 v26, 16, v119
    v_and_b32 v27, s69, v119
    v_fma_f32 v20, v20, v16, v17
    v_fma_f32 v21, v21, v16, v17
    v_fma_f32 v22, v22, v16, v17
    v_fma_f32 v23, v23, v16, v17
    v_fma_f32 v24, v24, v16, v17
    v_fma_f32 v25, v25, v16, v17
    v_fma_f32 v26, v26, v16, v17
    v_fma_f32 v27, v27, v16, v17
    v_cvt_pk_bf16_f32 v116, v20, v21
    v_cvt_pk_bf16_f32 v117, v22, v23
    v_cvt_pk_bf16_f32 v118, v24, v25
    v_cvt_pk_bf16_f32 v119, v26, v27
    s_nop 1
    v_mfma_f32_32x32x16_bf16 v[48:63], a[152:155], v[116:119], v[48:63]
    ds_read_b64_tr_b16 a[144:145], v4 offset:4096
    ds_read_b64_tr_b16 a[146:147], v4 offset:4608
    s_add_u32 s73, s46, 12288
    buffer_load_dwordx4 v[160:163], v2, s[20:23], s73 offen offset:0 sc1
    s_waitcnt vmcnt(9)
    v_lshlrev_b32 v20, 16, v120
    v_and_b32 v21, s69, v120
    v_lshlrev_b32 v22, 16, v121
    v_mfma_f32_32x32x16_bf16 v[64:79], a[156:159], v[116:119], v[64:79]
    s_waitcnt lgkmcnt(6)
    ds_read_b64_tr_b16 a[148:149], v4 offset:4160
    ds_read_b64_tr_b16 a[150:151], v4 offset:4672
    ds_read_b128 v[80:83], v15 offset:256
    ds_read_b128 v[84:87], v15 offset:288
    buffer_load_dwordx4 v[164:167], v2, s[20:23], s73 offen offset:1024 sc1
    v_and_b32 v23, s69, v121
    v_lshlrev_b32 v24, 16, v122
    v_and_b32 v25, s69, v122
    v_lshlrev_b32 v26, 16, v123
    v_and_b32 v27, s69, v123
    v_fma_f32 v20, v20, v16, v17
    v_fma_f32 v21, v21, v16, v17
    v_fma_f32 v22, v22, v16, v17
    v_fma_f32 v23, v23, v16, v17
    v_fma_f32 v24, v24, v16, v17
    v_fma_f32 v25, v25, v16, v17
    v_fma_f32 v26, v26, v16, v17
    v_fma_f32 v27, v27, v16, v17
    v_cvt_pk_bf16_f32 v120, v20, v21
    v_cvt_pk_bf16_f32 v121, v22, v23
    v_cvt_pk_bf16_f32 v122, v24, v25
    v_cvt_pk_bf16_f32 v123, v26, v27
    s_nop 1
    v_mfma_f32_32x32x16_bf16 v[48:63], a[160:163], v[120:123], v[48:63]
    ds_read_b64_tr_b16 a[152:153], v4 offset:5120
    ds_read_b64_tr_b16 a[154:155], v4 offset:5632
    ds_read_b128 v[88:91], v15 offset:320
    ds_read_b128 v[92:95], v15 offset:352
    buffer_load_dwordx4 v[168:171], v2, s[20:23], s73 offen offset:2048 sc1
    v_lshlrev_b32 v20, 16, v124
    v_mfma_f32_32x32x16_bf16 v[64:79], a[164:167], v[120:123], v[64:79]
    s_waitcnt lgkmcnt(10)
    ds_read_b64_tr_b16 a[156:157], v4 offset:5184
    ds_read_b64_tr_b16 a[158:159], v4 offset:5696
    buffer_load_dwordx4 v[172:175], v2, s[20:23], s73 offen offset:3072 sc1
    v_and_b32 v21, s69, v124
    v_lshlrev_b32 v22, 16, v125
    v_and_b32 v23, s69, v125
    v_lshlrev_b32 v24, 16, v126
    v_and_b32 v25, s69, v126
    v_lshlrev_b32 v26, 16, v127
    v_and_b32 v27, s69, v127
    v_fma_f32 v20, v20, v16, v17
    v_fma_f32 v21, v21, v16, v17
    v_fma_f32 v22, v22, v16, v17
    v_fma_f32 v23, v23, v16, v17
    v_fma_f32 v24, v24, v16, v17
    v_fma_f32 v25, v25, v16, v17
    v_fma_f32 v26, v26, v16, v17
    v_fma_f32 v27, v27, v16, v17
    v_cvt_pk_bf16_f32 v124, v20, v21
    v_cvt_pk_bf16_f32 v125, v22, v23
    v_cvt_pk_bf16_f32 v126, v24, v25
    v_cvt_pk_bf16_f32 v127, v26, v27
    s_nop 1
    v_mfma_f32_32x32x16_bf16 v[48:63], a[168:171], v[124:127], v[48:63]
    ds_read_b64_tr_b16 a[160:161], v4 offset:6144
    ds_read_b64_tr_b16 a[162:163], v4 offset:6656
    s_add_u32 s73, s46, 16384
    buffer_load_dwordx4 v[176:179], v2, s[20:23], s73 offen offset:0 sc1
    s_waitcnt vmcnt(11)
    v_lshlrev_b32 v20, 16, v128
    v_and_b32 v21, s69, v128
    v_lshlrev_b32 v22, 16, v129
    v_mfma_f32_32x32x16_bf16 v[64:79], a[172:175], v[124:127], v[64:79]
    s_waitcnt lgkmcnt(10)
    ds_read_b64_tr_b16 a[164:165], v4 offset:6208
    ds_read_b64_tr_b16 a[166:167], v4 offset:6720
    ds_read_b128 v[96:99], v15 offset:384
    ds_read_b128 v[100:103], v15 offset:416
    buffer_load_dwordx4 v[180:183], v2, s[20:23], s73 offen offset:1024 sc1
    v_and_b32 v23, s69, v129
    v_lshlrev_b32 v24, 16, v130
    v_and_b32 v25, s69, v130
    v_lshlrev_b32 v26, 16, v131
    v_and_b32 v27, s69, v131
    v_fma_f32 v20, v20, v16, v17
    v_fma_f32 v21, v21, v16, v17
    v_fma_f32 v22, v22, v16, v17
    v_fma_f32 v23, v23, v16, v17
    v_fma_f32 v24, v24, v16, v17
    v_fma_f32 v25, v25, v16, v17
    v_fma_f32 v26, v26, v16, v17
    v_fma_f32 v27, v27, v16, v17
    v_cvt_pk_bf16_f32 v128, v20, v21
    v_cvt_pk_bf16_f32 v129, v22, v23
    v_cvt_pk_bf16_f32 v130, v24, v25
    v_cvt_pk_bf16_f32 v131, v26, v27
    s_nop 1
    v_mfma_f32_32x32x16_bf16 v[48:63], a[144:147], v[128:131], v[48:63]
    ds_read_b64_tr_b16 a[168:169], v4 offset:7168
    ds_read_b64_tr_b16 a[170:171], v4 offset:7680
    ds_read_b128 v[104:107], v15 offset:448
    ds_read_b128 v[108:111], v15 offset:480
    buffer_load_dwordx4 v[184:187], v2, s[20:23], s73 offen offset:2048 sc1
    v_lshlrev_b32 v20, 16, v132
    v_mfma_f32_32x32x16_bf16 v[64:79], a[148:151], v[128:131], v[64:79]
    s_waitcnt lgkmcnt(10)
    ds_read_b64_tr_b16 a[172:173], v4 offset:7232
    ds_read_b64_tr_b16 a[174:175], v4 offset:7744
    buffer_load_dwordx4 v[188:191], v2, s[20:23], s73 offen offset:3072 sc1
    v_and_b32 v21, s69, v132
    v_lshlrev_b32 v22, 16, v133
    v_and_b32 v23, s69, v133
    v_lshlrev_b32 v24, 16, v134
    v_and_b32 v25, s69, v134
    v_lshlrev_b32 v26, 16, v135
    v_and_b32 v27, s69, v135
    v_fma_f32 v20, v20, v16, v17
    v_fma_f32 v21, v21, v16, v17
    v_fma_f32 v22, v22, v16, v17
    v_fma_f32 v23, v23, v16, v17
    v_fma_f32 v24, v24, v16, v17
    v_fma_f32 v25, v25, v16, v17
    v_fma_f32 v26, v26, v16, v17
    v_fma_f32 v27, v27, v16, v17
    v_cvt_pk_bf16_f32 v132, v20, v21
    v_cvt_pk_bf16_f32 v133, v22, v23
    v_cvt_pk_bf16_f32 v134, v24, v25
    v_cvt_pk_bf16_f32 v135, v26, v27
    s_nop 1
    v_mfma_f32_32x32x16_bf16 v[48:63], a[152:155], v[132:135], v[48:63]
    ds_read_b64_tr_b16 a[144:145], v4 offset:8192
    ds_read_b64_tr_b16 a[146:147], v4 offset:8704
    s_add_u32 s73, s46, 20480
    buffer_load_dwordx4 v[192:195], v2, s[20:23], s73 offen offset:0 sc1
    s_waitcnt vmcnt(13)
    v_lshlrev_b32 v20, 16, v136
    v_and_b32 v21, s69, v136
    v_lshlrev_b32 v22, 16, v137
    v_mfma_f32_32x32x16_bf16 v[64:79], a[156:159], v[132:135], v[64:79]
    s_waitcnt lgkmcnt(10)
    ds_read_b64_tr_b16 a[148:149], v4 offset:8256
    ds_read_b64_tr_b16 a[150:151], v4 offset:8768
    buffer_load_dwordx4 v[196:199], v2, s[20:23], s73 offen offset:1024 sc1
    v_and_b32 v23, s69, v137
    v_lshlrev_b32 v24, 16, v138
    v_and_b32 v25, s69, v138
    v_lshlrev_b32 v26, 16, v139
    v_and_b32 v27, s69, v139
    v_fma_f32 v20, v20, v16, v17
    v_fma_f32 v21, v21, v16, v17
    v_fma_f32 v22, v22, v16, v17
    v_fma_f32 v23, v23, v16, v17
    v_fma_f32 v24, v24, v16, v17
    v_fma_f32 v25, v25, v16, v17
    v_fma_f32 v26, v26, v16, v17
    v_fma_f32 v27, v27, v16, v17
    v_cvt_pk_bf16_f32 v136, v20, v21
    v_cvt_pk_bf16_f32 v137, v22, v23
    v_cvt_pk_bf16_f32 v138, v24, v25
    v_cvt_pk_bf16_f32 v139, v26, v27
    s_nop 1
    v_mfma_f32_32x32x16_bf16 v[48:63], a[160:163], v[136:139], v[48:63]
    ds_read_b64_tr_b16 a[152:153], v4 offset:9216
    ds_read_b64_tr_b16 a[154:155], v4 offset:9728
    buffer_load_dwordx4 v[200:203], v2, s[20:23], s73 offen offset:2048 sc1
    v_lshlrev_b32 v20, 16, v140
    v_and_b32 v21, s69, v140
    v_lshlrev_b32 v22, 16, v141
    v_mfma_f32_32x32x16_bf16 v[64:79], a[164:167], v[136:139], v[64:79]
    s_waitcnt lgkmcnt(6)
    ds_read_b64_tr_b16 a[156:157], v4 offset:9280
    ds_read_b64_tr_b16 a[158:159], v4 offset:9792
    buffer_load_dwordx4 v[204:207], v2, s[20:23], s73 offen offset:3072 sc1
    v_and_b32 v23, s69, v141
    v_lshlrev_b32 v24, 16, v142
    v_and_b32 v25, s69, v142
    v_lshlrev_b32 v26, 16, v143
    v_and_b32 v27, s69, v143
    v_fma_f32 v20, v20, v16, v17
    v_fma_f32 v21, v21, v16, v17
    v_fma_f32 v22, v22, v16, v17
    v_fma_f32 v23, v23, v16, v17
    v_fma_f32 v24, v24, v16, v17
    v_fma_f32 v25, v25, v16, v17
    v_fma_f32 v26, v26, v16, v17
    v_fma_f32 v27, v27, v16, v17
    v_cvt_pk_bf16_f32 v140, v20, v21
    v_cvt_pk_bf16_f32 v141, v22, v23
    v_cvt_pk_bf16_f32 v142, v24, v25
    v_cvt_pk_bf16_f32 v143, v26, v27
    s_nop 1
    v_mfma_f32_32x32x16_bf16 v[48:63], a[168:171], v[140:143], v[48:63]
    ds_read_b64_tr_b16 a[160:161], v4 offset:10240
    ds_read_b64_tr_b16 a[162:163], v4 offset:10752
    s_add_u32 s73, s46, 24576
    buffer_load_dwordx4 v[208:211], v2, s[20:23], s73 offen offset:0 sc1
    s_waitcnt vmcnt(15)
    v_lshlrev_b32 v20, 16, v144
    v_and_b32 v21, s69, v144
    v_lshlrev_b32 v22, 16, v145
    v_mfma_f32_32x32x16_bf16 v[64:79], a[172:175], v[140:143], v[64:79]
    s_waitcnt lgkmcnt(6)
    ds_read_b64_tr_b16 a[164:165], v4 offset:10304
    ds_read_b64_tr_b16 a[166:167], v4 offset:10816
    buffer_load_dwordx4 v[212:215], v2, s[20:23], s73 offen offset:1024 sc1
    v_and_b32 v23, s69, v145
    v_lshlrev_b32 v24, 16, v146
    v_and_b32 v25, s69, v146
    v_lshlrev_b32 v26, 16, v147
    v_and_b32 v27, s69, v147
    v_fma_f32 v20, v20, v16, v17
    v_fma_f32 v21, v21, v16, v17
    v_fma_f32 v22, v22, v16, v17
    v_fma_f32 v23, v23, v16, v17
    v_fma_f32 v24, v24, v16, v17
    v_fma_f32 v25, v25, v16, v17
    v_fma_f32 v26, v26, v16, v17
    v_fma_f32 v27, v27, v16, v17
    v_cvt_pk_bf16_f32 v144, v20, v21
    v_cvt_pk_bf16_f32 v145, v22, v23
    v_cvt_pk_bf16_f32 v146, v24, v25
    v_cvt_pk_bf16_f32 v147, v26, v27
    s_nop 1
    v_mfma_f32_32x32x16_bf16 v[48:63], a[144:147], v[144:147], v[48:63]
    ds_read_b64_tr_b16 a[168:169], v4 offset:11264
    ds_read_b64_tr_b16 a[170:171], v4 offset:11776
    buffer_load_dwordx4 v[216:219], v2, s[20:23], s73 offen offset:2048 sc1
    v_lshlrev_b32 v20, 16, v148
    v_and_b32 v21, s69, v148
    v_lshlrev_b32 v22, 16, v149
    v_mfma_f32_32x32x16_bf16 v[64:79], a[148:151], v[144:147], v[64:79]
    s_waitcnt lgkmcnt(6)
    ds_read_b64_tr_b16 a[172:173], v4 offset:11328
    ds_read_b64_tr_b16 a[174:175], v4 offset:11840
    buffer_load_dwordx4 v[220:223], v2, s[20:23], s73 offen offset:3072 sc1
    v_and_b32 v23, s69, v149
    v_lshlrev_b32 v24, 16, v150
    v_and_b32 v25, s69, v150
    v_lshlrev_b32 v26, 16, v151
    v_and_b32 v27, s69, v151
    v_fma_f32 v20, v20, v16, v17
    v_fma_f32 v21, v21, v16, v17
    v_fma_f32 v22, v22, v16, v17
    v_fma_f32 v23, v23, v16, v17
    v_fma_f32 v24, v24, v16, v17
    v_fma_f32 v25, v25, v16, v17
    v_fma_f32 v26, v26, v16, v17
    v_fma_f32 v27, v27, v16, v17
    v_cvt_pk_bf16_f32 v148, v20, v21
    v_cvt_pk_bf16_f32 v149, v22, v23
    v_cvt_pk_bf16_f32 v150, v24, v25
    v_cvt_pk_bf16_f32 v151, v26, v27
    s_nop 1
    v_mfma_f32_32x32x16_bf16 v[48:63], a[152:155], v[148:151], v[48:63]
    ds_read_b64_tr_b16 a[144:145], v4 offset:12288
    ds_read_b64_tr_b16 a[146:147], v4 offset:12800
    s_add_u32 s73, s46, 28672
    buffer_load_dwordx4 v[224:227], v2, s[20:23], s73 offen offset:0 sc1
    s_waitcnt vmcnt(17)
    v_lshlrev_b32 v20, 16, v152
    v_and_b32 v21, s69, v152
    v_lshlrev_b32 v22, 16, v153
    v_mfma_f32_32x32x16_bf16 v[64:79], a[156:159], v[148:151], v[64:79]
    s_waitcnt lgkmcnt(6)
    ds_read_b64_tr_b16 a[148:149], v4 offset:12352
    ds_read_b64_tr_b16 a[150:151], v4 offset:12864
    buffer_load_dwordx4 v[228:231], v2, s[20:23], s73 offen offset:1024 sc1
    v_and_b32 v23, s69, v153
    v_lshlrev_b32 v24, 16, v154
    v_and_b32 v25, s69, v154
    v_lshlrev_b32 v26, 16, v155
    v_and_b32 v27, s69, v155
    v_fma_f32 v20, v20, v16, v17
    v_fma_f32 v21, v21, v16, v17
    v_fma_f32 v22, v22, v16, v17
    v_fma_f32 v23, v23, v16, v17
    v_fma_f32 v24, v24, v16, v17
    v_fma_f32 v25, v25, v16, v17
    v_fma_f32 v26, v26, v16, v17
    v_fma_f32 v27, v27, v16, v17
    v_cvt_pk_bf16_f32 v152, v20, v21
    v_cvt_pk_bf16_f32 v153, v22, v23
    v_cvt_pk_bf16_f32 v154, v24, v25
    v_cvt_pk_bf16_f32 v155, v26, v27
    s_nop 1
    v_mfma_f32_32x32x16_bf16 v[48:63], a[160:163], v[152:155], v[48:63]
    ds_read_b64_tr_b16 a[152:153], v4 offset:13312
    ds_read_b64_tr_b16 a[154:155], v4 offset:13824
    buffer_load_dwordx4 v[232:235], v2, s[20:23], s73 offen offset:2048 sc1
    v_lshlrev_b32 v20, 16, v156
    v_and_b32 v21, s69, v156
    v_lshlrev_b32 v22, 16, v157
    v_mfma_f32_32x32x16_bf16 v[64:79], a[164:167], v[152:155], v[64:79]
    s_waitcnt lgkmcnt(6)
    ds_read_b64_tr_b16 a[156:157], v4 offset:13376
    ds_read_b64_tr_b16 a[158:159], v4 offset:13888
    buffer_load_dwordx4 v[236:239], v2, s[20:23], s73 offen offset:3072 sc1
    v_and_b32 v23, s69, v157
    v_lshlrev_b32 v24, 16, v158
    v_and_b32 v25, s69, v158
    v_lshlrev_b32 v26, 16, v159
    v_and_b32 v27, s69, v159
    v_fma_f32 v20, v20, v16, v17
    v_fma_f32 v21, v21, v16, v17
    v_fma_f32 v22, v22, v16, v17
    v_fma_f32 v23, v23, v16, v17
    v_fma_f32 v24, v24, v16, v17
    v_fma_f32 v25, v25, v16, v17
    v_fma_f32 v26, v26, v16, v17
    v_fma_f32 v27, v27, v16, v17
    v_cvt_pk_bf16_f32 v156, v20, v21
    v_cvt_pk_bf16_f32 v157, v22, v23
    v_cvt_pk_bf16_f32 v158, v24, v25
    v_cvt_pk_bf16_f32 v159, v26, v27
    s_nop 1
    v_mfma_f32_32x32x16_bf16 v[48:63], a[168:171], v[156:159], v[48:63]
    ds_read_b64_tr_b16 a[160:161], v4 offset:14336
    ds_read_b64_tr_b16 a[162:163], v4 offset:14848
    s_add_u32 s73, s46, 32768
    buffer_load_dwordx4 v[240:243], v2, s[20:23], s73 offen offset:0 sc1
    s_waitcnt vmcnt(19)
    v_lshlrev_b32 v20, 16, v160
    v_and_b32 v21, s69, v160
    v_lshlrev_b32 v22, 16, v161
    v_mfma_f32_32x32x16_bf16 v[64:79], a[172:175], v[156:159], v[64:79]
    s_waitcnt lgkmcnt(6)
    ds_read_b64_tr_b16 a[164:165], v4 offset:14400
    ds_read_b64_tr_b16 a[166:167], v4 offset:14912
    buffer_load_dwordx4 v[244:247], v2, s[20:23], s73 offen offset:1024 sc1
    v_and_b32 v23, s69, v161
    v_lshlrev_b32 v24, 16, v162
    v_and_b32 v25, s69, v162
    v_lshlrev_b32 v26, 16, v163
    v_and_b32 v27, s69, v163
    v_fma_f32 v20, v20, v16, v17
    v_fma_f32 v21, v21, v16, v17
    v_fma_f32 v22, v22, v16, v17
    v_fma_f32 v23, v23, v16, v17
    v_fma_f32 v24, v24, v16, v17
    v_fma_f32 v25, v25, v16, v17
    v_fma_f32 v26, v26, v16, v17
    v_fma_f32 v27, v27, v16, v17
    v_cvt_pk_bf16_f32 v160, v20, v21
    v_cvt_pk_bf16_f32 v161, v22, v23
    v_cvt_pk_bf16_f32 v162, v24, v25
    v_cvt_pk_bf16_f32 v163, v26, v27
    s_nop 1
    v_mfma_f32_32x32x16_bf16 v[48:63], a[144:147], v[160:163], v[48:63]
    ds_read_b64_tr_b16 a[168:169], v4 offset:15360
    ds_read_b64_tr_b16 a[170:171], v4 offset:15872
    buffer_load_dwordx4 v[248:251], v2, s[20:23], s73 offen offset:2048 sc1
    v_lshlrev_b32 v20, 16, v164
    v_and_b32 v21, s69, v164
    v_lshlrev_b32 v22, 16, v165
    v_mfma_f32_32x32x16_bf16 v[64:79], a[148:151], v[160:163], v[64:79]
    s_waitcnt lgkmcnt(6)
    ds_read_b64_tr_b16 a[172:173], v4 offset:15424
    ds_read_b64_tr_b16 a[174:175], v4 offset:15936
    buffer_load_dwordx4 v[252:255], v2, s[20:23], s73 offen offset:3072 sc1
    v_and_b32 v23, s69, v165
    v_lshlrev_b32 v24, 16, v166
    v_and_b32 v25, s69, v166
    v_lshlrev_b32 v26, 16, v167
    v_and_b32 v27, s69, v167
    v_fma_f32 v20, v20, v16, v17
    v_fma_f32 v21, v21, v16, v17
    v_fma_f32 v22, v22, v16, v17
    v_fma_f32 v23, v23, v16, v17
    v_fma_f32 v24, v24, v16, v17
    v_fma_f32 v25, v25, v16, v17
    v_fma_f32 v26, v26, v16, v17
    v_fma_f32 v27, v27, v16, v17
    v_cvt_pk_bf16_f32 v164, v20, v21
    v_cvt_pk_bf16_f32 v165, v22, v23
    v_cvt_pk_bf16_f32 v166, v24, v25
    v_cvt_pk_bf16_f32 v167, v26, v27
    s_nop 1
    v_mfma_f32_32x32x16_bf16 v[48:63], a[152:155], v[164:167], v[48:63]
    ds_read_b64_tr_b16 a[144:145], v4 offset:16384
    ds_read_b64_tr_b16 a[146:147], v4 offset:16896
    s_waitcnt vmcnt(20)
    v_lshlrev_b32 v20, 16, v168
    v_and_b32 v21, s69, v168
    v_lshlrev_b32 v22, 16, v169
    v_and_b32 v23, s69, v169
    v_lshlrev_b32 v24, 16, v170
    v_mfma_f32_32x32x16_bf16 v[64:79], a[156:159], v[164:167], v[64:79]
    s_waitcnt lgkmcnt(6)
    ds_read_b64_tr_b16 a[148:149], v4 offset:16448
    ds_read_b64_tr_b16 a[150:151], v4 offset:16960
    v_and_b32 v25, s69, v170
    v_lshlrev_b32 v26, 16, v171
    v_and_b32 v27, s69, v171
    v_fma_f32 v20, v20, v16, v17
    v_fma_f32 v21, v21, v16, v17
    v_fma_f32 v22, v22, v16, v17
    v_fma_f32 v23, v23, v16, v17
    v_fma_f32 v24, v24, v16, v17
    v_fma_f32 v25, v25, v16, v17
    v_fma_f32 v26, v26, v16, v17
    v_fma_f32 v27, v27, v16, v17
    v_cvt_pk_bf16_f32 v168, v20, v21
    v_cvt_pk_bf16_f32 v169, v22, v23
    v_cvt_pk_bf16_f32 v170, v24, v25
    v_cvt_pk_bf16_f32 v171, v26, v27
    s_nop 1
    v_mfma_f32_32x32x16_bf16 v[48:63], a[160:163], v[168:171], v[48:63]
    ds_read_b64_tr_b16 a[152:153], v4 offset:17408
    ds_read_b64_tr_b16 a[154:155], v4 offset:17920
    v_lshlrev_b32 v20, 16, v172
    v_and_b32 v21, s69, v172
    v_lshlrev_b32 v22, 16, v173
    v_and_b32 v23, s69, v173
    v_lshlrev_b32 v24, 16, v174
    v_mfma_f32_32x32x16_bf16 v[64:79], a[164:167], v[168:171], v[64:79]
    s_waitcnt lgkmcnt(6)
    ds_read_b64_tr_b16 a[156:157], v4 offset:17472
    ds_read_b64_tr_b16 a[158:159], v4 offset:17984
    v_and_b32 v25, s69, v174
    v_lshlrev_b32 v26, 16, v175
    v_and_b32 v27, s69, v175
    v_fma_f32 v20, v20, v16, v17
    v_fma_f32 v21, v21, v16, v17
    v_fma_f32 v22, v22, v16, v17
    v_fma_f32 v23, v23, v16, v17
    v_fma_f32 v24, v24, v16, v17
    v_fma_f32 v25, v25, v16, v17
    v_fma_f32 v26, v26, v16, v17
    v_fma_f32 v27, v27, v16, v17
    v_cvt_pk_bf16_f32 v172, v20, v21
    v_cvt_pk_bf16_f32 v173, v22, v23
    v_cvt_pk_bf16_f32 v174, v24, v25
    v_cvt_pk_bf16_f32 v175, v26, v27
    s_nop 1
    v_mfma_f32_32x32x16_bf16 v[48:63], a[168:171], v[172:175], v[48:63]
    s_barrier
    ds_read_b64_tr_b16 a[160:161], v5 offset:0
    ds_read_b64_tr_b16 a[162:163], v5 offset:512
    s_waitcnt vmcnt(18)
    v_mfma_f32_32x32x16_bf16 v[64:79], a[172:175], v[172:175], v[64:79]
    s_waitcnt lgkmcnt(6)
    ds_read_b64_tr_b16 a[164:165], v5 offset:64
    ds_read_b64_tr_b16 a[166:167], v5 offset:576
    v_lshlrev_b32 v20, 16, v176
    v_and_b32 v21, s69, v176
    v_lshlrev_b32 v22, 16, v177
    v_and_b32 v23, s69, v177
    v_lshlrev_b32 v24, 16, v178
    v_and_b32 v25, s69, v178
    v_lshlrev_b32 v26, 16, v179
    v_and_b32 v27, s69, v179
    v_fma_f32 v20, v20, v16, v17
    v_fma_f32 v21, v21, v16, v17
    v_fma_f32 v22, v22, v16, v17
    v_fma_f32 v23, v23, v16, v17
    v_fma_f32 v24, v24, v16, v17
    v_fma_f32 v25, v25, v16, v17
    v_fma_f32 v26, v26, v16, v17
    v_fma_f32 v27, v27, v16, v17
    v_cvt_pk_bf16_f32 v176, v20, v21
    v_cvt_pk_bf16_f32 v177, v22, v23
    v_cvt_pk_bf16_f32 v178, v24, v25
    v_cvt_pk_bf16_f32 v179, v26, v27
    s_nop 1
    v_mfma_f32_32x32x16_bf16 v[48:63], a[144:147], v[176:179], v[48:63]
    s_add_u32 m0, s44, 110976
    ds_read_b64_tr_b16 a[168:169], v5 offset:1024
    ds_read_b64_tr_b16 a[170:171], v5 offset:1536
    s_add_u32 s58, s42, 2654336
    buffer_load_dwordx4 v9, s[12:15], s58 offen lds
    v_lshlrev_b32 v20, 16, v180
    v_mfma_f32_32x32x16_bf16 v[64:79], a[148:151], v[176:179], v[64:79]
    s_waitcnt lgkmcnt(6)
    ds_read_b64_tr_b16 a[172:173], v5 offset:1088
    ds_read_b64_tr_b16 a[174:175], v5 offset:1600
    v_and_b32 v21, s69, v180
    v_lshlrev_b32 v22, 16, v181
    v_and_b32 v23, s69, v181
    v_lshlrev_b32 v24, 16, v182
    v_and_b32 v25, s69, v182
    v_lshlrev_b32 v26, 16, v183
    v_and_b32 v27, s69, v183
    v_fma_f32 v20, v20, v16, v17
    v_fma_f32 v21, v21, v16, v17
    v_fma_f32 v22, v22, v16, v17
    v_fma_f32 v23, v23, v16, v17
    v_fma_f32 v24, v24, v16, v17
    v_fma_f32 v25, v25, v16, v17
    v_fma_f32 v26, v26, v16, v17
    v_fma_f32 v27, v27, v16, v17
    v_cvt_pk_bf16_f32 v180, v20, v21
    v_cvt_pk_bf16_f32 v181, v22, v23
    v_cvt_pk_bf16_f32 v182, v24, v25
    v_cvt_pk_bf16_f32 v183, v26, v27
    s_nop 1
    v_mfma_f32_32x32x16_bf16 v[48:63], a[152:155], v[180:183], v[48:63]
    s_add_u32 m0, s44, 113024
    ds_read_b64_tr_b16 a[144:145], v5 offset:2048
    ds_read_b64_tr_b16 a[146:147], v5 offset:2560
    s_waitcnt vmcnt(17)
    v_lshlrev_b32 v20, 16, v184
    v_and_b32 v21, s69, v184
    v_lshlrev_b32 v22, 16, v185
    v_and_b32 v23, s69, v185
    v_lshlrev_b32 v24, 16, v186
    v_mfma_f32_32x32x16_bf16 v[64:79], a[156:159], v[180:183], v[64:79]
    s_waitcnt lgkmcnt(6)
    ds_read_b64_tr_b16 a[148:149], v5 offset:2112
    ds_read_b64_tr_b16 a[150:151], v5 offset:2624
    v_and_b32 v25, s69, v186
    v_lshlrev_b32 v26, 16, v187
    v_and_b32 v27, s69, v187
    v_fma_f32 v20, v20, v16, v17
    v_fma_f32 v21, v21, v16, v17
    v_fma_f32 v22, v22, v16, v17
    v_fma_f32 v23, v23, v16, v17
    v_fma_f32 v24, v24, v16, v17
    v_fma_f32 v25, v25, v16, v17
    v_fma_f32 v26, v26, v16, v17
    v_fma_f32 v27, v27, v16, v17
    v_cvt_pk_bf16_f32 v184, v20, v21
    v_cvt_pk_bf16_f32 v185, v22, v23
    v_cvt_pk_bf16_f32 v186, v24, v25
    v_cvt_pk_bf16_f32 v187, v26, v27
    s_nop 1
    v_mfma_f32_32x32x16_bf16 v[48:63], a[160:163], v[184:187], v[48:63]
    s_add_u32 s58, s42, 2949248
    ds_read_b64_tr_b16 a[152:153], v5 offset:3072
    ds_read_b64_tr_b16 a[154:155], v5 offset:3584
    buffer_load_dwordx4 v9, s[12:15], s58 offen lds
    v_lshlrev_b32 v20, 16, v188
    v_and_b32 v21, s69, v188
    v_mfma_f32_32x32x16_bf16 v[64:79], a[164:167], v[184:187], v[64:79]
    s_waitcnt lgkmcnt(6)
    ds_read_b64_tr_b16 a[156:157], v5 offset:3136
    ds_read_b64_tr_b16 a[158:159], v5 offset:3648
    v_lshlrev_b32 v22, 16, v189
    v_and_b32 v23, s69, v189
    v_lshlrev_b32 v24, 16, v190
    v_and_b32 v25, s69, v190
    v_lshlrev_b32 v26, 16, v191
    v_and_b32 v27, s69, v191
    v_fma_f32 v20, v20, v16, v17
    v_fma_f32 v21, v21, v16, v17
    v_fma_f32 v22, v22, v16, v17
    v_fma_f32 v23, v23, v16, v17
    v_fma_f32 v24, v24, v16, v17
    v_fma_f32 v25, v25, v16, v17
    v_fma_f32 v26, v26, v16, v17
    v_fma_f32 v27, v27, v16, v17
    v_cvt_pk_bf16_f32 v188, v20, v21
    v_cvt_pk_bf16_f32 v189, v22, v23
    v_cvt_pk_bf16_f32 v190, v24, v25
    v_cvt_pk_bf16_f32 v191, v26, v27
    s_nop 1
    v_mfma_f32_32x32x16_bf16 v[48:63], a[168:171], v[188:191], v[48:63]
    s_add_u32 m0, s44, 115072
    ds_read_b64_tr_b16 a[160:161], v5 offset:4096
    ds_read_b64_tr_b16 a[162:163], v5 offset:4608
    s_waitcnt vmcnt(16)
    v_lshlrev_b32 v20, 16, v192
    v_and_b32 v21, s69, v192
    v_lshlrev_b32 v22, 16, v193
    v_and_b32 v23, s69, v193
    v_lshlrev_b32 v24, 16, v194
    v_mfma_f32_32x32x16_bf16 v[64:79], a[172:175], v[188:191], v[64:79]
    s_waitcnt lgkmcnt(6)
    ds_read_b64_tr_b16 a[164:165], v5 offset:4160
    ds_read_b64_tr_b16 a[166:167], v5 offset:4672
    v_and_b32 v25, s69, v194
    v_lshlrev_b32 v26, 16, v195
    v_and_b32 v27, s69, v195
    v_fma_f32 v20, v20, v16, v17
    v_fma_f32 v21, v21, v16, v17
    v_fma_f32 v22, v22, v16, v17
    v_fma_f32 v23, v23, v16, v17
    v_fma_f32 v24, v24, v16, v17
    v_fma_f32 v25, v25, v16, v17
    v_fma_f32 v26, v26, v16, v17
    v_fma_f32 v27, v27, v16, v17
    v_cvt_pk_bf16_f32 v192, v20, v21
    v_cvt_pk_bf16_f32 v193, v22, v23
    v_cvt_pk_bf16_f32 v194, v24, v25
    v_cvt_pk_bf16_f32 v195, v26, v27
    s_nop 1
    v_mfma_f32_32x32x16_bf16 v[48:63], a[144:147], v[192:195], v[48:63]
    s_add_u32 s58, s42, 3244160
    ds_read_b64_tr_b16 a[168:169], v5 offset:5120
    ds_read_b64_tr_b16 a[170:171], v5 offset:5632
    buffer_load_dwordx4 v9, s[12:15], s58 offen lds
    v_lshlrev_b32 v20, 16, v196
    v_and_b32 v21, s69, v196
    v_mfma_f32_32x32x16_bf16 v[64:79], a[148:151], v[192:195], v[64:79]
    s_waitcnt lgkmcnt(6)
    ds_read_b64_tr_b16 a[172:173], v5 offset:5184
    ds_read_b64_tr_b16 a[174:175], v5 offset:5696
    v_lshlrev_b32 v22, 16, v197
    v_and_b32 v23, s69, v197
    v_lshlrev_b32 v24, 16, v198
    v_and_b32 v25, s69, v198
    v_lshlrev_b32 v26, 16, v199
    v_and_b32 v27, s69, v199
    v_fma_f32 v20, v20, v16, v17
    v_fma_f32 v21, v21, v16, v17
    v_fma_f32 v22, v22, v16, v17
    v_fma_f32 v23, v23, v16, v17
    v_fma_f32 v24, v24, v16, v17
    v_fma_f32 v25, v25, v16, v17
    v_fma_f32 v26, v26, v16, v17
    v_fma_f32 v27, v27, v16, v17
    v_cvt_pk_bf16_f32 v196, v20, v21
    v_cvt_pk_bf16_f32 v197, v22, v23
    v_cvt_pk_bf16_f32 v198, v24, v25
    v_cvt_pk_bf16_f32 v199, v26, v27
    s_nop 1
    v_mfma_f32_32x32x16_bf16 v[48:63], a[152:155], v[196:199], v[48:63]
    s_add_u32 m0, s44, 117120
    ds_read_b64_tr_b16 a[144:145], v5 offset:6144
    ds_read_b64_tr_b16 a[146:147], v5 offset:6656
    s_waitcnt vmcnt(15)
    v_lshlrev_b32 v20, 16, v200
    v_and_b32 v21, s69, v200
    v_lshlrev_b32 v22, 16, v201
    v_and_b32 v23, s69, v201
    v_lshlrev_b32 v24, 16, v202
    v_mfma_f32_32x32x16_bf16 v[64:79], a[156:159], v[196:199], v[64:79]
    s_waitcnt lgkmcnt(6)
    ds_read_b64_tr_b16 a[148:149], v5 offset:6208
    ds_read_b64_tr_b16 a[150:151], v5 offset:6720
    v_and_b32 v25, s69, v202
    v_lshlrev_b32 v26, 16, v203
    v_and_b32 v27, s69, v203
    v_fma_f32 v20, v20, v16, v17
    v_fma_f32 v21, v21, v16, v17
    v_fma_f32 v22, v22, v16, v17
    v_fma_f32 v23, v23, v16, v17
    v_fma_f32 v24, v24, v16, v17
    v_fma_f32 v25, v25, v16, v17
    v_fma_f32 v26, v26, v16, v17
    v_fma_f32 v27, v27, v16, v17
    v_cvt_pk_bf16_f32 v200, v20, v21
    v_cvt_pk_bf16_f32 v201, v22, v23
    v_cvt_pk_bf16_f32 v202, v24, v25
    v_cvt_pk_bf16_f32 v203, v26, v27
    s_nop 1
    v_mfma_f32_32x32x16_bf16 v[48:63], a[160:163], v[200:203], v[48:63]
    s_add_u32 s58, s42, 3539072
    ds_read_b64_tr_b16 a[152:153], v5 offset:7168
    ds_read_b64_tr_b16 a[154:155], v5 offset:7680
    buffer_load_dwordx4 v9, s[12:15], s58 offen lds
    v_lshlrev_b32 v20, 16, v204
    v_and_b32 v21, s69, v204
    v_mfma_f32_32x32x16_bf16 v[64:79], a[164:167], v[200:203], v[64:79]
    s_waitcnt lgkmcnt(6)
    ds_read_b64_tr_b16 a[156:157], v5 offset:7232
    ds_read_b64_tr_b16 a[158:159], v5 offset:7744
    s_sub_u32 s70, s66, 12320768
    buffer_load_dwordx4 a[176:179], v2, s[20:23], s70 offen offset:0 sc1
    buffer_load_dwordx4 a[180:183], v2, s[20:23], s70 offen offset:1024 sc1
    s_lshl_b32 s3, s41, 11
    s_add_u32 s70, s46, s3
    s_lshl_b32 s3, s39, 6
    s_add_u32 s70, s70, s3
    s_add_u32 s70, s70, 16384
    v_and_b32 v36, 15, v1
    v_lshlrev_b32 v36, 2, v36
    v_lshrrev_b32 v44, 4, v1
    v_lshl_add_u32 v36, v44, 9, v36
    buffer_load_dword a192, v36, s[20:23], s70 offen sc1
    v_lshlrev_b32 v22, 16, v205
    v_and_b32 v23, s69, v205
    v_lshlrev_b32 v24, 16, v206
    v_and_b32 v25, s69, v206
    v_lshlrev_b32 v26, 16, v207
    v_and_b32 v27, s69, v207
    v_fma_f32 v20, v20, v16, v17
    v_fma_f32 v21, v21, v16, v17
    v_fma_f32 v22, v22, v16, v17
    v_fma_f32 v23, v23, v16, v17
    v_fma_f32 v24, v24, v16, v17
    v_fma_f32 v25, v25, v16, v17
    v_fma_f32 v26, v26, v16, v17
    v_fma_f32 v27, v27, v16, v17
    v_cvt_pk_bf16_f32 v204, v20, v21
    v_cvt_pk_bf16_f32 v205, v22, v23
    v_cvt_pk_bf16_f32 v206, v24, v25
    v_cvt_pk_bf16_f32 v207, v26, v27
    s_nop 1
    v_mfma_f32_32x32x16_bf16 v[48:63], a[168:171], v[204:207], v[48:63]
    s_add_u32 m0, s44, 119168
    ds_read_b64_tr_b16 a[160:161], v5 offset:8192
    ds_read_b64_tr_b16 a[162:163], v5 offset:8704
    s_waitcnt vmcnt(17)
    v_lshlrev_b32 v20, 16, v208
    v_and_b32 v21, s69, v208
    v_lshlrev_b32 v22, 16, v209
    v_and_b32 v23, s69, v209
    v_lshlrev_b32 v24, 16, v210
    v_mfma_f32_32x32x16_bf16 v[64:79], a[172:175], v[204:207], v[64:79]
    s_waitcnt lgkmcnt(6)
    ds_read_b64_tr_b16 a[164:165], v5 offset:8256
    ds_read_b64_tr_b16 a[166:167], v5 offset:8768
    v_and_b32 v25, s69, v210
    v_lshlrev_b32 v26, 16, v211
    v_and_b32 v27, s69, v211
    v_fma_f32 v20, v20, v16, v17
    v_fma_f32 v21, v21, v16, v17
    v_fma_f32 v22, v22, v16, v17
    v_fma_f32 v23, v23, v16, v17
    v_fma_f32 v24, v24, v16, v17
    v_fma_f32 v25, v25, v16, v17
    v_fma_f32 v26, v26, v16, v17
    v_fma_f32 v27, v27, v16, v17
    v_cvt_pk_bf16_f32 v208, v20, v21
    v_cvt_pk_bf16_f32 v209, v22, v23
    v_cvt_pk_bf16_f32 v210, v24, v25
    v_cvt_pk_bf16_f32 v211, v26, v27
    s_nop 1
    v_mfma_f32_32x32x16_bf16 v[48:63], a[144:147], v[208:211], v[48:63]
    s_add_u32 s58, s42, 3833984
    ds_read_b64_tr_b16 a[168:169], v5 offset:9216
    ds_read_b64_tr_b16 a[170:171], v5 offset:9728
    buffer_load_dwordx4 v9, s[12:15], s58 offen lds
    v_lshlrev_b32 v20, 16, v212
    v_and_b32 v21, s69, v212
    v_mfma_f32_32x32x16_bf16 v[64:79], a[148:151], v[208:211], v[64:79]
    s_waitcnt lgkmcnt(6)
    ds_read_b64_tr_b16 a[172:173], v5 offset:9280
    ds_read_b64_tr_b16 a[174:175], v5 offset:9792
    v_lshlrev_b32 v22, 16, v213
    v_and_b32 v23, s69, v213
    v_lshlrev_b32 v24, 16, v214
    v_and_b32 v25, s69, v214
    v_lshlrev_b32 v26, 16, v215
    v_and_b32 v27, s69, v215
    v_fma_f32 v20, v20, v16, v17
    v_fma_f32 v21, v21, v16, v17
    v_fma_f32 v22, v22, v16, v17
    v_fma_f32 v23, v23, v16, v17
    v_fma_f32 v24, v24, v16, v17
    v_fma_f32 v25, v25, v16, v17
    v_fma_f32 v26, v26, v16, v17
    v_fma_f32 v27, v27, v16, v17
    v_cvt_pk_bf16_f32 v212, v20, v21
    v_cvt_pk_bf16_f32 v213, v22, v23
    v_cvt_pk_bf16_f32 v214, v24, v25
    v_cvt_pk_bf16_f32 v215, v26, v27
    s_nop 1
    v_mfma_f32_32x32x16_bf16 v[48:63], a[152:155], v[212:215], v[48:63]
    s_add_u32 m0, s44, 121216
    ds_read_b64_tr_b16 a[144:145], v5 offset:10240
    ds_read_b64_tr_b16 a[146:147], v5 offset:10752
    s_waitcnt vmcnt(16)
    v_lshlrev_b32 v20, 16, v216
    v_and_b32 v21, s69, v216
    v_lshlrev_b32 v22, 16, v217
    v_and_b32 v23, s69, v217
    v_lshlrev_b32 v24, 16, v218
    v_mfma_f32_32x32x16_bf16 v[64:79], a[156:159], v[212:215], v[64:79]
    s_waitcnt lgkmcnt(6)
    ds_read_b64_tr_b16 a[148:149], v5 offset:10304
    ds_read_b64_tr_b16 a[150:151], v5 offset:10816
    v_and_b32 v25, s69, v218
    v_lshlrev_b32 v26, 16, v219
    v_and_b32 v27, s69, v219
    v_fma_f32 v20, v20, v16, v17
    v_fma_f32 v21, v21, v16, v17
    v_fma_f32 v22, v22, v16, v17
    v_fma_f32 v23, v23, v16, v17
    v_fma_f32 v24, v24, v16, v17
    v_fma_f32 v25, v25, v16, v17
    v_fma_f32 v26, v26, v16, v17
    v_fma_f32 v27, v27, v16, v17
    v_cvt_pk_bf16_f32 v216, v20, v21
    v_cvt_pk_bf16_f32 v217, v22, v23
    v_cvt_pk_bf16_f32 v218, v24, v25
    v_cvt_pk_bf16_f32 v219, v26, v27
    s_nop 1
    v_mfma_f32_32x32x16_bf16 v[48:63], a[160:163], v[216:219], v[48:63]
    s_add_u32 s58, s42, 4128896
    ds_read_b64_tr_b16 a[152:153], v5 offset:11264
    ds_read_b64_tr_b16 a[154:155], v5 offset:11776
    buffer_load_dwordx4 v9, s[12:15], s58 offen lds
    v_lshlrev_b32 v20, 16, v220
    v_and_b32 v21, s69, v220
    v_mfma_f32_32x32x16_bf16 v[64:79], a[164:167], v[216:219], v[64:79]
    s_waitcnt lgkmcnt(6)
    ds_read_b64_tr_b16 a[156:157], v5 offset:11328
    ds_read_b64_tr_b16 a[158:159], v5 offset:11840
    v_lshlrev_b32 v22, 16, v221
    v_and_b32 v23, s69, v221
    v_lshlrev_b32 v24, 16, v222
    v_and_b32 v25, s69, v222
    v_lshlrev_b32 v26, 16, v223
    v_and_b32 v27, s69, v223
    v_fma_f32 v20, v20, v16, v17
    v_fma_f32 v21, v21, v16, v17
    v_fma_f32 v22, v22, v16, v17
    v_fma_f32 v23, v23, v16, v17
    v_fma_f32 v24, v24, v16, v17
    v_fma_f32 v25, v25, v16, v17
    v_fma_f32 v26, v26, v16, v17
    v_fma_f32 v27, v27, v16, v17
    v_cvt_pk_bf16_f32 v220, v20, v21
    v_cvt_pk_bf16_f32 v221, v22, v23
    v_cvt_pk_bf16_f32 v222, v24, v25
    v_cvt_pk_bf16_f32 v223, v26, v27
    s_nop 1
    v_mfma_f32_32x32x16_bf16 v[48:63], a[168:171], v[220:223], v[48:63]
    s_add_u32 m0, s44, 123264
    ds_read_b64_tr_b16 a[160:161], v5 offset:12288
    ds_read_b64_tr_b16 a[162:163], v5 offset:12800
    s_waitcnt vmcnt(15)
    v_lshlrev_b32 v20, 16, v224
    v_and_b32 v21, s69, v224
    v_lshlrev_b32 v22, 16, v225
    v_and_b32 v23, s69, v225
    v_lshlrev_b32 v24, 16, v226
    v_mfma_f32_32x32x16_bf16 v[64:79], a[172:175], v[220:223], v[64:79]
    s_waitcnt lgkmcnt(6)
    ds_read_b64_tr_b16 a[164:165], v5 offset:12352
    ds_read_b64_tr_b16 a[166:167], v5 offset:12864
    v_and_b32 v25, s69, v226
    v_lshlrev_b32 v26, 16, v227
    v_and_b32 v27, s69, v227
    v_fma_f32 v20, v20, v16, v17
    v_fma_f32 v21, v21, v16, v17
    v_fma_f32 v22, v22, v16, v17
    v_fma_f32 v23, v23, v16, v17
    v_fma_f32 v24, v24, v16, v17
    v_fma_f32 v25, v25, v16, v17
    v_fma_f32 v26, v26, v16, v17
    v_fma_f32 v27, v27, v16, v17
    v_cvt_pk_bf16_f32 v224, v20, v21
    v_cvt_pk_bf16_f32 v225, v22, v23
    v_cvt_pk_bf16_f32 v226, v24, v25
    v_cvt_pk_bf16_f32 v227, v26, v27
    s_nop 1
    v_mfma_f32_32x32x16_bf16 v[48:63], a[144:147], v[224:227], v[48:63]
    s_add_u32 s58, s42, 4423808
    ds_read_b64_tr_b16 a[168:169], v5 offset:13312
    ds_read_b64_tr_b16 a[170:171], v5 offset:13824
    buffer_load_dwordx4 v9, s[12:15], s58 offen lds
    v_lshlrev_b32 v20, 16, v228
    v_and_b32 v21, s69, v228
    v_mfma_f32_32x32x16_bf16 v[64:79], a[148:151], v[224:227], v[64:79]
    s_waitcnt lgkmcnt(6)
    ds_read_b64_tr_b16 a[172:173], v5 offset:13376
    ds_read_b64_tr_b16 a[174:175], v5 offset:13888
    v_lshlrev_b32 v22, 16, v229
    v_and_b32 v23, s69, v229
    v_lshlrev_b32 v24, 16, v230
    v_and_b32 v25, s69, v230
    v_lshlrev_b32 v26, 16, v231
    v_and_b32 v27, s69, v231
    v_fma_f32 v20, v20, v16, v17
    v_fma_f32 v21, v21, v16, v17
    v_fma_f32 v22, v22, v16, v17
    v_fma_f32 v23, v23, v16, v17
    v_fma_f32 v24, v24, v16, v17
    v_fma_f32 v25, v25, v16, v17
    v_fma_f32 v26, v26, v16, v17
    v_fma_f32 v27, v27, v16, v17
    v_cvt_pk_bf16_f32 v228, v20, v21
    v_cvt_pk_bf16_f32 v229, v22, v23
    v_cvt_pk_bf16_f32 v230, v24, v25
    v_cvt_pk_bf16_f32 v231, v26, v27
    s_nop 1
    v_mfma_f32_32x32x16_bf16 v[48:63], a[152:155], v[228:231], v[48:63]
    s_add_u32 m0, s44, 125312
    ds_read_b64_tr_b16 a[144:145], v5 offset:14336
    ds_read_b64_tr_b16 a[146:147], v5 offset:14848
    s_waitcnt vmcnt(14)
    v_lshlrev_b32 v20, 16, v232
    v_and_b32 v21, s69, v232
    v_lshlrev_b32 v22, 16, v233
    v_and_b32 v23, s69, v233
    v_lshlrev_b32 v24, 16, v234
    v_mfma_f32_32x32x16_bf16 v[64:79], a[156:159], v[228:231], v[64:79]
    s_waitcnt lgkmcnt(6)
    ds_read_b64_tr_b16 a[148:149], v5 offset:14400
    ds_read_b64_tr_b16 a[150:151], v5 offset:14912
    v_and_b32 v25, s69, v234
    v_lshlrev_b32 v26, 16, v235
    v_and_b32 v27, s69, v235
    v_fma_f32 v20, v20, v16, v17
    v_fma_f32 v21, v21, v16, v17
    v_fma_f32 v22, v22, v16, v17
    v_fma_f32 v23, v23, v16, v17
    v_fma_f32 v24, v24, v16, v17
    v_fma_f32 v25, v25, v16, v17
    v_fma_f32 v26, v26, v16, v17
    v_fma_f32 v27, v27, v16, v17
    v_cvt_pk_bf16_f32 v232, v20, v21
    v_cvt_pk_bf16_f32 v233, v22, v23
    v_cvt_pk_bf16_f32 v234, v24, v25
    v_cvt_pk_bf16_f32 v235, v26, v27
    s_nop 1
    v_mfma_f32_32x32x16_bf16 v[48:63], a[160:163], v[232:235], v[48:63]
    s_add_u32 s58, s42, 4718720
    ds_read_b64_tr_b16 a[152:153], v5 offset:15360
    ds_read_b64_tr_b16 a[154:155], v5 offset:15872
    buffer_load_dwordx4 v9, s[12:15], s58 offen lds
    v_lshlrev_b32 v20, 16, v236
    v_and_b32 v21, s69, v236
    v_mfma_f32_32x32x16_bf16 v[64:79], a[164:167], v[232:235], v[64:79]
    s_waitcnt lgkmcnt(6)
    ds_read_b64_tr_b16 a[156:157], v5 offset:15424
    ds_read_b64_tr_b16 a[158:159], v5 offset:15936
    v_lshlrev_b32 v22, 16, v237
    v_and_b32 v23, s69, v237
    v_lshlrev_b32 v24, 16, v238
    v_and_b32 v25, s69, v238
    v_lshlrev_b32 v26, 16, v239
    v_and_b32 v27, s69, v239
    v_fma_f32 v20, v20, v16, v17
    v_fma_f32 v21, v21, v16, v17
    v_fma_f32 v22, v22, v16, v17
    v_fma_f32 v23, v23, v16, v17
    v_fma_f32 v24, v24, v16, v17
    v_fma_f32 v25, v25, v16, v17
    v_fma_f32 v26, v26, v16, v17
    v_fma_f32 v27, v27, v16, v17
    v_cvt_pk_bf16_f32 v236, v20, v21
    v_cvt_pk_bf16_f32 v237, v22, v23
    v_cvt_pk_bf16_f32 v238, v24, v25
    v_cvt_pk_bf16_f32 v239, v26, v27
    s_nop 1
    v_mfma_f32_32x32x16_bf16 v[48:63], a[168:171], v[236:239], v[48:63]
    s_add_u32 m0, s44, 127360
    ds_read_b64_tr_b16 a[160:161], v5 offset:16384
    ds_read_b64_tr_b16 a[162:163], v5 offset:16896
    s_waitcnt vmcnt(13)
    v_lshlrev_b32 v20, 16, v240
    v_and_b32 v21, s69, v240
    v_lshlrev_b32 v22, 16, v241
    v_and_b32 v23, s69, v241
    v_lshlrev_b32 v24, 16, v242
    v_mfma_f32_32x32x16_bf16 v[64:79], a[172:175], v[236:239], v[64:79]
    s_waitcnt lgkmcnt(6)
    ds_read_b64_tr_b16 a[164:165], v5 offset:16448
    ds_read_b64_tr_b16 a[166:167], v5 offset:16960
    v_and_b32 v25, s69, v242
    v_lshlrev_b32 v26, 16, v243
    v_and_b32 v27, s69, v243
    v_fma_f32 v20, v20, v16, v17
    v_fma_f32 v21, v21, v16, v17
    v_fma_f32 v22, v22, v16, v17
    v_fma_f32 v23, v23, v16, v17
    v_fma_f32 v24, v24, v16, v17
    v_fma_f32 v25, v25, v16, v17
    v_fma_f32 v26, v26, v16, v17
    v_fma_f32 v27, v27, v16, v17
    v_cvt_pk_bf16_f32 v240, v20, v21
    v_cvt_pk_bf16_f32 v241, v22, v23
    v_cvt_pk_bf16_f32 v242, v24, v25
    v_cvt_pk_bf16_f32 v243, v26, v27
    s_nop 1
    v_mfma_f32_32x32x16_bf16 v[48:63], a[144:147], v[240:243], v[48:63]
    s_add_u32 s58, s42, 5013632
    ds_read_b64_tr_b16 a[168:169], v5 offset:17408
    ds_read_b64_tr_b16 a[170:171], v5 offset:17920
    buffer_load_dwordx4 v9, s[12:15], s58 offen lds
    v_lshlrev_b32 v20, 16, v244
    v_and_b32 v21, s69, v244
    v_mfma_f32_32x32x16_bf16 v[64:79], a[148:151], v[240:243], v[64:79]
    s_waitcnt lgkmcnt(6)
    ds_read_b64_tr_b16 a[172:173], v5 offset:17472
    ds_read_b64_tr_b16 a[174:175], v5 offset:17984
    v_lshlrev_b32 v22, 16, v245
    v_and_b32 v23, s69, v245
    v_lshlrev_b32 v24, 16, v246
    v_and_b32 v25, s69, v246
    v_lshlrev_b32 v26, 16, v247
    v_and_b32 v27, s69, v247
    v_fma_f32 v20, v20, v16, v17
    v_fma_f32 v21, v21, v16, v17
    v_fma_f32 v22, v22, v16, v17
    v_fma_f32 v23, v23, v16, v17
    v_fma_f32 v24, v24, v16, v17
    v_fma_f32 v25, v25, v16, v17
    v_fma_f32 v26, v26, v16, v17
    v_fma_f32 v27, v27, v16, v17
    v_cvt_pk_bf16_f32 v244, v20, v21
    v_cvt_pk_bf16_f32 v245, v22, v23
    v_cvt_pk_bf16_f32 v246, v24, v25
    v_cvt_pk_bf16_f32 v247, v26, v27
    s_nop 1
    v_mfma_f32_32x32x16_bf16 v[48:63], a[152:155], v[244:247], v[48:63]
    s_barrier
    ds_read_b64_tr_b16 a[144:145], v6 offset:0
    ds_read_b64_tr_b16 a[146:147], v6 offset:512
    s_waitcnt vmcnt(12)
    v_mfma_f32_32x32x16_bf16 v[64:79], a[156:159], v[244:247], v[64:79]
    s_waitcnt lgkmcnt(6)
    ds_read_b64_tr_b16 a[148:149], v6 offset:64
    ds_read_b64_tr_b16 a[150:151], v6 offset:576
    v_lshlrev_b32 v20, 16, v248
    v_and_b32 v21, s69, v248
    v_lshlrev_b32 v22, 16, v249
    v_and_b32 v23, s69, v249
    v_lshlrev_b32 v24, 16, v250
    v_and_b32 v25, s69, v250
    v_lshlrev_b32 v26, 16, v251
    v_and_b32 v27, s69, v251
    v_fma_f32 v20, v20, v16, v17
    v_fma_f32 v21, v21, v16, v17
    v_fma_f32 v22, v22, v16, v17
    v_fma_f32 v23, v23, v16, v17
    v_fma_f32 v24, v24, v16, v17
    v_fma_f32 v25, v25, v16, v17
    v_fma_f32 v26, v26, v16, v17
    v_fma_f32 v27, v27, v16, v17
    v_cvt_pk_bf16_f32 v248, v20, v21
    v_cvt_pk_bf16_f32 v249, v22, v23
    v_cvt_pk_bf16_f32 v250, v24, v25
    v_cvt_pk_bf16_f32 v251, v26, v27
    s_nop 1
    v_mfma_f32_32x32x16_bf16 v[48:63], a[160:163], v[248:251], v[48:63]
    s_add_u32 m0, s44, 0
    ds_read_b64_tr_b16 a[152:153], v6 offset:1024
    ds_read_b64_tr_b16 a[154:155], v6 offset:1536
    s_add_u32 s58, s42, 256
    buffer_load_dwordx4 v9, s[12:15], s58 offen lds
    v_lshlrev_b32 v20, 16, v252
    v_mfma_f32_32x32x16_bf16 v[64:79], a[164:167], v[248:251], v[64:79]
    s_waitcnt lgkmcnt(6)
    ds_read_b64_tr_b16 a[156:157], v6 offset:1088
    ds_read_b64_tr_b16 a[158:159], v6 offset:1600
    v_and_b32 v21, s69, v252
    v_lshlrev_b32 v22, 16, v253
    v_and_b32 v23, s69, v253
    v_lshlrev_b32 v24, 16, v254
    v_and_b32 v25, s69, v254
    v_lshlrev_b32 v26, 16, v255
    v_and_b32 v27, s69, v255
    v_fma_f32 v20, v20, v16, v17
    v_fma_f32 v21, v21, v16, v17
    v_fma_f32 v22, v22, v16, v17
    v_fma_f32 v23, v23, v16, v17
    v_fma_f32 v24, v24, v16, v17
    v_fma_f32 v25, v25, v16, v17
    v_fma_f32 v26, v26, v16, v17
    v_fma_f32 v27, v27, v16, v17
    v_cvt_pk_bf16_f32 v252, v20, v21
    v_cvt_pk_bf16_f32 v253, v22, v23
    v_cvt_pk_bf16_f32 v254, v24, v25
    v_cvt_pk_bf16_f32 v255, v26, v27
    s_nop 1
    v_mfma_f32_32x32x16_bf16 v[48:63], a[168:171], v[252:255], v[48:63]
    s_add_u32 m0, s44, 2048
    ds_read_b64_tr_b16 a[160:161], v6 offset:2048
    ds_read_b64_tr_b16 a[162:163], v6 offset:2560
    v_mfma_f32_32x32x16_bf16 v[64:79], a[172:175], v[252:255], v[64:79]
    s_waitcnt lgkmcnt(6)
    ds_read_b64_tr_b16 a[164:165], v6 offset:2112
    ds_read_b64_tr_b16 a[166:167], v6 offset:2624
    v_mfma_f32_32x32x16_bf16 v[80:95], a[144:147], v[112:115], v[80:95]
    s_add_u32 s58, s42, 295168
    ds_read_b64_tr_b16 a[168:169], v6 offset:3072
    ds_read_b64_tr_b16 a[170:171], v6 offset:3584
    buffer_load_dwordx4 v9, s[12:15], s58 offen lds
    v_fma_f32 v20, v48, v48, s60
    v_fma_f32 v21, v49, v49, s60
    v_fma_f32 v22, v50, v50, s60
    v_mfma_f32_32x32x16_bf16 v[96:111], a[148:151], v[112:115], v[96:111]
    s_waitcnt lgkmcnt(6)
    ds_read_b64_tr_b16 a[172:173], v6 offset:3136
    ds_read_b64_tr_b16 a[174:175], v6 offset:3648
    v_fma_f32 v23, v51, v51, s60
    v_mul_f32 v20, v20, v48
    v_mul_f32 v21, v21, v49
    v_mul_f32 v22, v22, v50
    v_mul_f32 v23, v23, v51
    v_mfma_f32_32x32x16_bf16 v[80:95], a[152:155], v[116:119], v[80:95]
    s_add_u32 m0, s44, 4096
    ds_read_b64_tr_b16 a[144:145], v6 offset:4096
    ds_read_b64_tr_b16 a[146:147], v6 offset:4608
    v_exp_f32 v20, v20
    v_exp_f32 v21, v21
    v_exp_f32 v22, v22
    v_mfma_f32_32x32x16_bf16 v[96:111], a[156:159], v[116:119], v[96:111]
    s_waitcnt lgkmcnt(6)
    ds_read_b64_tr_b16 a[148:149], v6 offset:4160
    ds_read_b64_tr_b16 a[150:151], v6 offset:4672
    v_exp_f32 v23, v23
    v_add_f32 v20, 1.0, v20
    v_add_f32 v21, 1.0, v21
    v_add_f32 v22, 1.0, v22
    v_add_f32 v23, 1.0, v23
    v_mfma_f32_32x32x16_bf16 v[80:95], a[160:163], v[120:123], v[80:95]
    s_add_u32 s58, s42, 590080
    ds_read_b64_tr_b16 a[152:153], v6 offset:5120
    ds_read_b64_tr_b16 a[154:155], v6 offset:5632
    buffer_load_dwordx4 v9, s[12:15], s58 offen lds
    v_rcp_f32 v20, v20
    v_mfma_f32_32x32x16_bf16 v[96:111], a[164:167], v[120:123], v[96:111]
    s_waitcnt lgkmcnt(6)
    ds_read_b64_tr_b16 a[156:157], v6 offset:5184
    ds_read_b64_tr_b16 a[158:159], v6 offset:5696
    v_rcp_f32 v21, v21
    v_rcp_f32 v22, v22
    v_rcp_f32 v23, v23
    v_mfma_f32_32x32x16_bf16 v[80:95], a[168:171], v[124:127], v[80:95]
    s_add_u32 m0, s44, 6144
    ds_read_b64_tr_b16 a[160:161], v6 offset:6144
    ds_read_b64_tr_b16 a[162:163], v6 offset:6656
    v_mul_f32 v20, v20, v48
    v_mul_f32 v21, v21, v49
    v_mul_f32 v22, v22, v50
    v_mul_f32 v23, v23, v51
    v_cvt_pk_bf16_f32 v28, v20, v21
    v_cvt_pk_bf16_f32 v29, v22, v23
    v_mfma_f32_32x32x16_bf16 v[96:111], a[172:175], v[124:127], v[96:111]
    s_waitcnt lgkmcnt(6)
    ds_read_b64_tr_b16 a[164:165], v6 offset:6208
    ds_read_b64_tr_b16 a[166:167], v6 offset:6720
    v_accvgpr_write_b32 a0, v28
    v_accvgpr_write_b32 a1, v29
    v_fma_f32 v24, v52, v52, s60
    v_fma_f32 v25, v53, v53, s60
    v_fma_f32 v26, v54, v54, s60
    v_fma_f32 v27, v55, v55, s60
    v_mfma_f32_32x32x16_bf16 v[80:95], a[144:147], v[128:131], v[80:95]
    s_add_u32 s58, s42, 884992
    ds_read_b64_tr_b16 a[168:169], v6 offset:7168
    ds_read_b64_tr_b16 a[170:171], v6 offset:7680
    buffer_load_dwordx4 v9, s[12:15], s58 offen lds
    v_mul_f32 v24, v24, v52
    v_mul_f32 v25, v25, v53
    v_mul_f32 v26, v26, v54
    v_mfma_f32_32x32x16_bf16 v[96:111], a[148:151], v[128:131], v[96:111]
    s_waitcnt lgkmcnt(6)
    ds_read_b64_tr_b16 a[172:173], v6 offset:7232
    ds_read_b64_tr_b16 a[174:175], v6 offset:7744
    v_mul_f32 v27, v27, v55
    v_exp_f32 v24, v24
    v_exp_f32 v25, v25
    v_mfma_f32_32x32x16_bf16 v[80:95], a[152:155], v[132:135], v[80:95]
    s_add_u32 m0, s44, 8192
    ds_read_b64_tr_b16 a[144:145], v6 offset:8192
    ds_read_b64_tr_b16 a[146:147], v6 offset:8704
    v_exp_f32 v26, v26
    v_exp_f32 v27, v27
    v_add_f32 v24, 1.0, v24
    v_add_f32 v25, 1.0, v25
    v_mfma_f32_32x32x16_bf16 v[96:111], a[156:159], v[132:135], v[96:111]
    s_waitcnt lgkmcnt(6)
    ds_read_b64_tr_b16 a[148:149], v6 offset:8256
    ds_read_b64_tr_b16 a[150:151], v6 offset:8768
    v_add_f32 v26, 1.0, v26
    v_add_f32 v27, 1.0, v27
    v_rcp_f32 v24, v24
    v_rcp_f32 v25, v25
    v_mfma_f32_32x32x16_bf16 v[80:95], a[160:163], v[136:139], v[80:95]
    s_add_u32 s58, s42, 1179904
    ds_read_b64_tr_b16 a[152:153], v6 offset:9216
    ds_read_b64_tr_b16 a[154:155], v6 offset:9728
    buffer_load_dwordx4 v9, s[12:15], s58 offen lds
    v_rcp_f32 v26, v26
    v_mfma_f32_32x32x16_bf16 v[96:111], a[164:167], v[136:139], v[96:111]
    s_waitcnt lgkmcnt(6)
    ds_read_b64_tr_b16 a[156:157], v6 offset:9280
    ds_read_b64_tr_b16 a[158:159], v6 offset:9792
    v_rcp_f32 v27, v27
    v_mul_f32 v24, v24, v52
    v_mul_f32 v25, v25, v53
    v_mul_f32 v26, v26, v54
    v_mul_f32 v27, v27, v55
    v_mfma_f32_32x32x16_bf16 v[80:95], a[168:171], v[140:143], v[80:95]
    s_add_u32 m0, s44, 10240
    ds_read_b64_tr_b16 a[160:161], v6 offset:10240
    ds_read_b64_tr_b16 a[162:163], v6 offset:10752
    ds_read_b128 v[48:51], v15 offset:512
    ds_read_b128 v[52:55], v15 offset:544
    v_cvt_pk_bf16_f32 v30, v24, v25
    v_cvt_pk_bf16_f32 v31, v26, v27
    v_accvgpr_write_b32 a2, v30
    v_accvgpr_write_b32 a3, v31
    v_mfma_f32_32x32x16_bf16 v[96:111], a[172:175], v[140:143], v[96:111]
    s_waitcnt lgkmcnt(8)
    ds_read_b64_tr_b16 a[164:165], v6 offset:10304
    ds_read_b64_tr_b16 a[166:167], v6 offset:10816
    s_add_u32 s63, s55, 0
    buffer_store_dwordx4 v[28:31], v2, s[20:23], s63 offen offset:0 sc1
    v_fma_f32 v20, v56, v56, s60
    v_fma_f32 v21, v57, v57, s60
    v_mfma_f32_32x32x16_bf16 v[80:95], a[144:147], v[144:147], v[80:95]
    s_add_u32 s58, s42, 1474816
    ds_read_b64_tr_b16 a[168:169], v6 offset:11264
    ds_read_b64_tr_b16 a[170:171], v6 offset:11776
    buffer_load_dwordx4 v9, s[12:15], s58 offen lds
    v_fma_f32 v22, v58, v58, s60
    v_fma_f32 v23, v59, v59, s60
    v_mul_f32 v20, v20, v56
    v_mfma_f32_32x32x16_bf16 v[96:111], a[148:151], v[144:147], v[96:111]
    s_waitcnt lgkmcnt(8)
    ds_read_b64_tr_b16 a[172:173], v6 offset:11328
    ds_read_b64_tr_b16 a[174:175], v6 offset:11840
    v_mul_f32 v21, v21, v57
    v_mul_f32 v22, v22, v58
    v_mul_f32 v23, v23, v59
    v_exp_f32 v20, v20
    v_mfma_f32_32x32x16_bf16 v[80:95], a[152:155], v[148:151], v[80:95]
    s_add_u32 m0, s44, 12288
    ds_read_b64_tr_b16 a[144:145], v6 offset:12288
    ds_read_b64_tr_b16 a[146:147], v6 offset:12800
    v_exp_f32 v21, v21
    v_exp_f32 v22, v22
    v_exp_f32 v23, v23
    v_mfma_f32_32x32x16_bf16 v[96:111], a[156:159], v[148:151], v[96:111]
    s_waitcnt lgkmcnt(6)
    ds_read_b64_tr_b16 a[148:149], v6 offset:12352
    ds_read_b64_tr_b16 a[150:151], v6 offset:12864
    v_add_f32 v20, 1.0, v20
    v_add_f32 v21, 1.0, v21
    v_add_f32 v22, 1.0, v22
    v_add_f32 v23, 1.0, v23
    v_rcp_f32 v20, v20
    v_mfma_f32_32x32x16_bf16 v[80:95], a[160:163], v[152:155], v[80:95]
    s_add_u32 s58, s42, 1769728
    ds_read_b64_tr_b16 a[152:153], v6 offset:13312
    ds_read_b64_tr_b16 a[154:155], v6 offset:13824
    buffer_load_dwordx4 v9, s[12:15], s58 offen lds
    v_rcp_f32 v21, v21
    v_mfma_f32_32x32x16_bf16 v[96:111], a[164:167], v[152:155], v[96:111]
    s_waitcnt lgkmcnt(6)
    ds_read_b64_tr_b16 a[156:157], v6 offset:13376
    ds_read_b64_tr_b16 a[158:159], v6 offset:13888
    v_rcp_f32 v22, v22
    v_rcp_f32 v23, v23
    v_mul_f32 v20, v20, v56
    v_mul_f32 v21, v21, v57
    v_mfma_f32_32x32x16_bf16 v[80:95], a[168:171], v[156:159], v[80:95]
    s_add_u32 m0, s44, 14336
    ds_read_b64_tr_b16 a[160:161], v6 offset:14336
    ds_read_b64_tr_b16 a[162:163], v6 offset:14848
    v_mul_f32 v22, v22, v58
    v_mul_f32 v23, v23, v59
    v_cvt_pk_bf16_f32 v32, v20, v21
    v_cvt_pk_bf16_f32 v33, v22, v23
    v_accvgpr_write_b32 a4, v32
    v_accvgpr_write_b32 a5, v33
    v_mfma_f32_32x32x16_bf16 v[96:111], a[172:175], v[156:159], v[96:111]
    s_waitcnt lgkmcnt(6)
    ds_read_b64_tr_b16 a[164:165], v6 offset:14400
    ds_read_b64_tr_b16 a[166:167], v6 offset:14912
    v_fma_f32 v24, v60, v60, s60
    v_fma_f32 v25, v61, v61, s60
    v_fma_f32 v26, v62, v62, s60
    v_fma_f32 v27, v63, v63, s60
    v_mul_f32 v24, v24, v60
    v_mul_f32 v25, v25, v61
    v_mfma_f32_32x32x16_bf16 v[80:95], a[144:147], v[160:163], v[80:95]
    s_add_u32 s58, s42, 2064640
    ds_read_b64_tr_b16 a[168:169], v6 offset:15360
    ds_read_b64_tr_b16 a[170:171], v6 offset:15872
    buffer_load_dwordx4 v9, s[12:15], s58 offen lds
    v_mul_f32 v26, v26, v62
    v_mul_f32 v27, v27, v63
    v_mfma_f32_32x32x16_bf16 v[96:111], a[148:151], v[160:163], v[96:111]
    s_waitcnt lgkmcnt(6)
    ds_read_b64_tr_b16 a[172:173], v6 offset:15424
    ds_read_b64_tr_b16 a[174:175], v6 offset:15936
    v_exp_f32 v24, v24
    v_exp_f32 v25, v25
    v_exp_f32 v26, v26
    v_mfma_f32_32x32x16_bf16 v[80:95], a[152:155], v[164:167], v[80:95]
    s_add_u32 m0, s44, 16384
    ds_read_b64_tr_b16 a[144:145], v6 offset:16384
    ds_read_b64_tr_b16 a[146:147], v6 offset:16896
    v_exp_f32 v27, v27
    v_add_f32 v24, 1.0, v24
    v_add_f32 v25, 1.0, v25
    v_add_f32 v26, 1.0, v26
    v_add_f32 v27, 1.0, v27
    v_mfma_f32_32x32x16_bf16 v[96:111], a[156:159], v[164:167], v[96:111]
    s_waitcnt lgkmcnt(6)
    ds_read_b64_tr_b16 a[148:149], v6 offset:16448
    ds_read_b64_tr_b16 a[150:151], v6 offset:16960
    v_rcp_f32 v24, v24
    v_rcp_f32 v25, v25
    v_rcp_f32 v26, v26
    v_mfma_f32_32x32x16_bf16 v[80:95], a[160:163], v[168:171], v[80:95]
    s_add_u32 s58, s42, 2359552
    ds_read_b64_tr_b16 a[152:153], v6 offset:17408
    ds_read_b64_tr_b16 a[154:155], v6 offset:17920
    buffer_load_dwordx4 v9, s[12:15], s58 offen lds
    v_rcp_f32 v27, v27
    v_mul_f32 v24, v24, v60
    v_mfma_f32_32x32x16_bf16 v[96:111], a[164:167], v[168:171], v[96:111]
    s_waitcnt lgkmcnt(6)
    ds_read_b64_tr_b16 a[156:157], v6 offset:17472
    ds_read_b64_tr_b16 a[158:159], v6 offset:17984
    v_mul_f32 v25, v25, v61
    v_mul_f32 v26, v26, v62
    v_mul_f32 v27, v27, v63
    v_cvt_pk_bf16_f32 v34, v24, v25
    v_cvt_pk_bf16_f32 v35, v26, v27
    v_accvgpr_write_b32 a6, v34
    v_mfma_f32_32x32x16_bf16 v[80:95], a[168:171], v[172:175], v[80:95]
    s_waitcnt vmcnt(10)
    s_barrier
    ds_read_b64_tr_b16 a[160:161], v7 offset:0
    ds_read_b64_tr_b16 a[162:163], v7 offset:512
    ds_read_b128 v[56:59], v15 offset:576
    ds_read_b128 v[60:63], v15 offset:608
    v_mfma_f32_32x32x16_bf16 v[96:111], a[172:175], v[172:175], v[96:111]
    s_waitcnt lgkmcnt(8)
    ds_read_b64_tr_b16 a[164:165], v7 offset:64
    ds_read_b64_tr_b16 a[166:167], v7 offset:576
    v_accvgpr_write_b32 a7, v35
    v_fma_f32 v20, v64, v64, s60
    v_fma_f32 v21, v65, v65, s60
    v_fma_f32 v22, v66, v66, s60
    v_fma_f32 v23, v67, v67, s60
    v_mul_f32 v20, v20, v64
    v_mfma_f32_32x32x16_bf16 v[80:95], a[144:147], v[176:179], v[80:95]
    s_add_u32 m0, s44, 36992
    ds_read_b64_tr_b16 a[168:169], v7 offset:1024
    ds_read_b64_tr_b16 a[170:171], v7 offset:1536
    s_add_u32 s58, s42, 2654464
    buffer_load_dwordx4 v9, s[12:15], s58 offen lds
    v_mul_f32 v21, v21, v65
    v_mul_f32 v22, v22, v66
    v_mfma_f32_32x32x16_bf16 v[96:111], a[148:151], v[176:179], v[96:111]
    s_waitcnt lgkmcnt(8)
    ds_read_b64_tr_b16 a[172:173], v7 offset:1088
    ds_read_b64_tr_b16 a[174:175], v7 offset:1600
    buffer_store_dwordx4 v[32:35], v2, s[20:23], s63 offen offset:1024 sc1
    v_mul_f32 v23, v23, v67
    v_mfma_f32_32x32x16_bf16 v[80:95], a[152:155], v[180:183], v[80:95]
    s_add_u32 m0, s44, 39040
    ds_read_b64_tr_b16 a[144:145], v7 offset:2048
    ds_read_b64_tr_b16 a[146:147], v7 offset:2560
    v_exp_f32 v20, v20
    v_exp_f32 v21, v21
    v_exp_f32 v22, v22
    v_mfma_f32_32x32x16_bf16 v[96:111], a[156:159], v[180:183], v[96:111]
    s_waitcnt lgkmcnt(6)
    ds_read_b64_tr_b16 a[148:149], v7 offset:2112
    ds_read_b64_tr_b16 a[150:151], v7 offset:2624
    v_exp_f32 v23, v23
    v_add_f32 v20, 1.0, v20
    v_add_f32 v21, 1.0, v21
    v_add_f32 v22, 1.0, v22
    v_add_f32 v23, 1.0, v23
    v_mfma_f32_32x32x16_bf16 v[80:95], a[160:163], v[184:187], v[80:95]
    s_add_u32 s58, s42, 2949376
    ds_read_b64_tr_b16 a[152:153], v7 offset:3072
    ds_read_b64_tr_b16 a[154:155], v7 offset:3584
    buffer_load_dwordx4 v9, s[12:15], s58 offen lds
    v_rcp_f32 v20, v20
    v_mfma_f32_32x32x16_bf16 v[96:111], a[164:167], v[184:187], v[96:111]
    s_waitcnt lgkmcnt(6)
    ds_read_b64_tr_b16 a[156:157], v7 offset:3136
    ds_read_b64_tr_b16 a[158:159], v7 offset:3648
    v_rcp_f32 v21, v21
    v_rcp_f32 v22, v22
    v_rcp_f32 v23, v23
    v_mfma_f32_32x32x16_bf16 v[80:95], a[168:171], v[188:191], v[80:95]
    s_add_u32 m0, s44, 41088
    ds_read_b64_tr_b16 a[160:161], v7 offset:4096
    ds_read_b64_tr_b16 a[162:163], v7 offset:4608
    v_mul_f32 v20, v20, v64
    v_mul_f32 v21, v21, v65
    v_mul_f32 v22, v22, v66
    v_mul_f32 v23, v23, v67
    v_cvt_pk_bf16_f32 v28, v20, v21
    v_cvt_pk_bf16_f32 v29, v22, v23
    v_mfma_f32_32x32x16_bf16 v[96:111], a[172:175], v[188:191], v[96:111]
    s_waitcnt lgkmcnt(6)
    ds_read_b64_tr_b16 a[164:165], v7 offset:4160
    ds_read_b64_tr_b16 a[166:167], v7 offset:4672
    v_accvgpr_write_b32 a8, v28
    v_accvgpr_write_b32 a9, v29
    v_fma_f32 v24, v68, v68, s60
    v_fma_f32 v25, v69, v69, s60
    v_fma_f32 v26, v70, v70, s60
    v_fma_f32 v27, v71, v71, s60
    v_mfma_f32_32x32x16_bf16 v[80:95], a[144:147], v[192:195], v[80:95]
    s_add_u32 s58, s42, 3244288
    ds_read_b64_tr_b16 a[168:169], v7 offset:5120
    ds_read_b64_tr_b16 a[170:171], v7 offset:5632
    buffer_load_dwordx4 v9, s[12:15], s58 offen lds
    v_mul_f32 v24, v24, v68
    v_mul_f32 v25, v25, v69
    v_mul_f32 v26, v26, v70
    v_mfma_f32_32x32x16_bf16 v[96:111], a[148:151], v[192:195], v[96:111]
    s_waitcnt lgkmcnt(6)
    ds_read_b64_tr_b16 a[172:173], v7 offset:5184
    ds_read_b64_tr_b16 a[174:175], v7 offset:5696
    v_mul_f32 v27, v27, v71
    v_exp_f32 v24, v24
    v_exp_f32 v25, v25
    v_mfma_f32_32x32x16_bf16 v[80:95], a[152:155], v[196:199], v[80:95]
    s_add_u32 m0, s44, 43136
    ds_read_b64_tr_b16 a[144:145], v7 offset:6144
    ds_read_b64_tr_b16 a[146:147], v7 offset:6656
    v_exp_f32 v26, v26
    v_exp_f32 v27, v27
    v_add_f32 v24, 1.0, v24
    v_add_f32 v25, 1.0, v25
    v_mfma_f32_32x32x16_bf16 v[96:111], a[156:159], v[196:199], v[96:111]
    s_waitcnt lgkmcnt(6)
    ds_read_b64_tr_b16 a[148:149], v7 offset:6208
    ds_read_b64_tr_b16 a[150:151], v7 offset:6720
    v_add_f32 v26, 1.0, v26
    v_add_f32 v27, 1.0, v27
    v_rcp_f32 v24, v24
    v_rcp_f32 v25, v25
    v_mfma_f32_32x32x16_bf16 v[80:95], a[160:163], v[200:203], v[80:95]
    s_add_u32 s58, s42, 3539200
    ds_read_b64_tr_b16 a[152:153], v7 offset:7168
    ds_read_b64_tr_b16 a[154:155], v7 offset:7680
    buffer_load_dwordx4 v9, s[12:15], s58 offen lds
    v_rcp_f32 v26, v26
    v_mfma_f32_32x32x16_bf16 v[96:111], a[164:167], v[200:203], v[96:111]
    s_waitcnt lgkmcnt(6)
    ds_read_b64_tr_b16 a[156:157], v7 offset:7232
    ds_read_b64_tr_b16 a[158:159], v7 offset:7744
    v_rcp_f32 v27, v27
    v_mul_f32 v24, v24, v68
    v_mul_f32 v25, v25, v69
    v_mul_f32 v26, v26, v70
    v_mul_f32 v27, v27, v71
    v_mfma_f32_32x32x16_bf16 v[80:95], a[168:171], v[204:207], v[80:95]
    s_add_u32 m0, s44, 45184
    ds_read_b64_tr_b16 a[160:161], v7 offset:8192
    ds_read_b64_tr_b16 a[162:163], v7 offset:8704
    ds_read_b128 v[64:67], v15 offset:640
    ds_read_b128 v[68:71], v15 offset:672
    v_cvt_pk_bf16_f32 v30, v24, v25
    v_cvt_pk_bf16_f32 v31, v26, v27
    v_accvgpr_write_b32 a10, v30
    v_accvgpr_write_b32 a11, v31
    v_mfma_f32_32x32x16_bf16 v[96:111], a[172:175], v[204:207], v[96:111]
    s_waitcnt lgkmcnt(8)
    ds_read_b64_tr_b16 a[164:165], v7 offset:8256
    ds_read_b64_tr_b16 a[166:167], v7 offset:8768
    buffer_store_dwordx4 v[28:31], v2, s[20:23], s63 offen offset:2048 sc1
    v_fma_f32 v20, v72, v72, s60
    v_fma_f32 v21, v73, v73, s60
    v_mfma_f32_32x32x16_bf16 v[80:95], a[144:147], v[208:211], v[80:95]
    s_add_u32 s58, s42, 3834112
    ds_read_b64_tr_b16 a[168:169], v7 offset:9216
    ds_read_b64_tr_b16 a[170:171], v7 offset:9728
    buffer_load_dwordx4 v9, s[12:15], s58 offen lds
    v_fma_f32 v22, v74, v74, s60
    v_fma_f32 v23, v75, v75, s60
    v_mul_f32 v20, v20, v72
    v_mfma_f32_32x32x16_bf16 v[96:111], a[148:151], v[208:211], v[96:111]
    s_waitcnt lgkmcnt(8)
    ds_read_b64_tr_b16 a[172:173], v7 offset:9280
    ds_read_b64_tr_b16 a[174:175], v7 offset:9792
    v_mul_f32 v21, v21, v73
    v_mul_f32 v22, v22, v74
    v_mul_f32 v23, v23, v75
    v_exp_f32 v20, v20
    v_mfma_f32_32x32x16_bf16 v[80:95], a[152:155], v[212:215], v[80:95]
    s_add_u32 m0, s44, 47232
    ds_read_b64_tr_b16 a[144:145], v7 offset:10240
    ds_read_b64_tr_b16 a[146:147], v7 offset:10752
    v_exp_f32 v21, v21
    v_exp_f32 v22, v22
    v_exp_f32 v23, v23
    v_mfma_f32_32x32x16_bf16 v[96:111], a[156:159], v[212:215], v[96:111]
    s_waitcnt lgkmcnt(6)
    ds_read_b64_tr_b16 a[148:149], v7 offset:10304
    ds_read_b64_tr_b16 a[150:151], v7 offset:10816
    v_add_f32 v20, 1.0, v20
    v_add_f32 v21, 1.0, v21
    v_add_f32 v22, 1.0, v22
    v_add_f32 v23, 1.0, v23
    v_rcp_f32 v20, v20
    v_mfma_f32_32x32x16_bf16 v[80:95], a[160:163], v[216:219], v[80:95]
    s_add_u32 s58, s42, 4129024
    ds_read_b64_tr_b16 a[152:153], v7 offset:11264
    ds_read_b64_tr_b16 a[154:155], v7 offset:11776
    buffer_load_dwordx4 v9, s[12:15], s58 offen lds
    v_rcp_f32 v21, v21
    v_mfma_f32_32x32x16_bf16 v[96:111], a[164:167], v[216:219], v[96:111]
    s_waitcnt lgkmcnt(6)
    ds_read_b64_tr_b16 a[156:157], v7 offset:11328
    ds_read_b64_tr_b16 a[158:159], v7 offset:11840
    v_rcp_f32 v22, v22
    v_rcp_f32 v23, v23
    v_mul_f32 v20, v20, v72
    v_mul_f32 v21, v21, v73
    v_mfma_f32_32x32x16_bf16 v[80:95], a[168:171], v[220:223], v[80:95]
    s_add_u32 m0, s44, 49280
    ds_read_b64_tr_b16 a[160:161], v7 offset:12288
    ds_read_b64_tr_b16 a[162:163], v7 offset:12800
    v_mul_f32 v22, v22, v74
    v_mul_f32 v23, v23, v75
    v_cvt_pk_bf16_f32 v32, v20, v21
    v_cvt_pk_bf16_f32 v33, v22, v23
    v_accvgpr_write_b32 a12, v32
    v_accvgpr_write_b32 a13, v33
    v_mfma_f32_32x32x16_bf16 v[96:111], a[172:175], v[220:223], v[96:111]
    s_waitcnt lgkmcnt(6)
    ds_read_b64_tr_b16 a[164:165], v7 offset:12352
    ds_read_b64_tr_b16 a[166:167], v7 offset:12864
    v_fma_f32 v24, v76, v76, s60
    v_fma_f32 v25, v77, v77, s60
    v_fma_f32 v26, v78, v78, s60
    v_fma_f32 v27, v79, v79, s60
    v_mul_f32 v24, v24, v76
    v_mul_f32 v25, v25, v77
    v_mfma_f32_32x32x16_bf16 v[80:95], a[144:147], v[224:227], v[80:95]
    s_add_u32 s58, s42, 4423936
    ds_read_b64_tr_b16 a[168:169], v7 offset:13312
    ds_read_b64_tr_b16 a[170:171], v7 offset:13824
    buffer_load_dwordx4 v9, s[12:15], s58 offen lds
    v_mul_f32 v26, v26, v78
    v_mul_f32 v27, v27, v79
    v_mfma_f32_32x32x16_bf16 v[96:111], a[148:151], v[224:227], v[96:111]
    s_waitcnt lgkmcnt(6)
    ds_read_b64_tr_b16 a[172:173], v7 offset:13376
    ds_read_b64_tr_b16 a[174:175], v7 offset:13888
    v_exp_f32 v24, v24
    v_exp_f32 v25, v25
    v_exp_f32 v26, v26
    v_mfma_f32_32x32x16_bf16 v[80:95], a[152:155], v[228:231], v[80:95]
    s_add_u32 m0, s44, 51328
    ds_read_b64_tr_b16 a[144:145], v7 offset:14336
    ds_read_b64_tr_b16 a[146:147], v7 offset:14848
    v_exp_f32 v27, v27
    v_add_f32 v24, 1.0, v24
    v_add_f32 v25, 1.0, v25
    v_add_f32 v26, 1.0, v26
    v_add_f32 v27, 1.0, v27
    v_mfma_f32_32x32x16_bf16 v[96:111], a[156:159], v[228:231], v[96:111]
    s_waitcnt lgkmcnt(6)
    ds_read_b64_tr_b16 a[148:149], v7 offset:14400
    ds_read_b64_tr_b16 a[150:151], v7 offset:14912
    v_rcp_f32 v24, v24
    v_rcp_f32 v25, v25
    v_rcp_f32 v26, v26
    v_mfma_f32_32x32x16_bf16 v[80:95], a[160:163], v[232:235], v[80:95]
    s_add_u32 s58, s42, 4718848
    ds_read_b64_tr_b16 a[152:153], v7 offset:15360
    ds_read_b64_tr_b16 a[154:155], v7 offset:15872
    buffer_load_dwordx4 v9, s[12:15], s58 offen lds
    v_rcp_f32 v27, v27
    v_mul_f32 v24, v24, v76
    v_mfma_f32_32x32x16_bf16 v[96:111], a[164:167], v[232:235], v[96:111]
    s_waitcnt lgkmcnt(6)
    ds_read_b64_tr_b16 a[156:157], v7 offset:15424
    ds_read_b64_tr_b16 a[158:159], v7 offset:15936
    v_mul_f32 v25, v25, v77
    v_mul_f32 v26, v26, v78
    v_mul_f32 v27, v27, v79
    v_cvt_pk_bf16_f32 v34, v24, v25
    v_cvt_pk_bf16_f32 v35, v26, v27
    v_accvgpr_write_b32 a14, v34
    v_mfma_f32_32x32x16_bf16 v[80:95], a[168:171], v[236:239], v[80:95]
    s_add_u32 m0, s44, 53376
    ds_read_b64_tr_b16 a[160:161], v7 offset:16384
    ds_read_b64_tr_b16 a[162:163], v7 offset:16896
    ds_read_b128 v[72:75], v15 offset:704
    ds_read_b128 v[76:79], v15 offset:736
    v_accvgpr_write_b32 a15, v35
    v_mfma_f32_32x32x16_bf16 v[96:111], a[172:175], v[236:239], v[96:111]
    s_waitcnt lgkmcnt(8)
    ds_read_b64_tr_b16 a[164:165], v7 offset:16448
    ds_read_b64_tr_b16 a[166:167], v7 offset:16960
    buffer_store_dwordx4 v[32:35], v2, s[20:23], s63 offen offset:3072 sc1
    v_mfma_f32_32x32x16_bf16 v[80:95], a[144:147], v[240:243], v[80:95]
    s_add_u32 s58, s42, 5013760
    ds_read_b64_tr_b16 a[168:169], v7 offset:17408
    ds_read_b64_tr_b16 a[170:171], v7 offset:17920
    buffer_load_dwordx4 v9, s[12:15], s58 offen lds
    v_mfma_f32_32x32x16_bf16 v[96:111], a[148:151], v[240:243], v[96:111]
    s_waitcnt lgkmcnt(8)
    ds_read_b64_tr_b16 a[172:173], v7 offset:17472
    ds_read_b64_tr_b16 a[174:175], v7 offset:17984
    v_mfma_f32_32x32x16_bf16 v[80:95], a[152:155], v[244:247], v[80:95]
    s_waitcnt vmcnt(12)
    s_barrier
    ds_read_b64_tr_b16 a[144:145], v4 offset:0
    ds_read_b64_tr_b16 a[146:147], v4 offset:512
    v_mfma_f32_32x32x16_bf16 v[96:111], a[156:159], v[244:247], v[96:111]
    s_waitcnt lgkmcnt(6)
    ds_read_b64_tr_b16 a[148:149], v4 offset:64
    ds_read_b64_tr_b16 a[150:151], v4 offset:576
    v_mfma_f32_32x32x16_bf16 v[80:95], a[160:163], v[248:251], v[80:95]
    s_add_u32 m0, s44, 73984
    ds_read_b64_tr_b16 a[152:153], v4 offset:1024
    ds_read_b64_tr_b16 a[154:155], v4 offset:1536
    s_add_u32 s58, s42, 384
    buffer_load_dwordx4 v9, s[12:15], s58 offen lds
    v_mfma_f32_32x32x16_bf16 v[96:111], a[164:167], v[248:251], v[96:111]
    s_waitcnt lgkmcnt(6)
    ds_read_b64_tr_b16 a[156:157], v4 offset:1088
    ds_read_b64_tr_b16 a[158:159], v4 offset:1600
    v_mfma_f32_32x32x16_bf16 v[80:95], a[168:171], v[252:255], v[80:95]
    s_add_u32 m0, s44, 76032
    ds_read_b64_tr_b16 a[160:161], v4 offset:2048
    ds_read_b64_tr_b16 a[162:163], v4 offset:2560
    v_mfma_f32_32x32x16_bf16 v[96:111], a[172:175], v[252:255], v[96:111]
    s_waitcnt lgkmcnt(6)
    ds_read_b64_tr_b16 a[164:165], v4 offset:2112
    ds_read_b64_tr_b16 a[166:167], v4 offset:2624
    v_mfma_f32_32x32x16_bf16 v[48:63], a[144:147], v[112:115], v[48:63]
    s_add_u32 s58, s42, 295296
    ds_read_b64_tr_b16 a[168:169], v4 offset:3072
    ds_read_b64_tr_b16 a[170:171], v4 offset:3584
    buffer_load_dwordx4 v9, s[12:15], s58 offen lds
    v_fma_f32 v20, v80, v80, s60
    v_fma_f32 v21, v81, v81, s60
    v_fma_f32 v22, v82, v82, s60
    v_mfma_f32_32x32x16_bf16 v[64:79], a[148:151], v[112:115], v[64:79]
    s_waitcnt lgkmcnt(6)
    ds_read_b64_tr_b16 a[172:173], v4 offset:3136
    ds_read_b64_tr_b16 a[174:175], v4 offset:3648
    v_fma_f32 v23, v83, v83, s60
    v_mul_f32 v20, v20, v80
    v_mul_f32 v21, v21, v81
    v_mul_f32 v22, v22, v82
    v_mul_f32 v23, v23, v83
    v_mfma_f32_32x32x16_bf16 v[48:63], a[152:155], v[116:119], v[48:63]
    s_add_u32 m0, s44, 78080
    ds_read_b64_tr_b16 a[144:145], v4 offset:4096
    ds_read_b64_tr_b16 a[146:147], v4 offset:4608
    v_exp_f32 v20, v20
    v_exp_f32 v21, v21
    v_exp_f32 v22, v22
    v_mfma_f32_32x32x16_bf16 v[64:79], a[156:159], v[116:119], v[64:79]
    s_waitcnt lgkmcnt(6)
    ds_read_b64_tr_b16 a[148:149], v4 offset:4160
    ds_read_b64_tr_b16 a[150:151], v4 offset:4672
    v_exp_f32 v23, v23
    v_add_f32 v20, 1.0, v20
    v_add_f32 v21, 1.0, v21
    v_add_f32 v22, 1.0, v22
    v_add_f32 v23, 1.0, v23
    v_mfma_f32_32x32x16_bf16 v[48:63], a[160:163], v[120:123], v[48:63]
    s_add_u32 s58, s42, 590208
    ds_read_b64_tr_b16 a[152:153], v4 offset:5120
    ds_read_b64_tr_b16 a[154:155], v4 offset:5632
    buffer_load_dwordx4 v9, s[12:15], s58 offen lds
    v_rcp_f32 v20, v20
    v_mfma_f32_32x32x16_bf16 v[64:79], a[164:167], v[120:123], v[64:79]
    s_waitcnt lgkmcnt(6)
    ds_read_b64_tr_b16 a[156:157], v4 offset:5184
    ds_read_b64_tr_b16 a[158:159], v4 offset:5696
    v_rcp_f32 v21, v21
    v_rcp_f32 v22, v22
    v_rcp_f32 v23, v23
    v_mfma_f32_32x32x16_bf16 v[48:63], a[168:171], v[124:127], v[48:63]
    s_add_u32 m0, s44, 80128
    ds_read_b64_tr_b16 a[160:161], v4 offset:6144
    ds_read_b64_tr_b16 a[162:163], v4 offset:6656
    v_mul_f32 v20, v20, v80
    v_mul_f32 v21, v21, v81
    v_mul_f32 v22, v22, v82
    v_mul_f32 v23, v23, v83
    v_cvt_pk_bf16_f32 v28, v20, v21
    v_cvt_pk_bf16_f32 v29, v22, v23
    v_mfma_f32_32x32x16_bf16 v[64:79], a[172:175], v[124:127], v[64:79]
    s_waitcnt lgkmcnt(6)
    ds_read_b64_tr_b16 a[164:165], v4 offset:6208
    ds_read_b64_tr_b16 a[166:167], v4 offset:6720
    v_accvgpr_write_b32 a16, v28
    v_accvgpr_write_b32 a17, v29
    v_fma_f32 v24, v84, v84, s60
    v_fma_f32 v25, v85, v85, s60
    v_fma_f32 v26, v86, v86, s60
    v_fma_f32 v27, v87, v87, s60
    v_mfma_f32_32x32x16_bf16 v[48:63], a[144:147], v[128:131], v[48:63]
    s_add_u32 s58, s42, 885120
    ds_read_b64_tr_b16 a[168:169], v4 offset:7168
    ds_read_b64_tr_b16 a[170:171], v4 offset:7680
    buffer_load_dwordx4 v9, s[12:15], s58 offen lds
    v_mul_f32 v24, v24, v84
    v_mul_f32 v25, v25, v85
    v_mul_f32 v26, v26, v86
    v_mfma_f32_32x32x16_bf16 v[64:79], a[148:151], v[128:131], v[64:79]
    s_waitcnt lgkmcnt(6)
    ds_read_b64_tr_b16 a[172:173], v4 offset:7232
    ds_read_b64_tr_b16 a[174:175], v4 offset:7744
    v_mul_f32 v27, v27, v87
    v_exp_f32 v24, v24
    v_exp_f32 v25, v25
    v_mfma_f32_32x32x16_bf16 v[48:63], a[152:155], v[132:135], v[48:63]
    s_add_u32 m0, s44, 82176
    ds_read_b64_tr_b16 a[144:145], v4 offset:8192
    ds_read_b64_tr_b16 a[146:147], v4 offset:8704
    v_exp_f32 v26, v26
    v_exp_f32 v27, v27
    v_add_f32 v24, 1.0, v24
    v_add_f32 v25, 1.0, v25
    v_mfma_f32_32x32x16_bf16 v[64:79], a[156:159], v[132:135], v[64:79]
    s_waitcnt lgkmcnt(6)
    ds_read_b64_tr_b16 a[148:149], v4 offset:8256
    ds_read_b64_tr_b16 a[150:151], v4 offset:8768
    v_add_f32 v26, 1.0, v26
    v_add_f32 v27, 1.0, v27
    v_rcp_f32 v24, v24
    v_rcp_f32 v25, v25
    v_mfma_f32_32x32x16_bf16 v[48:63], a[160:163], v[136:139], v[48:63]
    s_add_u32 s58, s42, 1180032
    ds_read_b64_tr_b16 a[152:153], v4 offset:9216
    ds_read_b64_tr_b16 a[154:155], v4 offset:9728
    buffer_load_dwordx4 v9, s[12:15], s58 offen lds
    v_rcp_f32 v26, v26
    v_mfma_f32_32x32x16_bf16 v[64:79], a[164:167], v[136:139], v[64:79]
    s_waitcnt lgkmcnt(6)
    ds_read_b64_tr_b16 a[156:157], v4 offset:9280
    ds_read_b64_tr_b16 a[158:159], v4 offset:9792
    v_rcp_f32 v27, v27
    v_mul_f32 v24, v24, v84
    v_mul_f32 v25, v25, v85
    v_mul_f32 v26, v26, v86
    v_mul_f32 v27, v27, v87
    v_mfma_f32_32x32x16_bf16 v[48:63], a[168:171], v[140:143], v[48:63]
    s_add_u32 m0, s44, 84224
    ds_read_b64_tr_b16 a[160:161], v4 offset:10240
    ds_read_b64_tr_b16 a[162:163], v4 offset:10752
    ds_read_b128 v[80:83], v15 offset:768
    ds_read_b128 v[84:87], v15 offset:800
    v_cvt_pk_bf16_f32 v30, v24, v25
    v_cvt_pk_bf16_f32 v31, v26, v27
    v_accvgpr_write_b32 a18, v30
    v_accvgpr_write_b32 a19, v31
    v_mfma_f32_32x32x16_bf16 v[64:79], a[172:175], v[140:143], v[64:79]
    s_waitcnt lgkmcnt(8)
    ds_read_b64_tr_b16 a[164:165], v4 offset:10304
    ds_read_b64_tr_b16 a[166:167], v4 offset:10816
    s_add_u32 s63, s55, 4096
    buffer_store_dwordx4 v[28:31], v2, s[20:23], s63 offen offset:0 sc1
    v_fma_f32 v20, v88, v88, s60
    v_fma_f32 v21, v89, v89, s60
    v_mfma_f32_32x32x16_bf16 v[48:63], a[144:147], v[144:147], v[48:63]
    s_add_u32 s58, s42, 1474944
    ds_read_b64_tr_b16 a[168:169], v4 offset:11264
    ds_read_b64_tr_b16 a[170:171], v4 offset:11776
    buffer_load_dwordx4 v9, s[12:15], s58 offen lds
    v_fma_f32 v22, v90, v90, s60
    v_fma_f32 v23, v91, v91, s60
    v_mul_f32 v20, v20, v88
    v_mfma_f32_32x32x16_bf16 v[64:79], a[148:151], v[144:147], v[64:79]
    s_waitcnt lgkmcnt(8)
    ds_read_b64_tr_b16 a[172:173], v4 offset:11328
    ds_read_b64_tr_b16 a[174:175], v4 offset:11840
    v_mul_f32 v21, v21, v89
    v_mul_f32 v22, v22, v90
    v_mul_f32 v23, v23, v91
    v_exp_f32 v20, v20
    v_mfma_f32_32x32x16_bf16 v[48:63], a[152:155], v[148:151], v[48:63]
    s_add_u32 m0, s44, 86272
    ds_read_b64_tr_b16 a[144:145], v4 offset:12288
    ds_read_b64_tr_b16 a[146:147], v4 offset:12800
    v_exp_f32 v21, v21
    v_exp_f32 v22, v22
    v_exp_f32 v23, v23
    v_mfma_f32_32x32x16_bf16 v[64:79], a[156:159], v[148:151], v[64:79]
    s_waitcnt lgkmcnt(6)
    ds_read_b64_tr_b16 a[148:149], v4 offset:12352
    ds_read_b64_tr_b16 a[150:151], v4 offset:12864
    v_add_f32 v20, 1.0, v20
    v_add_f32 v21, 1.0, v21
    v_add_f32 v22, 1.0, v22
    v_add_f32 v23, 1.0, v23
    v_rcp_f32 v20, v20
    v_mfma_f32_32x32x16_bf16 v[48:63], a[160:163], v[152:155], v[48:63]
    s_add_u32 s58, s42, 1769856
    ds_read_b64_tr_b16 a[152:153], v4 offset:13312
    ds_read_b64_tr_b16 a[154:155], v4 offset:13824
    buffer_load_dwordx4 v9, s[12:15], s58 offen lds
    v_rcp_f32 v21, v21
    v_mfma_f32_32x32x16_bf16 v[64:79], a[164:167], v[152:155], v[64:79]
    s_waitcnt lgkmcnt(6)
    ds_read_b64_tr_b16 a[156:157], v4 offset:13376
    ds_read_b64_tr_b16 a[158:159], v4 offset:13888
    v_rcp_f32 v22, v22
    v_rcp_f32 v23, v23
    v_mul_f32 v20, v20, v88
    v_mul_f32 v21, v21, v89
    v_mfma_f32_32x32x16_bf16 v[48:63], a[168:171], v[156:159], v[48:63]
    s_add_u32 m0, s44, 88320
    ds_read_b64_tr_b16 a[160:161], v4 offset:14336
    ds_read_b64_tr_b16 a[162:163], v4 offset:14848
    v_mul_f32 v22, v22, v90
    v_mul_f32 v23, v23, v91
    v_cvt_pk_bf16_f32 v32, v20, v21
    v_cvt_pk_bf16_f32 v33, v22, v23
    v_accvgpr_write_b32 a20, v32
    v_accvgpr_write_b32 a21, v33
    v_mfma_f32_32x32x16_bf16 v[64:79], a[172:175], v[156:159], v[64:79]
    s_waitcnt lgkmcnt(6)
    ds_read_b64_tr_b16 a[164:165], v4 offset:14400
    ds_read_b64_tr_b16 a[166:167], v4 offset:14912
    v_fma_f32 v24, v92, v92, s60
    v_fma_f32 v25, v93, v93, s60
    v_fma_f32 v26, v94, v94, s60
    v_fma_f32 v27, v95, v95, s60
    v_mul_f32 v24, v24, v92
    v_mul_f32 v25, v25, v93
    v_mfma_f32_32x32x16_bf16 v[48:63], a[144:147], v[160:163], v[48:63]
    s_add_u32 s58, s42, 2064768
    ds_read_b64_tr_b16 a[168:169], v4 offset:15360
    ds_read_b64_tr_b16 a[170:171], v4 offset:15872
    buffer_load_dwordx4 v9, s[12:15], s58 offen lds
    v_mul_f32 v26, v26, v94
    v_mul_f32 v27, v27, v95
    v_mfma_f32_32x32x16_bf16 v[64:79], a[148:151], v[160:163], v[64:79]
    s_waitcnt lgkmcnt(6)
    ds_read_b64_tr_b16 a[172:173], v4 offset:15424
    ds_read_b64_tr_b16 a[174:175], v4 offset:15936
    v_exp_f32 v24, v24
    v_exp_f32 v25, v25
    v_exp_f32 v26, v26
    v_mfma_f32_32x32x16_bf16 v[48:63], a[152:155], v[164:167], v[48:63]
    s_add_u32 m0, s44, 90368
    ds_read_b64_tr_b16 a[144:145], v4 offset:16384
    ds_read_b64_tr_b16 a[146:147], v4 offset:16896
    v_exp_f32 v27, v27
    v_add_f32 v24, 1.0, v24
    v_add_f32 v25, 1.0, v25
    v_add_f32 v26, 1.0, v26
    v_add_f32 v27, 1.0, v27
    v_mfma_f32_32x32x16_bf16 v[64:79], a[156:159], v[164:167], v[64:79]
    s_waitcnt lgkmcnt(6)
    ds_read_b64_tr_b16 a[148:149], v4 offset:16448
    ds_read_b64_tr_b16 a[150:151], v4 offset:16960
    v_rcp_f32 v24, v24
    v_rcp_f32 v25, v25
    v_rcp_f32 v26, v26
    v_mfma_f32_32x32x16_bf16 v[48:63], a[160:163], v[168:171], v[48:63]
    s_add_u32 s58, s42, 2359680
    ds_read_b64_tr_b16 a[152:153], v4 offset:17408
    ds_read_b64_tr_b16 a[154:155], v4 offset:17920
    buffer_load_dwordx4 v9, s[12:15], s58 offen lds
    v_rcp_f32 v27, v27
    v_mul_f32 v24, v24, v92
    v_mfma_f32_32x32x16_bf16 v[64:79], a[164:167], v[168:171], v[64:79]
    s_waitcnt lgkmcnt(6)
    ds_read_b64_tr_b16 a[156:157], v4 offset:17472
    ds_read_b64_tr_b16 a[158:159], v4 offset:17984
    v_mul_f32 v25, v25, v93
    v_mul_f32 v26, v26, v94
    v_mul_f32 v27, v27, v95
    v_cvt_pk_bf16_f32 v34, v24, v25
    v_cvt_pk_bf16_f32 v35, v26, v27
    v_accvgpr_write_b32 a22, v34
    v_mfma_f32_32x32x16_bf16 v[48:63], a[168:171], v[172:175], v[48:63]
    s_waitcnt vmcnt(10)
    s_barrier
    ds_read_b64_tr_b16 a[160:161], v5 offset:0
    ds_read_b64_tr_b16 a[162:163], v5 offset:512
    ds_read_b128 v[88:91], v15 offset:832
    ds_read_b128 v[92:95], v15 offset:864
    v_mfma_f32_32x32x16_bf16 v[64:79], a[172:175], v[172:175], v[64:79]
    s_waitcnt lgkmcnt(8)
    ds_read_b64_tr_b16 a[164:165], v5 offset:64
    ds_read_b64_tr_b16 a[166:167], v5 offset:576
    v_accvgpr_write_b32 a23, v35
    v_fma_f32 v20, v96, v96, s60
    v_fma_f32 v21, v97, v97, s60
    v_fma_f32 v22, v98, v98, s60
    v_fma_f32 v23, v99, v99, s60
    v_mul_f32 v20, v20, v96
    v_mfma_f32_32x32x16_bf16 v[48:63], a[144:147], v[176:179], v[48:63]
    s_add_u32 m0, s44, 110976
    ds_read_b64_tr_b16 a[168:169], v5 offset:1024
    ds_read_b64_tr_b16 a[170:171], v5 offset:1536
    s_add_u32 s58, s42, 2654592
    buffer_load_dwordx4 v9, s[12:15], s58 offen lds
    v_mul_f32 v21, v21, v97
    v_mul_f32 v22, v22, v98
    v_mfma_f32_32x32x16_bf16 v[64:79], a[148:151], v[176:179], v[64:79]
    s_waitcnt lgkmcnt(8)
    ds_read_b64_tr_b16 a[172:173], v5 offset:1088
    ds_read_b64_tr_b16 a[174:175], v5 offset:1600
    buffer_store_dwordx4 v[32:35], v2, s[20:23], s63 offen offset:1024 sc1
    v_mul_f32 v23, v23, v99
    v_mfma_f32_32x32x16_bf16 v[48:63], a[152:155], v[180:183], v[48:63]
    s_add_u32 m0, s44, 113024
    ds_read_b64_tr_b16 a[144:145], v5 offset:2048
    ds_read_b64_tr_b16 a[146:147], v5 offset:2560
    v_exp_f32 v20, v20
    v_exp_f32 v21, v21
    v_exp_f32 v22, v22
    v_mfma_f32_32x32x16_bf16 v[64:79], a[156:159], v[180:183], v[64:79]
    s_waitcnt lgkmcnt(6)
    ds_read_b64_tr_b16 a[148:149], v5 offset:2112
    ds_read_b64_tr_b16 a[150:151], v5 offset:2624
    v_exp_f32 v23, v23
    v_add_f32 v20, 1.0, v20
    v_add_f32 v21, 1.0, v21
    v_add_f32 v22, 1.0, v22
    v_add_f32 v23, 1.0, v23
    v_mfma_f32_32x32x16_bf16 v[48:63], a[160:163], v[184:187], v[48:63]
    s_add_u32 s58, s42, 2949504
    ds_read_b64_tr_b16 a[152:153], v5 offset:3072
    ds_read_b64_tr_b16 a[154:155], v5 offset:3584
    buffer_load_dwordx4 v9, s[12:15], s58 offen lds
    v_rcp_f32 v20, v20
    v_mfma_f32_32x32x16_bf16 v[64:79], a[164:167], v[184:187], v[64:79]
    s_waitcnt lgkmcnt(6)
    ds_read_b64_tr_b16 a[156:157], v5 offset:3136
    ds_read_b64_tr_b16 a[158:159], v5 offset:3648
    s_waitcnt vmcnt(14)
    s_mov_b64 exec, 1
    buffer_store_dword v37, v19, s[20:23], s56 offen offset:0 sc1
    s_mov_b64 exec, -1
    v_rcp_f32 v21, v21
    v_mfma_f32_32x32x16_bf16 v[48:63], a[168:171], v[188:191], v[48:63]
    s_add_u32 m0, s44, 115072
    ds_read_b64_tr_b16 a[160:161], v5 offset:4096
    ds_read_b64_tr_b16 a[162:163], v5 offset:4608
    v_rcp_f32 v22, v22
    v_rcp_f32 v23, v23
    v_mul_f32 v20, v20, v96
    v_mul_f32 v21, v21, v97
    v_mfma_f32_32x32x16_bf16 v[64:79], a[172:175], v[188:191], v[64:79]
    s_waitcnt lgkmcnt(6)
    ds_read_b64_tr_b16 a[164:165], v5 offset:4160
    ds_read_b64_tr_b16 a[166:167], v5 offset:4672
    v_mul_f32 v22, v22, v98
    v_mul_f32 v23, v23, v99
    v_cvt_pk_bf16_f32 v28, v20, v21
    v_cvt_pk_bf16_f32 v29, v22, v23
    v_accvgpr_write_b32 a24, v28
    v_accvgpr_write_b32 a25, v29
    v_mfma_f32_32x32x16_bf16 v[48:63], a[144:147], v[192:195], v[48:63]
    s_add_u32 s58, s42, 3244416
    ds_read_b64_tr_b16 a[168:169], v5 offset:5120
    ds_read_b64_tr_b16 a[170:171], v5 offset:5632
    buffer_load_dwordx4 v9, s[12:15], s58 offen lds
    v_fma_f32 v24, v100, v100, s60
    v_fma_f32 v25, v101, v101, s60
    v_fma_f32 v26, v102, v102, s60
    v_mfma_f32_32x32x16_bf16 v[64:79], a[148:151], v[192:195], v[64:79]
    s_waitcnt lgkmcnt(6)
    ds_read_b64_tr_b16 a[172:173], v5 offset:5184
    ds_read_b64_tr_b16 a[174:175], v5 offset:5696
    v_fma_f32 v27, v103, v103, s60
    v_mul_f32 v24, v24, v100
    v_mul_f32 v25, v25, v101
    v_mul_f32 v26, v26, v102
    v_mul_f32 v27, v27, v103
    v_mfma_f32_32x32x16_bf16 v[48:63], a[152:155], v[196:199], v[48:63]
    s_add_u32 m0, s44, 117120
    ds_read_b64_tr_b16 a[144:145], v5 offset:6144
    ds_read_b64_tr_b16 a[146:147], v5 offset:6656
    v_exp_f32 v24, v24
    v_exp_f32 v25, v25
    v_exp_f32 v26, v26
    v_mfma_f32_32x32x16_bf16 v[64:79], a[156:159], v[196:199], v[64:79]
    s_waitcnt lgkmcnt(6)
    ds_read_b64_tr_b16 a[148:149], v5 offset:6208
    ds_read_b64_tr_b16 a[150:151], v5 offset:6720
    v_exp_f32 v27, v27
    v_add_f32 v24, 1.0, v24
    v_add_f32 v25, 1.0, v25
    v_add_f32 v26, 1.0, v26
    v_add_f32 v27, 1.0, v27
    v_mfma_f32_32x32x16_bf16 v[48:63], a[160:163], v[200:203], v[48:63]
    s_add_u32 s58, s42, 3539328
    ds_read_b64_tr_b16 a[152:153], v5 offset:7168
    ds_read_b64_tr_b16 a[154:155], v5 offset:7680
    buffer_load_dwordx4 v9, s[12:15], s58 offen lds
    v_rcp_f32 v24, v24
    v_mfma_f32_32x32x16_bf16 v[64:79], a[164:167], v[200:203], v[64:79]
    s_waitcnt lgkmcnt(6)
    ds_read_b64_tr_b16 a[156:157], v5 offset:7232
    ds_read_b64_tr_b16 a[158:159], v5 offset:7744
    v_rcp_f32 v25, v25
    v_rcp_f32 v26, v26
    v_rcp_f32 v27, v27
    v_mfma_f32_32x32x16_bf16 v[48:63], a[168:171], v[204:207], v[48:63]
    s_add_u32 m0, s44, 119168
    ds_read_b64_tr_b16 a[160:161], v5 offset:8192
    ds_read_b64_tr_b16 a[162:163], v5 offset:8704
    v_mul_f32 v24, v24, v100
    v_mul_f32 v25, v25, v101
    v_mul_f32 v26, v26, v102
    v_mul_f32 v27, v27, v103
    v_cvt_pk_bf16_f32 v30, v24, v25
    v_cvt_pk_bf16_f32 v31, v26, v27
    v_mfma_f32_32x32x16_bf16 v[64:79], a[172:175], v[204:207], v[64:79]
    s_waitcnt lgkmcnt(6)
    ds_read_b64_tr_b16 a[164:165], v5 offset:8256
    ds_read_b64_tr_b16 a[166:167], v5 offset:8768
    ds_read_b128 v[96:99], v15 offset:896
    ds_read_b128 v[100:103], v15 offset:928
    v_accvgpr_write_b32 a26, v30
    v_accvgpr_write_b32 a27, v31
    v_fma_f32 v20, v104, v104, s60
    v_fma_f32 v21, v105, v105, s60
    v_mfma_f32_32x32x16_bf16 v[48:63], a[144:147], v[208:211], v[48:63]
    s_add_u32 s58, s42, 3834240
    ds_read_b64_tr_b16 a[168:169], v5 offset:9216
    ds_read_b64_tr_b16 a[170:171], v5 offset:9728
    buffer_load_dwordx4 v9, s[12:15], s58 offen lds
    v_fma_f32 v22, v106, v106, s60
    v_fma_f32 v23, v107, v107, s60
    v_mul_f32 v20, v20, v104
    v_mfma_f32_32x32x16_bf16 v[64:79], a[148:151], v[208:211], v[64:79]
    s_waitcnt lgkmcnt(8)
    ds_read_b64_tr_b16 a[172:173], v5 offset:9280
    ds_read_b64_tr_b16 a[174:175], v5 offset:9792
    buffer_store_dwordx4 v[28:31], v2, s[20:23], s63 offen offset:2048 sc1
    v_mul_f32 v21, v21, v105
    v_mul_f32 v22, v22, v106
    v_mfma_f32_32x32x16_bf16 v[48:63], a[152:155], v[212:215], v[48:63]
    s_add_u32 m0, s44, 121216
    ds_read_b64_tr_b16 a[144:145], v5 offset:10240
    ds_read_b64_tr_b16 a[146:147], v5 offset:10752
    v_mul_f32 v23, v23, v107
    v_exp_f32 v20, v20
    v_exp_f32 v21, v21
    v_mfma_f32_32x32x16_bf16 v[64:79], a[156:159], v[212:215], v[64:79]
    s_waitcnt lgkmcnt(8)
    ds_read_b64_tr_b16 a[148:149], v5 offset:10304
    ds_read_b64_tr_b16 a[150:151], v5 offset:10816
    v_exp_f32 v22, v22
    v_exp_f32 v23, v23
    v_add_f32 v20, 1.0, v20
    v_add_f32 v21, 1.0, v21
    v_mfma_f32_32x32x16_bf16 v[48:63], a[160:163], v[216:219], v[48:63]
    s_add_u32 s58, s42, 4129152
    ds_read_b64_tr_b16 a[152:153], v5 offset:11264
    ds_read_b64_tr_b16 a[154:155], v5 offset:11776
    buffer_load_dwordx4 v9, s[12:15], s58 offen lds
    v_add_f32 v22, 1.0, v22
    v_add_f32 v23, 1.0, v23
    v_mfma_f32_32x32x16_bf16 v[64:79], a[164:167], v[216:219], v[64:79]
    s_waitcnt lgkmcnt(6)
    ds_read_b64_tr_b16 a[156:157], v5 offset:11328
    ds_read_b64_tr_b16 a[158:159], v5 offset:11840
    v_rcp_f32 v20, v20
    v_rcp_f32 v21, v21
    v_rcp_f32 v22, v22
    v_mfma_f32_32x32x16_bf16 v[48:63], a[168:171], v[220:223], v[48:63]
    s_add_u32 m0, s44, 123264
    ds_read_b64_tr_b16 a[160:161], v5 offset:12288
    ds_read_b64_tr_b16 a[162:163], v5 offset:12800
    v_rcp_f32 v23, v23
    v_mul_f32 v20, v20, v104
    v_mul_f32 v21, v21, v105
    v_mul_f32 v22, v22, v106
    v_mul_f32 v23, v23, v107
    v_mfma_f32_32x32x16_bf16 v[64:79], a[172:175], v[220:223], v[64:79]
    s_waitcnt lgkmcnt(6)
    ds_read_b64_tr_b16 a[164:165], v5 offset:12352
    ds_read_b64_tr_b16 a[166:167], v5 offset:12864
    v_cvt_pk_bf16_f32 v32, v20, v21
    v_cvt_pk_bf16_f32 v33, v22, v23
    v_accvgpr_write_b32 a28, v32
    v_accvgpr_write_b32 a29, v33
    v_fma_f32 v24, v108, v108, s60
    v_fma_f32 v25, v109, v109, s60
    v_mfma_f32_32x32x16_bf16 v[48:63], a[144:147], v[224:227], v[48:63]
    s_add_u32 s58, s42, 4424064
    ds_read_b64_tr_b16 a[168:169], v5 offset:13312
    ds_read_b64_tr_b16 a[170:171], v5 offset:13824
    buffer_load_dwordx4 v9, s[12:15], s58 offen lds
    v_fma_f32 v26, v110, v110, s60
    v_fma_f32 v27, v111, v111, s60
    v_mul_f32 v24, v24, v108
    v_mfma_f32_32x32x16_bf16 v[64:79], a[148:151], v[224:227], v[64:79]
    s_waitcnt lgkmcnt(6)
    ds_read_b64_tr_b16 a[172:173], v5 offset:13376
    ds_read_b64_tr_b16 a[174:175], v5 offset:13888
    s_add_u32 m0, s44, 125312
    s_add_u32 s58, s42, 4718976
    buffer_load_dwordx4 v9, s[12:15], s58 offen lds
    v_mul_f32 v25, v25, v109
    v_mfma_f32_32x32x16_bf16 v[48:63], a[152:155], v[228:231], v[48:63]
    s_add_u32 m0, s44, 127360
    ds_read_b64_tr_b16 a[144:145], v5 offset:14336
    ds_read_b64_tr_b16 a[146:147], v5 offset:14848
    s_add_u32 s58, s42, 5013888
    buffer_load_dwordx4 v9, s[12:15], s58 offen lds
    v_mul_f32 v26, v26, v110
    v_mul_f32 v27, v27, v111
    v_mfma_f32_32x32x16_bf16 v[64:79], a[156:159], v[228:231], v[64:79]
    s_waitcnt lgkmcnt(6)
    ds_read_b64_tr_b16 a[148:149], v5 offset:14400
    ds_read_b64_tr_b16 a[150:151], v5 offset:14912
    v_exp_f32 v24, v24
    v_exp_f32 v25, v25
    v_exp_f32 v26, v26
    v_mfma_f32_32x32x16_bf16 v[48:63], a[160:163], v[232:235], v[48:63]
    ds_read_b64_tr_b16 a[152:153], v5 offset:15360
    ds_read_b64_tr_b16 a[154:155], v5 offset:15872
    v_exp_f32 v27, v27
    v_add_f32 v24, 1.0, v24
    v_add_f32 v25, 1.0, v25
    v_add_f32 v26, 1.0, v26
    v_add_f32 v27, 1.0, v27
    v_mfma_f32_32x32x16_bf16 v[64:79], a[164:167], v[232:235], v[64:79]
    s_waitcnt lgkmcnt(6)
    ds_read_b64_tr_b16 a[156:157], v5 offset:15424
    ds_read_b64_tr_b16 a[158:159], v5 offset:15936
    v_rcp_f32 v24, v24
    v_rcp_f32 v25, v25
    v_rcp_f32 v26, v26
    v_mfma_f32_32x32x16_bf16 v[48:63], a[168:171], v[236:239], v[48:63]
    ds_read_b64_tr_b16 a[160:161], v5 offset:16384
    ds_read_b64_tr_b16 a[162:163], v5 offset:16896
    v_rcp_f32 v27, v27
    v_mul_f32 v24, v24, v108
    v_mul_f32 v25, v25, v109
    v_mul_f32 v26, v26, v110
    v_mul_f32 v27, v27, v111
    v_mfma_f32_32x32x16_bf16 v[64:79], a[172:175], v[236:239], v[64:79]
    s_waitcnt lgkmcnt(6)
    ds_read_b64_tr_b16 a[164:165], v5 offset:16448
    ds_read_b64_tr_b16 a[166:167], v5 offset:16960
    ds_read_b128 v[104:107], v15 offset:960
    ds_read_b128 v[108:111], v15 offset:992
    v_cvt_pk_bf16_f32 v34, v24, v25
    v_cvt_pk_bf16_f32 v35, v26, v27
    v_accvgpr_write_b32 a30, v34
    v_accvgpr_write_b32 a31, v35
    v_mfma_f32_32x32x16_bf16 v[48:63], a[144:147], v[240:243], v[48:63]
    ds_read_b64_tr_b16 a[168:169], v5 offset:17408
    ds_read_b64_tr_b16 a[170:171], v5 offset:17920
    buffer_store_dwordx4 v[32:35], v2, s[20:23], s63 offen offset:3072 sc1
    v_mfma_f32_32x32x16_bf16 v[64:79], a[148:151], v[240:243], v[64:79]
    s_waitcnt lgkmcnt(8)
    ds_read_b64_tr_b16 a[172:173], v5 offset:17472
    ds_read_b64_tr_b16 a[174:175], v5 offset:17984
    v_mfma_f32_32x32x16_bf16 v[48:63], a[152:155], v[244:247], v[48:63]
    s_waitcnt vmcnt(13)
    s_barrier
    ds_read_b64_tr_b16 a[144:145], v6 offset:0
    ds_read_b64_tr_b16 a[146:147], v6 offset:512
    v_mfma_f32_32x32x16_bf16 v[64:79], a[156:159], v[244:247], v[64:79]
    s_waitcnt lgkmcnt(8)
    ds_read_b64_tr_b16 a[148:149], v6 offset:64
    ds_read_b64_tr_b16 a[150:151], v6 offset:576
    v_mfma_f32_32x32x16_bf16 v[48:63], a[160:163], v[248:251], v[48:63]
    s_add_u32 m0, s48, 0
    ds_read_b64_tr_b16 a[152:153], v6 offset:1024
    ds_read_b64_tr_b16 a[154:155], v6 offset:1536
    s_add_u32 s58, s43, 0
    buffer_load_dwordx4 v10, s[12:15], s58 offen lds
    v_mfma_f32_32x32x16_bf16 v[64:79], a[164:167], v[248:251], v[64:79]
    s_waitcnt lgkmcnt(6)
    ds_read_b64_tr_b16 a[156:157], v6 offset:1088
    ds_read_b64_tr_b16 a[158:159], v6 offset:1600
    s_xor_b32 s70, s56, 8192
    buffer_load_dword v36, v19, s[20:23], s70 offen offset:0 sc1
    v_mfma_f32_32x32x16_bf16 v[48:63], a[168:171], v[252:255], v[48:63]
    s_add_u32 m0, s48, 4096
    ds_read_b64_tr_b16 a[160:161], v6 offset:2048
    ds_read_b64_tr_b16 a[162:163], v6 offset:2560
    v_mfma_f32_32x32x16_bf16 v[64:79], a[172:175], v[252:255], v[64:79]
    s_waitcnt lgkmcnt(6)
    ds_read_b64_tr_b16 a[164:165], v6 offset:2112
    ds_read_b64_tr_b16 a[166:167], v6 offset:2624
    s_add_u32 s58, s43, 589824
    buffer_load_dwordx4 v10, s[12:15], s58 offen lds
    v_mfma_f32_32x32x16_bf16 v[80:95], a[144:147], v[112:115], v[80:95]
    s_add_u32 m0, s48, 8192
    ds_read_b64_tr_b16 a[168:169], v6 offset:3072
    ds_read_b64_tr_b16 a[170:171], v6 offset:3584
    v_fma_f32 v20, v48, v48, s60
    v_fma_f32 v21, v49, v49, s60
    v_fma_f32 v22, v50, v50, s60
    v_fma_f32 v23, v51, v51, s60
    v_mul_f32 v20, v20, v48
    v_mul_f32 v21, v21, v49
    v_mfma_f32_32x32x16_bf16 v[96:111], a[148:151], v[112:115], v[96:111]
    s_waitcnt lgkmcnt(6)
    ds_read_b64_tr_b16 a[172:173], v6 offset:3136
    ds_read_b64_tr_b16 a[174:175], v6 offset:3648
    v_mul_f32 v22, v22, v50
    v_mul_f32 v23, v23, v51
    v_exp_f32 v20, v20
    v_exp_f32 v21, v21
    v_mfma_f32_32x32x16_bf16 v[80:95], a[152:155], v[116:119], v[80:95]
    s_add_u32 s58, s43, 1179648
    ds_read_b64_tr_b16 a[144:145], v6 offset:4096
    ds_read_b64_tr_b16 a[146:147], v6 offset:4608
    buffer_load_dwordx4 v10, s[12:15], s58 offen lds
    v_exp_f32 v22, v22
    v_mfma_f32_32x32x16_bf16 v[96:111], a[156:159], v[116:119], v[96:111]
    s_waitcnt lgkmcnt(6)
    ds_read_b64_tr_b16 a[148:149], v6 offset:4160
    ds_read_b64_tr_b16 a[150:151], v6 offset:4672
    v_exp_f32 v23, v23
    v_add_f32 v20, 1.0, v20
    v_add_f32 v21, 1.0, v21
    v_add_f32 v22, 1.0, v22
    v_add_f32 v23, 1.0, v23
    v_mfma_f32_32x32x16_bf16 v[80:95], a[160:163], v[120:123], v[80:95]
    s_add_u32 m0, s48, 12288
    ds_read_b64_tr_b16 a[152:153], v6 offset:5120
    ds_read_b64_tr_b16 a[154:155], v6 offset:5632
    v_rcp_f32 v20, v20
    v_rcp_f32 v21, v21
    v_rcp_f32 v22, v22
    v_mfma_f32_32x32x16_bf16 v[96:111], a[164:167], v[120:123], v[96:111]
    s_waitcnt lgkmcnt(6)
    ds_read_b64_tr_b16 a[156:157], v6 offset:5184
    ds_read_b64_tr_b16 a[158:159], v6 offset:5696
    s_add_u32 s58, s43, 1769472
    buffer_load_dwordx4 v10, s[12:15], s58 offen lds
    v_rcp_f32 v23, v23
    v_mfma_f32_32x32x16_bf16 v[80:95], a[168:171], v[124:127], v[80:95]
    s_add_u32 m0, s48, 16384
    ds_read_b64_tr_b16 a[160:161], v6 offset:6144
    ds_read_b64_tr_b16 a[162:163], v6 offset:6656
    v_mul_f32 v20, v20, v48
    v_mul_f32 v21, v21, v49
    v_mul_f32 v22, v22, v50
    v_mul_f32 v23, v23, v51
    v_cvt_pk_bf16_f32 v28, v20, v21
    v_cvt_pk_bf16_f32 v29, v22, v23
    v_mfma_f32_32x32x16_bf16 v[96:111], a[172:175], v[124:127], v[96:111]
    s_waitcnt lgkmcnt(6)
    ds_read_b64_tr_b16 a[164:165], v6 offset:6208
    ds_read_b64_tr_b16 a[166:167], v6 offset:6720
    v_accvgpr_write_b32 a32, v28
    v_accvgpr_write_b32 a33, v29
    v_fma_f32 v24, v52, v52, s60
    v_fma_f32 v25, v53, v53, s60
    v_fma_f32 v26, v54, v54, s60
    v_fma_f32 v27, v55, v55, s60
    v_mfma_f32_32x32x16_bf16 v[80:95], a[144:147], v[128:131], v[80:95]
    s_add_u32 s58, s43, 2359296
    ds_read_b64_tr_b16 a[168:169], v6 offset:7168
    ds_read_b64_tr_b16 a[170:171], v6 offset:7680
    buffer_load_dwordx4 v10, s[12:15], s58 offen lds
    v_mul_f32 v24, v24, v52
    v_mul_f32 v25, v25, v53
    v_mul_f32 v26, v26, v54
    v_mfma_f32_32x32x16_bf16 v[96:111], a[148:151], v[128:131], v[96:111]
    s_waitcnt lgkmcnt(6)
    ds_read_b64_tr_b16 a[172:173], v6 offset:7232
    ds_read_b64_tr_b16 a[174:175], v6 offset:7744
    v_mul_f32 v27, v27, v55
    v_exp_f32 v24, v24
    v_exp_f32 v25, v25
    v_mfma_f32_32x32x16_bf16 v[80:95], a[152:155], v[132:135], v[80:95]
    s_add_u32 m0, s48, 20480
    ds_read_b64_tr_b16 a[144:145], v6 offset:8192
    ds_read_b64_tr_b16 a[146:147], v6 offset:8704
    v_exp_f32 v26, v26
    v_exp_f32 v27, v27
    v_add_f32 v24, 1.0, v24
    v_add_f32 v25, 1.0, v25
    v_mfma_f32_32x32x16_bf16 v[96:111], a[156:159], v[132:135], v[96:111]
    s_waitcnt lgkmcnt(6)
    ds_read_b64_tr_b16 a[148:149], v6 offset:8256
    ds_read_b64_tr_b16 a[150:151], v6 offset:8768
    s_add_u32 s58, s43, 2949120
    buffer_load_dwordx4 v10, s[12:15], s58 offen lds
    v_add_f32 v26, 1.0, v26
    v_add_f32 v27, 1.0, v27
    v_mfma_f32_32x32x16_bf16 v[80:95], a[160:163], v[136:139], v[80:95]
    s_add_u32 m0, s48, 24576
    ds_read_b64_tr_b16 a[152:153], v6 offset:9216
    ds_read_b64_tr_b16 a[154:155], v6 offset:9728
    v_rcp_f32 v24, v24
    v_rcp_f32 v25, v25
    v_rcp_f32 v26, v26
    v_mfma_f32_32x32x16_bf16 v[96:111], a[164:167], v[136:139], v[96:111]
    s_waitcnt lgkmcnt(6)
    ds_read_b64_tr_b16 a[156:157], v6 offset:9280
    ds_read_b64_tr_b16 a[158:159], v6 offset:9792
    v_rcp_f32 v27, v27
    v_mul_f32 v24, v24, v52
    v_mul_f32 v25, v25, v53
    v_mul_f32 v26, v26, v54
    v_mul_f32 v27, v27, v55
    v_mfma_f32_32x32x16_bf16 v[80:95], a[168:171], v[140:143], v[80:95]
    s_add_u32 s58, s43, 3538944
    ds_read_b64_tr_b16 a[160:161], v6 offset:10240
    ds_read_b64_tr_b16 a[162:163], v6 offset:10752
    ds_read_b128 v[48:51], v15 offset:1024
    ds_read_b128 v[52:55], v15 offset:1056
    buffer_load_dwordx4 v10, s[12:15], s58 offen lds
    v_cvt_pk_bf16_f32 v30, v24, v25
    v_mfma_f32_32x32x16_bf16 v[96:111], a[172:175], v[140:143], v[96:111]
    s_waitcnt lgkmcnt(8)
    ds_read_b64_tr_b16 a[164:165], v6 offset:10304
    ds_read_b64_tr_b16 a[166:167], v6 offset:10816
    v_cvt_pk_bf16_f32 v31, v26, v27
    v_accvgpr_write_b32 a34, v30
    v_accvgpr_write_b32 a35, v31
    v_fma_f32 v20, v56, v56, s60
    v_fma_f32 v21, v57, v57, s60
    v_fma_f32 v22, v58, v58, s60
    v_mfma_f32_32x32x16_bf16 v[80:95], a[144:147], v[144:147], v[80:95]
    s_add_u32 m0, s48, 28672
    ds_read_b64_tr_b16 a[168:169], v6 offset:11264
    ds_read_b64_tr_b16 a[170:171], v6 offset:11776
    s_add_u32 s63, s55, 8192
    buffer_store_dwordx4 v[28:31], v2, s[20:23], s63 offen offset:0 sc1
    v_fma_f32 v23, v59, v59, s60
    v_mul_f32 v20, v20, v56
    v_mfma_f32_32x32x16_bf16 v[96:111], a[148:151], v[144:147], v[96:111]
    s_waitcnt lgkmcnt(8)
    ds_read_b64_tr_b16 a[172:173], v6 offset:11328
    ds_read_b64_tr_b16 a[174:175], v6 offset:11840
    s_add_u32 s58, s43, 4128768
    buffer_load_dwordx4 v10, s[12:15], s58 offen lds
    v_mul_f32 v21, v21, v57
    v_mul_f32 v22, v22, v58
    v_mfma_f32_32x32x16_bf16 v[80:95], a[152:155], v[148:151], v[80:95]
    s_add_u32 m0, s48, 32768
    ds_read_b64_tr_b16 a[144:145], v6 offset:12288
    ds_read_b64_tr_b16 a[146:147], v6 offset:12800
    v_mul_f32 v23, v23, v59
    v_exp_f32 v20, v20
    v_exp_f32 v21, v21
    v_mfma_f32_32x32x16_bf16 v[96:111], a[156:159], v[148:151], v[96:111]
    s_waitcnt lgkmcnt(6)
    ds_read_b64_tr_b16 a[148:149], v6 offset:12352
    ds_read_b64_tr_b16 a[150:151], v6 offset:12864
    v_exp_f32 v22, v22
    v_exp_f32 v23, v23
    v_add_f32 v20, 1.0, v20
    v_add_f32 v21, 1.0, v21
    v_mfma_f32_32x32x16_bf16 v[80:95], a[160:163], v[152:155], v[80:95]
    s_add_u32 s58, s43, 4718592
    ds_read_b64_tr_b16 a[152:153], v6 offset:13312
    ds_read_b64_tr_b16 a[154:155], v6 offset:13824
    buffer_load_dwordx4 v10, s[12:15], s58 offen lds
    v_add_f32 v22, 1.0, v22
    v_add_f32 v23, 1.0, v23
    v_mfma_f32_32x32x16_bf16 v[96:111], a[164:167], v[152:155], v[96:111]
    s_waitcnt lgkmcnt(6)
    ds_read_b64_tr_b16 a[156:157], v6 offset:13376
    ds_read_b64_tr_b16 a[158:159], v6 offset:13888
    s_waitcnt vmcnt(9)
    v_cmp_ne_u32 vcc, s2, v36
    s_nop 0
    s_cmp_lg_u64 vcc, 0
    s_cbranch_scc1 M_SPX0
M_SRX0:
    v_rcp_f32 v20, v20
    v_mfma_f32_32x32x16_bf16 v[80:95], a[168:171], v[156:159], v[80:95]
    ds_read_b64_tr_b16 a[160:161], v6 offset:14336
    ds_read_b64_tr_b16 a[162:163], v6 offset:14848
    s_add_u32 s71, s68, 0
    buffer_load_dwordx4 a[72:75], v2, s[20:23], s71 offen offset:0 sc1
    v_rcp_f32 v21, v21
    v_mfma_f32_32x32x16_bf16 v[96:111], a[172:175], v[156:159], v[96:111]
    s_waitcnt lgkmcnt(6)
    ds_read_b64_tr_b16 a[164:165], v6 offset:14400
    ds_read_b64_tr_b16 a[166:167], v6 offset:14912
    v_rcp_f32 v22, v22
    v_rcp_f32 v23, v23
    v_mul_f32 v20, v20, v56
    v_mul_f32 v21, v21, v57
    v_mfma_f32_32x32x16_bf16 v[80:95], a[144:147], v[160:163], v[80:95]
    ds_read_b64_tr_b16 a[168:169], v6 offset:15360
    ds_read_b64_tr_b16 a[170:171], v6 offset:15872
    buffer_load_dwordx4 a[76:79], v2, s[20:23], s71 offen offset:1024 sc1
    v_mul_f32 v22, v22, v58
    v_mul_f32 v23, v23, v59
    v_cvt_pk_bf16_f32 v32, v20, v21
    v_mfma_f32_32x32x16_bf16 v[96:111], a[148:151], v[160:163], v[96:111]
    s_waitcnt lgkmcnt(6)
    ds_read_b64_tr_b16 a[172:173], v6 offset:15424
    ds_read_b64_tr_b16 a[174:175], v6 offset:15936
    v_cvt_pk_bf16_f32 v33, v22, v23
    v_accvgpr_write_b32 a36, v32
    v_accvgpr_write_b32 a37, v33
    v_fma_f32 v24, v60, v60, s60
    v_fma_f32 v25, v61, v61, s60
    v_fma_f32 v26, v62, v62, s60
    v_mfma_f32_32x32x16_bf16 v[80:95], a[152:155], v[164:167], v[80:95]
    ds_read_b64_tr_b16 a[144:145], v6 offset:16384
    ds_read_b64_tr_b16 a[146:147], v6 offset:16896
    buffer_load_dwordx4 a[80:83], v2, s[20:23], s71 offen offset:2048 sc1
    v_fma_f32 v27, v63, v63, s60
    v_mul_f32 v24, v24, v60
    v_mul_f32 v25, v25, v61
    v_mfma_f32_32x32x16_bf16 v[96:111], a[156:159], v[164:167], v[96:111]
    s_waitcnt lgkmcnt(6)
    ds_read_b64_tr_b16 a[148:149], v6 offset:16448
    ds_read_b64_tr_b16 a[150:151], v6 offset:16960
    v_mul_f32 v26, v26, v62
    v_mul_f32 v27, v27, v63
    v_exp_f32 v24, v24
    v_exp_f32 v25, v25
    v_mfma_f32_32x32x16_bf16 v[80:95], a[160:163], v[168:171], v[80:95]
    ds_read_b64_tr_b16 a[152:153], v6 offset:17408
    ds_read_b64_tr_b16 a[154:155], v6 offset:17920
    buffer_load_dwordx4 a[84:87], v2, s[20:23], s71 offen offset:3072 sc1
    v_exp_f32 v26, v26
    v_mfma_f32_32x32x16_bf16 v[96:111], a[164:167], v[168:171], v[96:111]
    s_waitcnt lgkmcnt(6)
    ds_read_b64_tr_b16 a[156:157], v6 offset:17472
    ds_read_b64_tr_b16 a[158:159], v6 offset:17984
    v_exp_f32 v27, v27
    v_add_f32 v24, 1.0, v24
    v_add_f32 v25, 1.0, v25
    v_add_f32 v26, 1.0, v26
    v_add_f32 v27, 1.0, v27
    v_mfma_f32_32x32x16_bf16 v[80:95], a[168:171], v[172:175], v[80:95]
    s_waitcnt vmcnt(16)
    s_barrier
    ds_read_b64_tr_b16 a[160:161], v7 offset:0
    ds_read_b64_tr_b16 a[162:163], v7 offset:512
    v_mfma_f32_32x32x16_bf16 v[96:111], a[172:175], v[172:175], v[96:111]
    s_waitcnt lgkmcnt(6)
    ds_read_b64_tr_b16 a[164:165], v7 offset:64
    ds_read_b64_tr_b16 a[166:167], v7 offset:576
    v_rcp_f32 v24, v24
    v_rcp_f32 v25, v25
    v_rcp_f32 v26, v26
    v_mfma_f32_32x32x16_bf16 v[80:95], a[144:147], v[176:179], v[80:95]
    s_add_u32 m0, s44, 36992
    ds_read_b64_tr_b16 a[168:169], v7 offset:1024
    ds_read_b64_tr_b16 a[170:171], v7 offset:1536
    s_add_u32 s58, s49, 0
    buffer_load_dwordx4 v42, s[16:19], s58 offen lds
    v_rcp_f32 v27, v27
    v_mfma_f32_32x32x16_bf16 v[96:111], a[148:151], v[176:179], v[96:111]
    s_waitcnt lgkmcnt(6)
    ds_read_b64_tr_b16 a[172:173], v7 offset:1088
    ds_read_b64_tr_b16 a[174:175], v7 offset:1600
    v_mul_f32 v24, v24, v60
    v_mul_f32 v25, v25, v61
    v_mul_f32 v26, v26, v62
    v_mul_f32 v27, v27, v63
    v_cvt_pk_bf16_f32 v34, v24, v25
    v_cvt_pk_bf16_f32 v35, v26, v27
    v_mfma_f32_32x32x16_bf16 v[80:95], a[152:155], v[180:183], v[80:95]
    s_add_u32 m0, s44, 39040
    ds_read_b64_tr_b16 a[144:145], v7 offset:2048
    ds_read_b64_tr_b16 a[146:147], v7 offset:2560
    ds_read_b128 v[56:59], v15 offset:1088
    ds_read_b128 v[60:63], v15 offset:1120
    v_accvgpr_write_b32 a38, v34
    v_accvgpr_write_b32 a39, v35
    v_fma_f32 v20, v64, v64, s60
    v_fma_f32 v21, v65, v65, s60
    v_mfma_f32_32x32x16_bf16 v[96:111], a[156:159], v[180:183], v[96:111]
    s_waitcnt lgkmcnt(8)
    ds_read_b64_tr_b16 a[148:149], v7 offset:2112
    ds_read_b64_tr_b16 a[150:151], v7 offset:2624
    s_add_u32 s58, s49, 36864
    buffer_load_dwordx4 v42, s[16:19], s58 offen lds
    v_fma_f32 v22, v66, v66, s60
    v_fma_f32 v23, v67, v67, s60
    v_mfma_f32_32x32x16_bf16 v[80:95], a[160:163], v[184:187], v[80:95]
    s_add_u32 m0, s44, 41088
    ds_read_b64_tr_b16 a[152:153], v7 offset:3072
    ds_read_b64_tr_b16 a[154:155], v7 offset:3584
    buffer_store_dwordx4 v[32:35], v2, s[20:23], s63 offen offset:1024 sc1
    v_mul_f32 v20, v20, v64
    v_mul_f32 v21, v21, v65
    v_mfma_f32_32x32x16_bf16 v[96:111], a[164:167], v[184:187], v[96:111]
    s_waitcnt lgkmcnt(8)
    ds_read_b64_tr_b16 a[156:157], v7 offset:3136
    ds_read_b64_tr_b16 a[158:159], v7 offset:3648
    v_mul_f32 v22, v22, v66
    v_mul_f32 v23, v23, v67
    v_exp_f32 v20, v20
    v_exp_f32 v21, v21
    v_mfma_f32_32x32x16_bf16 v[80:95], a[168:171], v[188:191], v[80:95]
    s_add_u32 s58, s49, 73728
    ds_read_b64_tr_b16 a[160:161], v7 offset:4096
    ds_read_b64_tr_b16 a[162:163], v7 offset:4608
    buffer_load_dwordx4 v42, s[16:19], s58 offen lds
    v_exp_f32 v22, v22
    v_mfma_f32_32x32x16_bf16 v[96:111], a[172:175], v[188:191], v[96:111]
    s_waitcnt lgkmcnt(6)
    ds_read_b64_tr_b16 a[164:165], v7 offset:4160
    ds_read_b64_tr_b16 a[166:167], v7 offset:4672
    s_waitcnt vmcnt(19)
    s_mov_b64 exec, 1
    buffer_store_dword v37, v19, s[20:23], s56 offen offset:4 sc1
    s_mov_b64 exec, -1
    v_exp_f32 v23, v23
    v_mfma_f32_32x32x16_bf16 v[80:95], a[144:147], v[192:195], v[80:95]
    s_add_u32 m0, s44, 43136
    ds_read_b64_tr_b16 a[168:169], v7 offset:5120
    ds_read_b64_tr_b16 a[170:171], v7 offset:5632
    v_add_f32 v20, 1.0, v20
    v_add_f32 v21, 1.0, v21
    v_add_f32 v22, 1.0, v22
    v_add_f32 v23, 1.0, v23
    v_rcp_f32 v20, v20
    v_mfma_f32_32x32x16_bf16 v[96:111], a[148:151], v[192:195], v[96:111]
    s_waitcnt lgkmcnt(6)
    ds_read_b64_tr_b16 a[172:173], v7 offset:5184
    ds_read_b64_tr_b16 a[174:175], v7 offset:5696
    s_add_u32 s58, s49, 110592
    buffer_load_dwordx4 v42, s[16:19], s58 offen lds
    v_rcp_f32 v21, v21
    v_mfma_f32_32x32x16_bf16 v[80:95], a[152:155], v[196:199], v[80:95]
    s_add_u32 m0, s44, 45184
    ds_read_b64_tr_b16 a[144:145], v7 offset:6144
    ds_read_b64_tr_b16 a[146:147], v7 offset:6656
    v_rcp_f32 v22, v22
    v_rcp_f32 v23, v23
    v_mul_f32 v20, v20, v64
    v_mul_f32 v21, v21, v65
    v_mfma_f32_32x32x16_bf16 v[96:111], a[156:159], v[196:199], v[96:111]
    s_waitcnt lgkmcnt(6)
    ds_read_b64_tr_b16 a[148:149], v7 offset:6208
    ds_read_b64_tr_b16 a[150:151], v7 offset:6720
    v_mul_f32 v22, v22, v66
    v_mul_f32 v23, v23, v67
    v_cvt_pk_bf16_f32 v28, v20, v21
    v_cvt_pk_bf16_f32 v29, v22, v23
    v_accvgpr_write_b32 a40, v28
    v_accvgpr_write_b32 a41, v29
    v_mfma_f32_32x32x16_bf16 v[80:95], a[160:163], v[200:203], v[80:95]
    s_add_u32 s58, s49, 147456
    ds_read_b64_tr_b16 a[152:153], v7 offset:7168
    ds_read_b64_tr_b16 a[154:155], v7 offset:7680
    buffer_load_dwordx4 v42, s[16:19], s58 offen lds
    v_fma_f32 v24, v68, v68, s60
    v_fma_f32 v25, v69, v69, s60
    v_fma_f32 v26, v70, v70, s60
    v_mfma_f32_32x32x16_bf16 v[96:111], a[164:167], v[200:203], v[96:111]
    s_waitcnt lgkmcnt(6)
    ds_read_b64_tr_b16 a[156:157], v7 offset:7232
    ds_read_b64_tr_b16 a[158:159], v7 offset:7744
    v_fma_f32 v27, v71, v71, s60
    v_mul_f32 v24, v24, v68
    v_mul_f32 v25, v25, v69
    v_mul_f32 v26, v26, v70
    v_mul_f32 v27, v27, v71
    v_mfma_f32_32x32x16_bf16 v[80:95], a[168:171], v[204:207], v[80:95]
    s_add_u32 m0, s44, 47232
    ds_read_b64_tr_b16 a[160:161], v7 offset:8192
    ds_read_b64_tr_b16 a[162:163], v7 offset:8704
    v_exp_f32 v24, v24
    v_exp_f32 v25, v25
    v_exp_f32 v26, v26
    v_mfma_f32_32x32x16_bf16 v[96:111], a[172:175], v[204:207], v[96:111]
    s_waitcnt lgkmcnt(6)
    ds_read_b64_tr_b16 a[164:165], v7 offset:8256
    ds_read_b64_tr_b16 a[166:167], v7 offset:8768
    s_add_u32 s58, s49, 184320
    buffer_load_dwordx4 v42, s[16:19], s58 offen lds
    v_exp_f32 v27, v27
    v_mfma_f32_32x32x16_bf16 v[80:95], a[144:147], v[208:211], v[80:95]
    s_add_u32 m0, s44, 49280
    ds_read_b64_tr_b16 a[168:169], v7 offset:9216
    ds_read_b64_tr_b16 a[170:171], v7 offset:9728
    v_add_f32 v24, 1.0, v24
    v_add_f32 v25, 1.0, v25
    v_add_f32 v26, 1.0, v26
    v_add_f32 v27, 1.0, v27
    v_rcp_f32 v24, v24
    v_mfma_f32_32x32x16_bf16 v[96:111], a[148:151], v[208:211], v[96:111]
    s_waitcnt lgkmcnt(6)
    ds_read_b64_tr_b16 a[172:173], v7 offset:9280
    ds_read_b64_tr_b16 a[174:175], v7 offset:9792
    v_rcp_f32 v25, v25
    v_rcp_f32 v26, v26
    v_rcp_f32 v27, v27
    v_mfma_f32_32x32x16_bf16 v[80:95], a[152:155], v[212:215], v[80:95]
    s_add_u32 s58, s49, 0
    ds_read_b64_tr_b16 a[144:145], v7 offset:10240
    ds_read_b64_tr_b16 a[146:147], v7 offset:10752
    buffer_load_dwordx4 v43, s[16:19], s58 offen lds
    v_mul_f32 v24, v24, v68
    v_mul_f32 v25, v25, v69
    v_mul_f32 v26, v26, v70
    v_mfma_f32_32x32x16_bf16 v[96:111], a[156:159], v[212:215], v[96:111]
    s_waitcnt lgkmcnt(6)
    ds_read_b64_tr_b16 a[148:149], v7 offset:10304
    ds_read_b64_tr_b16 a[150:151], v7 offset:10816
    v_mul_f32 v27, v27, v71
    v_cvt_pk_bf16_f32 v30, v24, v25
    v_cvt_pk_bf16_f32 v31, v26, v27
    v_accvgpr_write_b32 a42, v30
    v_accvgpr_write_b32 a43, v31
    v_fma_f32 v20, v72, v72, s60
    v_mfma_f32_32x32x16_bf16 v[80:95], a[160:163], v[216:219], v[80:95]
    s_add_u32 m0, s44, 51328
    ds_read_b64_tr_b16 a[152:153], v7 offset:11264
    ds_read_b64_tr_b16 a[154:155], v7 offset:11776
    buffer_store_dwordx4 v[28:31], v2, s[20:23], s63 offen offset:2048 sc1
    v_fma_f32 v21, v73, v73, s60
    v_fma_f32 v22, v74, v74, s60
    v_mfma_f32_32x32x16_bf16 v[96:111], a[164:167], v[216:219], v[96:111]
    s_waitcnt lgkmcnt(6)
    ds_read_b64_tr_b16 a[156:157], v7 offset:11328
    ds_read_b64_tr_b16 a[158:159], v7 offset:11840
    s_add_u32 s58, s49, 36864
    buffer_load_dwordx4 v43, s[16:19], s58 offen lds
    v_fma_f32 v23, v75, v75, s60
    v_mul_f32 v20, v20, v72
    v_mfma_f32_32x32x16_bf16 v[80:95], a[168:171], v[220:223], v[80:95]
    s_add_u32 m0, s44, 53376
    ds_read_b64_tr_b16 a[160:161], v7 offset:12288
    ds_read_b64_tr_b16 a[162:163], v7 offset:12800
    v_mul_f32 v21, v21, v73
    v_mul_f32 v22, v22, v74
    v_mul_f32 v23, v23, v75
    v_exp_f32 v20, v20
    v_mfma_f32_32x32x16_bf16 v[96:111], a[172:175], v[220:223], v[96:111]
    s_waitcnt lgkmcnt(6)
    ds_read_b64_tr_b16 a[164:165], v7 offset:12352
    ds_read_b64_tr_b16 a[166:167], v7 offset:12864
    v_exp_f32 v21, v21
    v_exp_f32 v22, v22
    v_exp_f32 v23, v23
    v_mfma_f32_32x32x16_bf16 v[80:95], a[144:147], v[224:227], v[80:95]
    s_add_u32 s58, s49, 73728
    ds_read_b64_tr_b16 a[168:169], v7 offset:13312
    ds_read_b64_tr_b16 a[170:171], v7 offset:13824
    buffer_load_dwordx4 v43, s[16:19], s58 offen lds
    v_add_f32 v20, 1.0, v20
    v_add_f32 v21, 1.0, v21
    v_add_f32 v22, 1.0, v22
    v_mfma_f32_32x32x16_bf16 v[96:111], a[148:151], v[224:227], v[96:111]
    s_waitcnt lgkmcnt(6)
    ds_read_b64_tr_b16 a[172:173], v7 offset:13376
    ds_read_b64_tr_b16 a[174:175], v7 offset:13888
    v_add_f32 v23, 1.0, v23
    v_rcp_f32 v20, v20
    v_rcp_f32 v21, v21
    v_mfma_f32_32x32x16_bf16 v[80:95], a[152:155], v[228:231], v[80:95]
    ds_read_b64_tr_b16 a[144:145], v7 offset:14336
    ds_read_b64_tr_b16 a[146:147], v7 offset:14848
    v_rcp_f32 v22, v22
    v_rcp_f32 v23, v23
    v_mul_f32 v20, v20, v72
    v_mul_f32 v21, v21, v73
    v_mfma_f32_32x32x16_bf16 v[96:111], a[156:159], v[228:231], v[96:111]
    s_waitcnt lgkmcnt(6)
    ds_read_b64_tr_b16 a[148:149], v7 offset:14400
    ds_read_b64_tr_b16 a[150:151], v7 offset:14912
    v_mul_f32 v22, v22, v74
    v_mul_f32 v23, v23, v75
    v_cvt_pk_bf16_f32 v32, v20, v21
    v_cvt_pk_bf16_f32 v33, v22, v23
    v_accvgpr_write_b32 a44, v32
    v_accvgpr_write_b32 a45, v33
    v_mfma_f32_32x32x16_bf16 v[80:95], a[160:163], v[232:235], v[80:95]
    ds_read_b64_tr_b16 a[152:153], v7 offset:15360
    ds_read_b64_tr_b16 a[154:155], v7 offset:15872
    v_fma_f32 v24, v76, v76, s60
    v_fma_f32 v25, v77, v77, s60
    v_fma_f32 v26, v78, v78, s60
    v_fma_f32 v27, v79, v79, s60
    v_mul_f32 v24, v24, v76
    v_mul_f32 v25, v25, v77
    v_mfma_f32_32x32x16_bf16 v[96:111], a[164:167], v[232:235], v[96:111]
    s_waitcnt lgkmcnt(6)
    ds_read_b64_tr_b16 a[156:157], v7 offset:15424
    ds_read_b64_tr_b16 a[158:159], v7 offset:15936
    v_mul_f32 v26, v26, v78
    v_mul_f32 v27, v27, v79
    v_exp_f32 v24, v24
    v_exp_f32 v25, v25
    v_mfma_f32_32x32x16_bf16 v[80:95], a[168:171], v[236:239], v[80:95]
    ds_read_b64_tr_b16 a[160:161], v7 offset:16384
    ds_read_b64_tr_b16 a[162:163], v7 offset:16896
    v_exp_f32 v26, v26
    v_exp_f32 v27, v27
    v_add_f32 v24, 1.0, v24
    v_add_f32 v25, 1.0, v25
    v_mfma_f32_32x32x16_bf16 v[96:111], a[172:175], v[236:239], v[96:111]
    s_waitcnt lgkmcnt(6)
    ds_read_b64_tr_b16 a[164:165], v7 offset:16448
    ds_read_b64_tr_b16 a[166:167], v7 offset:16960
    v_add_f32 v26, 1.0, v26
    v_add_f32 v27, 1.0, v27
    v_rcp_f32 v24, v24
    v_rcp_f32 v25, v25
    v_mfma_f32_32x32x16_bf16 v[80:95], a[144:147], v[240:243], v[80:95]
    ds_read_b64_tr_b16 a[168:169], v7 offset:17408
    ds_read_b64_tr_b16 a[170:171], v7 offset:17920
    v_rcp_f32 v26, v26
    v_rcp_f32 v27, v27
    v_mul_f32 v24, v24, v76
    v_mul_f32 v25, v25, v77
    v_mfma_f32_32x32x16_bf16 v[96:111], a[148:151], v[240:243], v[96:111]
    s_waitcnt lgkmcnt(6)
    ds_read_b64_tr_b16 a[172:173], v7 offset:17472
    ds_read_b64_tr_b16 a[174:175], v7 offset:17984
    v_mul_f32 v26, v26, v78
    v_mul_f32 v27, v27, v79
    v_cvt_pk_bf16_f32 v34, v24, v25
    v_cvt_pk_bf16_f32 v35, v26, v27
    v_accvgpr_write_b32 a46, v34
    v_accvgpr_write_b32 a47, v35
    v_mfma_f32_32x32x16_bf16 v[80:95], a[152:155], v[244:247], v[80:95]
    s_waitcnt vmcnt(16)
    s_barrier
    ds_read_b64_tr_b16 a[144:145], v8 offset:0
    ds_read_b64_tr_b16 a[146:147], v8 offset:512
    buffer_store_dwordx4 v[32:35], v2, s[20:23], s63 offen offset:3072 sc1
    v_mfma_f32_32x32x16_bf16 v[96:111], a[156:159], v[244:247], v[96:111]
    s_waitcnt lgkmcnt(6)
    ds_read_b64_tr_b16 a[148:149], v8 offset:1024
    ds_read_b64_tr_b16 a[150:151], v8 offset:1536
    v_mfma_f32_32x32x16_bf16 v[80:95], a[160:163], v[248:251], v[80:95]
    s_add_u32 m0, s44, 73984
    ds_read_b64_tr_b16 a[152:153], v8 offset:2048
    ds_read_b64_tr_b16 a[154:155], v8 offset:2560
    s_add_u32 s58, s49, 110592
    buffer_load_dwordx4 v43, s[16:19], s58 offen lds
    v_mfma_f32_32x32x16_bf16 v[96:111], a[164:167], v[248:251], v[96:111]
    s_waitcnt lgkmcnt(6)
    ds_read_b64_tr_b16 a[156:157], v8 offset:3072
    ds_read_b64_tr_b16 a[158:159], v8 offset:3584
    s_xor_b32 s70, s56, 8192
    buffer_load_dword v36, v19, s[20:23], s70 offen offset:4 sc1
    v_mfma_f32_32x32x16_bf16 v[80:95], a[168:171], v[252:255], v[80:95]
    s_add_u32 m0, s44, 76032
    ds_read_b64_tr_b16 a[160:161], v8 offset:4096
    ds_read_b64_tr_b16 a[162:163], v8 offset:4608
    v_mfma_f32_32x32x16_bf16 v[96:111], a[172:175], v[252:255], v[96:111]
    s_waitcnt lgkmcnt(6)
    ds_read_b64_tr_b16 a[164:165], v8 offset:5120
    ds_read_b64_tr_b16 a[166:167], v8 offset:5632
    s_add_u32 s58, s49, 147456
    buffer_load_dwordx4 v43, s[16:19], s58 offen lds
    v_mfma_f32_32x32x16_bf16 v[48:63], a[144:147], v[112:115], v[48:63]
    s_add_u32 m0, s44, 78080
    ds_read_b64_tr_b16 a[168:169], v8 offset:6144
    ds_read_b64_tr_b16 a[170:171], v8 offset:6656
    v_fma_f32 v20, v80, v80, s60
    v_fma_f32 v21, v81, v81, s60
    v_fma_f32 v22, v82, v82, s60
    v_fma_f32 v23, v83, v83, s60
    v_mul_f32 v20, v20, v80
    v_mul_f32 v21, v21, v81
    v_mul_f32 v22, v22, v82
    v_mfma_f32_32x32x16_bf16 v[48:63], a[148:151], v[116:119], v[48:63]
    s_waitcnt lgkmcnt(6)
    ds_read_b64_tr_b16 a[172:173], v8 offset:7168
    ds_read_b64_tr_b16 a[174:175], v8 offset:7680
    v_mul_f32 v23, v23, v83
    v_exp_f32 v20, v20
    v_exp_f32 v21, v21
    v_exp_f32 v22, v22
    v_mfma_f32_32x32x16_bf16 v[48:63], a[152:155], v[120:123], v[48:63]
    s_add_u32 s58, s49, 184320
    ds_read_b64_tr_b16 a[144:145], v8 offset:8192
    ds_read_b64_tr_b16 a[146:147], v8 offset:8704
    buffer_load_dwordx4 v43, s[16:19], s58 offen lds
    v_exp_f32 v23, v23
    v_add_f32 v20, 1.0, v20
    v_add_f32 v21, 1.0, v21
    v_mfma_f32_32x32x16_bf16 v[48:63], a[156:159], v[124:127], v[48:63]
    s_waitcnt lgkmcnt(6)
    ds_read_b64_tr_b16 a[148:149], v8 offset:9216
    ds_read_b64_tr_b16 a[150:151], v8 offset:9728
    v_add_f32 v22, 1.0, v22
    v_add_f32 v23, 1.0, v23
    v_rcp_f32 v20, v20
    v_rcp_f32 v21, v21
    v_mfma_f32_32x32x16_bf16 v[48:63], a[160:163], v[128:131], v[48:63]
    s_add_u32 m0, s44, 80128
    ds_read_b64_tr_b16 a[152:153], v8 offset:10240
    ds_read_b64_tr_b16 a[154:155], v8 offset:10752
    v_rcp_f32 v22, v22
    v_rcp_f32 v23, v23
    v_mul_f32 v20, v20, v80
    v_mul_f32 v21, v21, v81
    v_mul_f32 v22, v22, v82
    v_mfma_f32_32x32x16_bf16 v[48:63], a[164:167], v[132:135], v[48:63]
    s_waitcnt lgkmcnt(6)
    ds_read_b64_tr_b16 a[156:157], v8 offset:11264
    ds_read_b64_tr_b16 a[158:159], v8 offset:11776
    s_add_u32 s58, s49, 0
    buffer_load_dwordx4 v46, s[16:19], s58 offen lds
    v_mul_f32 v23, v23, v83
    v_cvt_pk_bf16_f32 v28, v20, v21
    v_cvt_pk_bf16_f32 v29, v22, v23
    v_mfma_f32_32x32x16_bf16 v[48:63], a[168:171], v[136:139], v[48:63]
    s_add_u32 m0, s44, 82176
    ds_read_b64_tr_b16 a[160:161], v8 offset:12288
    ds_read_b64_tr_b16 a[162:163], v8 offset:12800
    v_accvgpr_write_b32 a48, v28
    v_accvgpr_write_b32 a49, v29
    v_fma_f32 v24, v84, v84, s60
    v_fma_f32 v25, v85, v85, s60
    v_fma_f32 v26, v86, v86, s60
    v_fma_f32 v27, v87, v87, s60
    v_mul_f32 v24, v24, v84
    v_mfma_f32_32x32x16_bf16 v[48:63], a[172:175], v[140:143], v[48:63]
    s_waitcnt lgkmcnt(6)
    ds_read_b64_tr_b16 a[164:165], v8 offset:13312
    ds_read_b64_tr_b16 a[166:167], v8 offset:13824
    v_mul_f32 v25, v25, v85
    v_mul_f32 v26, v26, v86
    v_mul_f32 v27, v27, v87
    v_exp_f32 v24, v24
    v_exp_f32 v25, v25
    v_mfma_f32_32x32x16_bf16 v[48:63], a[144:147], v[144:147], v[48:63]
    s_add_u32 s58, s49, 36864
    ds_read_b64_tr_b16 a[168:169], v8 offset:14336
    ds_read_b64_tr_b16 a[170:171], v8 offset:14848
    buffer_load_dwordx4 v46, s[16:19], s58 offen lds
    v_exp_f32 v26, v26
    v_exp_f32 v27, v27
    v_mfma_f32_32x32x16_bf16 v[48:63], a[148:151], v[148:151], v[48:63]
    s_waitcnt lgkmcnt(6)
    ds_read_b64_tr_b16 a[172:173], v8 offset:15360
    ds_read_b64_tr_b16 a[174:175], v8 offset:15872
    v_add_f32 v24, 1.0, v24
    v_add_f32 v25, 1.0, v25
    v_add_f32 v26, 1.0, v26
    v_add_f32 v27, 1.0, v27
    v_rcp_f32 v24, v24
    v_mfma_f32_32x32x16_bf16 v[48:63], a[152:155], v[152:155], v[48:63]
    s_add_u32 m0, s44, 84224
    ds_read_b64_tr_b16 a[144:145], v8 offset:16384
    ds_read_b64_tr_b16 a[146:147], v8 offset:16896
    v_rcp_f32 v25, v25
    v_rcp_f32 v26, v26
    v_rcp_f32 v27, v27
    v_mul_f32 v24, v24, v84
    v_mfma_f32_32x32x16_bf16 v[48:63], a[156:159], v[156:159], v[48:63]
    s_waitcnt lgkmcnt(6)
    ds_read_b64_tr_b16 a[148:149], v8 offset:17408
    ds_read_b64_tr_b16 a[150:151], v8 offset:17920
    s_add_u32 s58, s49, 73728
    buffer_load_dwordx4 v46, s[16:19], s58 offen lds
    v_mul_f32 v25, v25, v85
    v_mul_f32 v26, v26, v86
    v_mul_f32 v27, v27, v87
    v_mfma_f32_32x32x16_bf16 v[48:63], a[160:163], v[160:163], v[48:63]
    s_add_u32 m0, s44, 86272
    ds_read_b64_tr_b16 a[152:153], v8 offset:18432
    ds_read_b64_tr_b16 a[154:155], v8 offset:18944
    v_cvt_pk_bf16_f32 v30, v24, v25
    v_cvt_pk_bf16_f32 v31, v26, v27
    v_accvgpr_write_b32 a50, v30
    v_accvgpr_write_b32 a51, v31
    v_fma_f32 v20, v88, v88, s60
    v_fma_f32 v21, v89, v89, s60
    v_fma_f32 v22, v90, v90, s60
    v_mfma_f32_32x32x16_bf16 v[48:63], a[164:167], v[164:167], v[48:63]
    s_waitcnt lgkmcnt(6)
    ds_read_b64_tr_b16 a[156:157], v8 offset:19456
    ds_read_b64_tr_b16 a[158:159], v8 offset:19968
    s_add_u32 s63, s55, 12288
    buffer_store_dwordx4 v[28:31], v2, s[20:23], s63 offen offset:0 sc1
    v_fma_f32 v23, v91, v91, s60
    v_mul_f32 v20, v20, v88
    v_mul_f32 v21, v21, v89
    v_mfma_f32_32x32x16_bf16 v[48:63], a[168:171], v[168:171], v[48:63]
    s_add_u32 s58, s49, 110592
    ds_read_b64_tr_b16 a[160:161], v8 offset:20480
    ds_read_b64_tr_b16 a[162:163], v8 offset:20992
    buffer_load_dwordx4 v46, s[16:19], s58 offen lds
    v_mul_f32 v22, v22, v90
    v_mul_f32 v23, v23, v91
    v_exp_f32 v20, v20
    v_mfma_f32_32x32x16_bf16 v[48:63], a[172:175], v[172:175], v[48:63]
    s_waitcnt lgkmcnt(6)
    ds_read_b64_tr_b16 a[164:165], v8 offset:21504
    ds_read_b64_tr_b16 a[166:167], v8 offset:22016
    v_exp_f32 v21, v21
    v_exp_f32 v22, v22
    v_exp_f32 v23, v23
    v_add_f32 v20, 1.0, v20
    v_mfma_f32_32x32x16_bf16 v[48:63], a[144:147], v[176:179], v[48:63]
    s_add_u32 m0, s44, 88320
    ds_read_b64_tr_b16 a[168:169], v8 offset:22528
    ds_read_b64_tr_b16 a[170:171], v8 offset:23040
    v_add_f32 v21, 1.0, v21
    v_add_f32 v22, 1.0, v22
    v_add_f32 v23, 1.0, v23
    v_rcp_f32 v20, v20
    v_rcp_f32 v21, v21
    v_mfma_f32_32x32x16_bf16 v[48:63], a[148:151], v[180:183], v[48:63]
    s_waitcnt lgkmcnt(6)
    ds_read_b64_tr_b16 a[172:173], v8 offset:23552
    ds_read_b64_tr_b16 a[174:175], v8 offset:24064
    s_add_u32 s58, s49, 147456
    buffer_load_dwordx4 v46, s[16:19], s58 offen lds
    v_rcp_f32 v22, v22
    v_mfma_f32_32x32x16_bf16 v[48:63], a[152:155], v[184:187], v[48:63]
    s_add_u32 m0, s44, 90368
    ds_read_b64_tr_b16 a[144:145], v8 offset:24576
    ds_read_b64_tr_b16 a[146:147], v8 offset:25088
    v_rcp_f32 v23, v23
    v_mul_f32 v20, v20, v88
    v_mul_f32 v21, v21, v89
    v_mul_f32 v22, v22, v90
    v_mul_f32 v23, v23, v91
    v_cvt_pk_bf16_f32 v32, v20, v21
    v_mfma_f32_32x32x16_bf16 v[48:63], a[156:159], v[188:191], v[48:63]
    s_waitcnt lgkmcnt(6)
    ds_read_b64_tr_b16 a[148:149], v8 offset:25600
    ds_read_b64_tr_b16 a[150:151], v8 offset:26112
    v_cvt_pk_bf16_f32 v33, v22, v23
    v_accvgpr_write_b32 a52, v32
    v_accvgpr_write_b32 a53, v33
    v_fma_f32 v24, v92, v92, s60
    v_fma_f32 v25, v93, v93, s60
    v_fma_f32 v26, v94, v94, s60
    v_fma_f32 v27, v95, v95, s60
    v_mfma_f32_32x32x16_bf16 v[48:63], a[160:163], v[192:195], v[48:63]
    s_add_u32 s58, s49, 184320
    ds_read_b64_tr_b16 a[152:153], v8 offset:26624
    ds_read_b64_tr_b16 a[154:155], v8 offset:27136
    buffer_load_dwordx4 v46, s[16:19], s58 offen lds
    v_mul_f32 v24, v24, v92
    v_mul_f32 v25, v25, v93
    v_mul_f32 v26, v26, v94
    v_mul_f32 v27, v27, v95
    v_mfma_f32_32x32x16_bf16 v[48:63], a[164:167], v[196:199], v[48:63]
    s_waitcnt lgkmcnt(6)
    ds_read_b64_tr_b16 a[156:157], v8 offset:27648
    ds_read_b64_tr_b16 a[158:159], v8 offset:28160
    s_waitcnt vmcnt(9)
    v_cmp_ne_u32 vcc, s2, v36
    s_nop 0
    s_cmp_lg_u64 vcc, 0
    s_cbranch_scc1 M_SPX1
M_SRX1:
    v_exp_f32 v24, v24
    v_mfma_f32_32x32x16_bf16 v[48:63], a[168:171], v[200:203], v[48:63]
    ds_read_b64_tr_b16 a[160:161], v8 offset:28672
    ds_read_b64_tr_b16 a[162:163], v8 offset:29184
    s_add_u32 s71, s68, 4096
    buffer_load_dwordx4 a[88:91], v2, s[20:23], s71 offen offset:0 sc1
    v_exp_f32 v25, v25
    v_exp_f32 v26, v26
    v_mfma_f32_32x32x16_bf16 v[48:63], a[172:175], v[204:207], v[48:63]
    s_waitcnt lgkmcnt(6)
    ds_read_b64_tr_b16 a[164:165], v8 offset:29696
    ds_read_b64_tr_b16 a[166:167], v8 offset:30208
    v_exp_f32 v27, v27
    v_add_f32 v24, 1.0, v24
    v_add_f32 v25, 1.0, v25
    v_add_f32 v26, 1.0, v26
    v_add_f32 v27, 1.0, v27
    v_mfma_f32_32x32x16_bf16 v[48:63], a[144:147], v[208:211], v[48:63]
    ds_read_b64_tr_b16 a[168:169], v8 offset:30720
    ds_read_b64_tr_b16 a[170:171], v8 offset:31232
    buffer_load_dwordx4 a[92:95], v2, s[20:23], s71 offen offset:1024 sc1
    v_rcp_f32 v24, v24
    v_rcp_f32 v25, v25
    v_mfma_f32_32x32x16_bf16 v[48:63], a[148:151], v[212:215], v[48:63]
    s_waitcnt lgkmcnt(6)
    ds_read_b64_tr_b16 a[172:173], v8 offset:31744
    ds_read_b64_tr_b16 a[174:175], v8 offset:32256
    v_rcp_f32 v26, v26
    v_rcp_f32 v27, v27
    v_mul_f32 v24, v24, v92
    v_mul_f32 v25, v25, v93
    v_mul_f32 v26, v26, v94
    v_mfma_f32_32x32x16_bf16 v[48:63], a[152:155], v[216:219], v[48:63]
    ds_read_b64_tr_b16 a[144:145], v8 offset:32768
    ds_read_b64_tr_b16 a[146:147], v8 offset:33280
    buffer_load_dwordx4 a[96:99], v2, s[20:23], s71 offen offset:2048 sc1
    v_mul_f32 v27, v27, v95
    v_cvt_pk_bf16_f32 v34, v24, v25
    v_cvt_pk_bf16_f32 v35, v26, v27
    v_accvgpr_write_b32 a54, v34
    v_mfma_f32_32x32x16_bf16 v[48:63], a[156:159], v[220:223], v[48:63]
    s_waitcnt lgkmcnt(6)
    ds_read_b64_tr_b16 a[148:149], v8 offset:33792
    ds_read_b64_tr_b16 a[150:151], v8 offset:34304
    v_accvgpr_write_b32 a55, v35
    v_fma_f32 v20, v96, v96, s60
    v_fma_f32 v21, v97, v97, s60
    v_fma_f32 v22, v98, v98, s60
    v_fma_f32 v23, v99, v99, s60
    v_mul_f32 v20, v20, v96
    v_mul_f32 v21, v21, v97
    v_mfma_f32_32x32x16_bf16 v[48:63], a[160:163], v[224:227], v[48:63]
    ds_read_b64_tr_b16 a[152:153], v8 offset:34816
    ds_read_b64_tr_b16 a[154:155], v8 offset:35328
    buffer_store_dwordx4 v[32:35], v2, s[20:23], s63 offen offset:1024 sc1
    v_mul_f32 v22, v22, v98
    v_mul_f32 v23, v23, v99
    v_mfma_f32_32x32x16_bf16 v[48:63], a[164:167], v[228:231], v[48:63]
    s_waitcnt lgkmcnt(6)
    ds_read_b64_tr_b16 a[156:157], v8 offset:35840
    ds_read_b64_tr_b16 a[158:159], v8 offset:36352
    v_exp_f32 v20, v20
    v_exp_f32 v21, v21
    v_exp_f32 v22, v22
    v_mfma_f32_32x32x16_bf16 v[48:63], a[168:171], v[232:235], v[48:63]
    s_waitcnt vmcnt(16)
    s_barrier
    ds_read_b64_tr_b16 a[160:161], v5 offset:0
    ds_read_b64_tr_b16 a[162:163], v5 offset:512
    v_mfma_f32_32x32x16_bf16 v[48:63], a[172:175], v[236:239], v[48:63]
    s_waitcnt lgkmcnt(6)
    ds_read_b64_tr_b16 a[164:165], v5 offset:64
    ds_read_b64_tr_b16 a[166:167], v5 offset:576
    buffer_load_dwordx4 a[100:103], v2, s[20:23], s71 offen offset:3072 sc1
    v_exp_f32 v23, v23
    v_add_f32 v20, 1.0, v20
    v_add_f32 v21, 1.0, v21
    v_mfma_f32_32x32x16_bf16 v[48:63], a[144:147], v[240:243], v[48:63]
    s_add_u32 m0, s44, 110976
    ds_read_b64_tr_b16 a[168:169], v5 offset:1024
    ds_read_b64_tr_b16 a[170:171], v5 offset:1536
    s_add_u32 s58, s49, 221184
    buffer_load_dwordx4 v42, s[16:19], s58 offen lds
    v_add_f32 v22, 1.0, v22
    v_add_f32 v23, 1.0, v23
    v_mfma_f32_32x32x16_bf16 v[48:63], a[148:151], v[244:247], v[48:63]
    s_waitcnt lgkmcnt(6)
    ds_read_b64_tr_b16 a[172:173], v5 offset:1088
    ds_read_b64_tr_b16 a[174:175], v5 offset:1600
    v_rcp_f32 v20, v20
    v_rcp_f32 v21, v21
    v_rcp_f32 v22, v22
    v_mfma_f32_32x32x16_bf16 v[48:63], a[152:155], v[248:251], v[48:63]
    s_add_u32 m0, s44, 113024
    ds_read_b64_tr_b16 a[144:145], v5 offset:2048
    ds_read_b64_tr_b16 a[146:147], v5 offset:2560
    v_rcp_f32 v23, v23
    v_mul_f32 v20, v20, v96
    v_mul_f32 v21, v21, v97
    v_mul_f32 v22, v22, v98
    v_mul_f32 v23, v23, v99
    v_cvt_pk_bf16_f32 v28, v20, v21
    v_mfma_f32_32x32x16_bf16 v[48:63], a[156:159], v[252:255], v[48:63]
    s_waitcnt lgkmcnt(6)
    ds_read_b64_tr_b16 a[148:149], v5 offset:2112
    ds_read_b64_tr_b16 a[150:151], v5 offset:2624
    s_add_u32 s58, s49, 258048
    buffer_load_dwordx4 v42, s[16:19], s58 offen lds
    v_cvt_pk_bf16_f32 v29, v22, v23
    v_accvgpr_write_b32 a56, v28
    v_accvgpr_write_b32 a57, v29
    v_mfma_f32_32x32x16_bf16 v[112:127], a[160:163], a[0:3], 0
    s_add_u32 m0, s44, 115072
    ds_read_b64_tr_b16 a[152:153], v5 offset:3072
    ds_read_b64_tr_b16 a[154:155], v5 offset:3584
    v_fma_f32 v24, v100, v100, s60
    v_fma_f32 v25, v101, v101, s60
    v_fma_f32 v26, v102, v102, s60
    v_fma_f32 v27, v103, v103, s60
    v_mul_f32 v24, v24, v100
    v_mul_f32 v25, v25, v101
    v_mul_f32 v26, v26, v102
    v_mfma_f32_32x32x16_bf16 v[128:143], a[164:167], a[0:3], 0
    s_waitcnt lgkmcnt(6)
    ds_read_b64_tr_b16 a[156:157], v5 offset:3136
    ds_read_b64_tr_b16 a[158:159], v5 offset:3648
    v_mul_f32 v27, v27, v103
    v_exp_f32 v24, v24
    v_exp_f32 v25, v25
    v_exp_f32 v26, v26
    v_mfma_f32_32x32x16_bf16 v[112:127], a[168:171], a[4:7], v[112:127]
    ds_read_b64_tr_b16 a[160:161], v5 offset:4096
    ds_read_b64_tr_b16 a[162:163], v5 offset:4608
    buffer_load_dwordx4 v42, s[16:19], s51 offen lds
    v_exp_f32 v27, v27
    v_add_f32 v24, 1.0, v24
    v_add_f32 v25, 1.0, v25
    v_mfma_f32_32x32x16_bf16 v[128:143], a[172:175], a[4:7], v[128:143]
    s_waitcnt lgkmcnt(6)
    ds_read_b64_tr_b16 a[164:165], v5 offset:4160
    ds_read_b64_tr_b16 a[166:167], v5 offset:4672
    s_waitcnt vmcnt(19)
    s_mov_b64 exec, 1
    buffer_store_dword v37, v19, s[20:23], s56 offen offset:8 sc1
    s_mov_b64 exec, -1
    v_add_f32 v26, 1.0, v26
    v_add_f32 v27, 1.0, v27
    v_mfma_f32_32x32x16_bf16 v[112:127], a[144:147], a[8:11], v[112:127]
    s_add_u32 m0, s44, 117120
    ds_read_b64_tr_b16 a[168:169], v5 offset:5120
    ds_read_b64_tr_b16 a[170:171], v5 offset:5632
    v_rcp_f32 v24, v24
    v_rcp_f32 v25, v25
    v_rcp_f32 v26, v26
    v_mfma_f32_32x32x16_bf16 v[128:143], a[148:151], a[8:11], v[128:143]
    s_waitcnt lgkmcnt(6)
    ds_read_b64_tr_b16 a[172:173], v5 offset:5184
    ds_read_b64_tr_b16 a[174:175], v5 offset:5696
    s_add_u32 s58, s49, 221184
    buffer_load_dwordx4 v43, s[16:19], s58 offen lds
    v_rcp_f32 v27, v27
    v_mul_f32 v24, v24, v100
    v_mfma_f32_32x32x16_bf16 v[112:127], a[152:155], a[12:15], v[112:127]
    s_add_u32 m0, s44, 119168
    ds_read_b64_tr_b16 a[144:145], v5 offset:6144
    ds_read_b64_tr_b16 a[146:147], v5 offset:6656
    v_mul_f32 v25, v25, v101
    v_mul_f32 v26, v26, v102
    v_mul_f32 v27, v27, v103
    v_cvt_pk_bf16_f32 v30, v24, v25
    v_cvt_pk_bf16_f32 v31, v26, v27
    v_accvgpr_write_b32 a58, v30
    v_accvgpr_write_b32 a59, v31
    v_mfma_f32_32x32x16_bf16 v[128:143], a[156:159], a[12:15], v[128:143]
    s_waitcnt lgkmcnt(6)
    ds_read_b64_tr_b16 a[148:149], v5 offset:6208
    ds_read_b64_tr_b16 a[150:151], v5 offset:6720
    buffer_store_dwordx4 v[28:31], v2, s[20:23], s63 offen offset:2048 sc1
    v_fma_f32 v20, v104, v104, s60
    v_fma_f32 v21, v105, v105, s60
    v_fma_f32 v22, v106, v106, s60
    v_mfma_f32_32x32x16_bf16 v[112:127], a[160:163], a[16:19], v[112:127]
    s_add_u32 s58, s49, 258048
    ds_read_b64_tr_b16 a[152:153], v5 offset:7168
    ds_read_b64_tr_b16 a[154:155], v5 offset:7680
    buffer_load_dwordx4 v43, s[16:19], s58 offen lds
    v_fma_f32 v23, v107, v107, s60
    v_mul_f32 v20, v20, v104
    v_mul_f32 v21, v21, v105
    v_mul_f32 v22, v22, v106
    v_mfma_f32_32x32x16_bf16 v[128:143], a[164:167], a[16:19], v[128:143]
    s_waitcnt lgkmcnt(6)
    ds_read_b64_tr_b16 a[156:157], v5 offset:7232
    ds_read_b64_tr_b16 a[158:159], v5 offset:7744
    v_mul_f32 v23, v23, v107
    v_exp_f32 v20, v20
    v_exp_f32 v21, v21
    v_exp_f32 v22, v22
    v_mfma_f32_32x32x16_bf16 v[112:127], a[168:171], a[20:23], v[112:127]
    s_add_u32 m0, s44, 121216
    ds_read_b64_tr_b16 a[160:161], v5 offset:8192
    ds_read_b64_tr_b16 a[162:163], v5 offset:8704
    v_exp_f32 v23, v23
    v_add_f32 v20, 1.0, v20
    v_add_f32 v21, 1.0, v21
    v_add_f32 v22, 1.0, v22
    v_add_f32 v23, 1.0, v23
    v_mfma_f32_32x32x16_bf16 v[128:143], a[172:175], a[20:23], v[128:143]
    s_waitcnt lgkmcnt(6)
    ds_read_b64_tr_b16 a[164:165], v5 offset:8256
    ds_read_b64_tr_b16 a[166:167], v5 offset:8768
    buffer_load_dwordx4 v43, s[16:19], s51 offen lds
    v_rcp_f32 v20, v20
    v_rcp_f32 v21, v21
    v_mfma_f32_32x32x16_bf16 v[112:127], a[144:147], a[24:27], v[112:127]
    s_add_u32 m0, s44, 123264
    ds_read_b64_tr_b16 a[168:169], v5 offset:9216
    ds_read_b64_tr_b16 a[170:171], v5 offset:9728
    v_rcp_f32 v22, v22
    v_rcp_f32 v23, v23
    v_mul_f32 v20, v20, v104
    v_mul_f32 v21, v21, v105
    v_mul_f32 v22, v22, v106
    v_mfma_f32_32x32x16_bf16 v[128:143], a[148:151], a[24:27], v[128:143]
    s_waitcnt lgkmcnt(6)
    ds_read_b64_tr_b16 a[172:173], v5 offset:9280
    ds_read_b64_tr_b16 a[174:175], v5 offset:9792
    v_mul_f32 v23, v23, v107
    v_cvt_pk_bf16_f32 v32, v20, v21
    v_cvt_pk_bf16_f32 v33, v22, v23
    v_accvgpr_write_b32 a60, v32
    v_accvgpr_write_b32 a61, v33
    v_fma_f32 v24, v108, v108, s60
    v_fma_f32 v25, v109, v109, s60
    v_mfma_f32_32x32x16_bf16 v[112:127], a[152:155], a[28:31], v[112:127]
    s_add_u32 s58, s49, 221184
    ds_read_b64_tr_b16 a[144:145], v5 offset:10240
    ds_read_b64_tr_b16 a[146:147], v5 offset:10752
    buffer_load_dwordx4 v46, s[16:19], s58 offen lds
    v_fma_f32 v26, v110, v110, s60
    v_fma_f32 v27, v111, v111, s60
    v_mul_f32 v24, v24, v108
    v_mul_f32 v25, v25, v109
    v_mfma_f32_32x32x16_bf16 v[128:143], a[156:159], a[28:31], v[128:143]
    s_waitcnt lgkmcnt(6)
    ds_read_b64_tr_b16 a[148:149], v5 offset:10304
    ds_read_b64_tr_b16 a[150:151], v5 offset:10816
    v_mul_f32 v26, v26, v110
    v_mul_f32 v27, v27, v111
    v_exp_f32 v24, v24
    v_exp_f32 v25, v25
    v_mfma_f32_32x32x16_bf16 v[112:127], a[160:163], a[32:35], v[112:127]
    s_add_u32 m0, s44, 125312
    ds_read_b64_tr_b16 a[152:153], v5 offset:11264
    ds_read_b64_tr_b16 a[154:155], v5 offset:11776
    v_exp_f32 v26, v26
    v_exp_f32 v27, v27
    v_add_f32 v24, 1.0, v24
    v_add_f32 v25, 1.0, v25
    v_add_f32 v26, 1.0, v26
    v_mfma_f32_32x32x16_bf16 v[128:143], a[164:167], a[32:35], v[128:143]
    s_waitcnt lgkmcnt(6)
    ds_read_b64_tr_b16 a[156:157], v5 offset:11328
    ds_read_b64_tr_b16 a[158:159], v5 offset:11840
    s_add_u32 s58, s49, 258048
    buffer_load_dwordx4 v46, s[16:19], s58 offen lds
    v_add_f32 v27, 1.0, v27
    v_rcp_f32 v24, v24
    v_mfma_f32_32x32x16_bf16 v[112:127], a[168:171], a[36:39], v[112:127]
    s_add_u32 m0, s44, 127360
    ds_read_b64_tr_b16 a[160:161], v5 offset:12288
    ds_read_b64_tr_b16 a[162:163], v5 offset:12800
    v_rcp_f32 v25, v25
    v_rcp_f32 v26, v26
    v_rcp_f32 v27, v27
    v_mul_f32 v24, v24, v108
    v_mfma_f32_32x32x16_bf16 v[128:143], a[172:175], a[36:39], v[128:143]
    s_waitcnt lgkmcnt(6)
    ds_read_b64_tr_b16 a[164:165], v5 offset:12352
    ds_read_b64_tr_b16 a[166:167], v5 offset:12864
    v_mul_f32 v25, v25, v109
    v_mul_f32 v26, v26, v110
    v_mul_f32 v27, v27, v111
    v_cvt_pk_bf16_f32 v34, v24, v25
    v_cvt_pk_bf16_f32 v35, v26, v27
    v_accvgpr_write_b32 a62, v34
    v_accvgpr_write_b32 a63, v35
    v_mfma_f32_32x32x16_bf16 v[112:127], a[144:147], a[40:43], v[112:127]
    ds_read_b64_tr_b16 a[168:169], v5 offset:13312
    ds_read_b64_tr_b16 a[170:171], v5 offset:13824
    buffer_load_dwordx4 v46, s[16:19], s51 offen lds
    v_fma_f32 v20, v48, v48, s60
    v_fma_f32 v21, v49, v49, s60
    v_fma_f32 v22, v50, v50, s60
    v_fma_f32 v23, v51, v51, s60
    v_mfma_f32_32x32x16_bf16 v[128:143], a[148:151], a[40:43], v[128:143]
    s_waitcnt lgkmcnt(6)
    ds_read_b64_tr_b16 a[172:173], v5 offset:13376
    ds_read_b64_tr_b16 a[174:175], v5 offset:13888
    buffer_store_dwordx4 v[32:35], v2, s[20:23], s63 offen offset:3072 sc1
    v_mul_f32 v20, v20, v48
    v_mul_f32 v21, v21, v49
    v_mul_f32 v22, v22, v50
    v_mfma_f32_32x32x16_bf16 v[112:127], a[152:155], a[44:47], v[112:127]
    ds_read_b64_tr_b16 a[144:145], v5 offset:14336
    ds_read_b64_tr_b16 a[146:147], v5 offset:14848
    v_mul_f32 v23, v23, v51
    v_exp_f32 v20, v20
    v_exp_f32 v21, v21
    v_exp_f32 v22, v22
    v_mfma_f32_32x32x16_bf16 v[128:143], a[156:159], a[44:47], v[128:143]
    s_waitcnt lgkmcnt(6)
    ds_read_b64_tr_b16 a[148:149], v5 offset:14400
    ds_read_b64_tr_b16 a[150:151], v5 offset:14912
    v_exp_f32 v23, v23
    v_add_f32 v20, 1.0, v20
    v_add_f32 v21, 1.0, v21
    v_add_f32 v22, 1.0, v22
    v_add_f32 v23, 1.0, v23
    v_mfma_f32_32x32x16_bf16 v[144:159], a[160:163], a[0:3], 0
    ds_read_b64_tr_b16 a[152:153], v5 offset:15360
    ds_read_b64_tr_b16 a[154:155], v5 offset:15872
    v_rcp_f32 v20, v20
    v_rcp_f32 v21, v21
    v_rcp_f32 v22, v22
    v_mfma_f32_32x32x16_bf16 v[160:175], a[164:167], a[0:3], 0
    s_waitcnt lgkmcnt(6)
    ds_read_b64_tr_b16 a[156:157], v5 offset:15424
    ds_read_b64_tr_b16 a[158:159], v5 offset:15936
    v_rcp_f32 v23, v23
    v_mul_f32 v20, v20, v48
    v_mul_f32 v21, v21, v49
    v_mul_f32 v22, v22, v50
    v_mul_f32 v23, v23, v51
    v_cvt_pk_bf16_f32 v28, v20, v21
    v_mfma_f32_32x32x16_bf16 v[144:159], a[168:171], a[4:7], v[144:159]
    ds_read_b64_tr_b16 a[160:161], v5 offset:16384
    ds_read_b64_tr_b16 a[162:163], v5 offset:16896
    v_cvt_pk_bf16_f32 v29, v22, v23
    v_accvgpr_write_b32 a64, v28
    v_accvgpr_write_b32 a65, v29
    v_fma_f32 v24, v52, v52, s60
    v_fma_f32 v25, v53, v53, s60
    v_fma_f32 v26, v54, v54, s60
    v_fma_f32 v27, v55, v55, s60
    v_mfma_f32_32x32x16_bf16 v[160:175], a[172:175], a[4:7], v[160:175]
    s_waitcnt lgkmcnt(6)
    ds_read_b64_tr_b16 a[164:165], v5 offset:16448
    ds_read_b64_tr_b16 a[166:167], v5 offset:16960
    v_mul_f32 v24, v24, v52
    v_mul_f32 v25, v25, v53
    v_mul_f32 v26, v26, v54
    v_mul_f32 v27, v27, v55
    v_exp_f32 v24, v24
    v_mfma_f32_32x32x16_bf16 v[144:159], a[144:147], a[8:11], v[144:159]
    ds_read_b64_tr_b16 a[168:169], v5 offset:17408
    ds_read_b64_tr_b16 a[170:171], v5 offset:17920
    v_exp_f32 v25, v25
    v_exp_f32 v26, v26
    v_exp_f32 v27, v27
    v_add_f32 v24, 1.0, v24
    v_mfma_f32_32x32x16_bf16 v[160:175], a[148:151], a[8:11], v[160:175]
    s_waitcnt lgkmcnt(6)
    ds_read_b64_tr_b16 a[172:173], v5 offset:17472
    ds_read_b64_tr_b16 a[174:175], v5 offset:17984
    v_add_f32 v25, 1.0, v25
    v_add_f32 v26, 1.0, v26
    v_add_f32 v27, 1.0, v27
    v_rcp_f32 v24, v24
    v_rcp_f32 v25, v25
    v_mfma_f32_32x32x16_bf16 v[144:159], a[152:155], a[12:15], v[144:159]
    s_waitcnt vmcnt(17)
    s_barrier
    ds_read_b64_tr_b16 a[144:145], v6 offset:0
    ds_read_b64_tr_b16 a[146:147], v6 offset:512
    v_mfma_f32_32x32x16_bf16 v[160:175], a[156:159], a[12:15], v[160:175]
    s_waitcnt lgkmcnt(6)
    ds_read_b64_tr_b16 a[148:149], v6 offset:64
    ds_read_b64_tr_b16 a[150:151], v6 offset:576
    v_rcp_f32 v26, v26
    v_rcp_f32 v27, v27
    v_mul_f32 v24, v24, v52
    v_mul_f32 v25, v25, v53
    v_mul_f32 v26, v26, v54
    v_mfma_f32_32x32x16_bf16 v[144:159], a[160:163], a[16:19], v[144:159]
    s_add_u32 m0, s44, 0
    ds_read_b64_tr_b16 a[152:153], v6 offset:1024
    ds_read_b64_tr_b16 a[154:155], v6 offset:1536
    s_add_u32 s58, s50, 0
    buffer_load_dwordx4 v42, s[16:19], s58 offen lds
    v_mul_f32 v27, v27, v55
    v_cvt_pk_bf16_f32 v30, v24, v25
    v_cvt_pk_bf16_f32 v31, v26, v27
    v_mfma_f32_32x32x16_bf16 v[160:175], a[164:167], a[16:19], v[160:175]
    s_waitcnt lgkmcnt(6)
    ds_read_b64_tr_b16 a[156:157], v6 offset:1088
    ds_read_b64_tr_b16 a[158:159], v6 offset:1600
    s_xor_b32 s70, s56, 8192
    buffer_load_dword v36, v19, s[20:23], s70 offen offset:8 sc1
    v_accvgpr_write_b32 a66, v30
    v_accvgpr_write_b32 a67, v31
    v_fma_f32 v20, v56, v56, s60
    v_fma_f32 v21, v57, v57, s60
    v_fma_f32 v22, v58, v58, s60
    v_mfma_f32_32x32x16_bf16 v[144:159], a[168:171], a[20:23], v[144:159]
    s_add_u32 m0, s44, 2048
    ds_read_b64_tr_b16 a[160:161], v6 offset:2048
    ds_read_b64_tr_b16 a[162:163], v6 offset:2560
    v_fma_f32 v23, v59, v59, s60
    v_mul_f32 v20, v20, v56
    v_mul_f32 v21, v21, v57
    v_mul_f32 v22, v22, v58
    v_mul_f32 v23, v23, v59
    v_exp_f32 v20, v20
    v_mfma_f32_32x32x16_bf16 v[160:175], a[172:175], a[20:23], v[160:175]
    s_waitcnt lgkmcnt(6)
    ds_read_b64_tr_b16 a[164:165], v6 offset:2112
    ds_read_b64_tr_b16 a[166:167], v6 offset:2624
    s_add_u32 s58, s50, 36864
    buffer_load_dwordx4 v42, s[16:19], s58 offen lds
    v_exp_f32 v21, v21
    v_mfma_f32_32x32x16_bf16 v[144:159], a[144:147], a[24:27], v[144:159]
    s_add_u32 m0, s44, 4096
    ds_read_b64_tr_b16 a[168:169], v6 offset:3072
    ds_read_b64_tr_b16 a[170:171], v6 offset:3584
    s_add_u32 s63, s55, 16384
    buffer_store_dwordx4 v[28:31], v2, s[20:23], s63 offen offset:0 sc1
    v_exp_f32 v22, v22
    v_mfma_f32_32x32x16_bf16 v[160:175], a[148:151], a[24:27], v[160:175]
    s_waitcnt lgkmcnt(6)
    ds_read_b64_tr_b16 a[172:173], v6 offset:3136
    ds_read_b64_tr_b16 a[174:175], v6 offset:3648
    v_exp_f32 v23, v23
    v_add_f32 v20, 1.0, v20
    v_add_f32 v21, 1.0, v21
    v_add_f32 v22, 1.0, v22
    v_add_f32 v23, 1.0, v23
    v_mfma_f32_32x32x16_bf16 v[144:159], a[152:155], a[28:31], v[144:159]
    s_add_u32 s58, s50, 73728
    ds_read_b64_tr_b16 a[144:145], v6 offset:4096
    ds_read_b64_tr_b16 a[146:147], v6 offset:4608
    buffer_load_dwordx4 v42, s[16:19], s58 offen lds
    v_rcp_f32 v20, v20
    v_rcp_f32 v21, v21
    v_mfma_f32_32x32x16_bf16 v[160:175], a[156:159], a[28:31], v[160:175]
    s_waitcnt lgkmcnt(6)
    ds_read_b64_tr_b16 a[148:149], v6 offset:4160
    ds_read_b64_tr_b16 a[150:151], v6 offset:4672
    v_rcp_f32 v22, v22
    v_rcp_f32 v23, v23
    v_mul_f32 v20, v20, v56
    v_mul_f32 v21, v21, v57
    v_mul_f32 v22, v22, v58
    v_mfma_f32_32x32x16_bf16 v[144:159], a[160:163], a[32:35], v[144:159]
    s_add_u32 m0, s44, 6144
    ds_read_b64_tr_b16 a[152:153], v6 offset:5120
    ds_read_b64_tr_b16 a[154:155], v6 offset:5632
    v_mul_f32 v23, v23, v59
    v_cvt_pk_bf16_f32 v32, v20, v21
    v_cvt_pk_bf16_f32 v33, v22, v23
    v_accvgpr_write_b32 a68, v32
    v_accvgpr_write_b32 a69, v33
    v_fma_f32 v24, v60, v60, s60
    v_fma_f32 v25, v61, v61, s60
    v_mfma_f32_32x32x16_bf16 v[160:175], a[164:167], a[32:35], v[160:175]
    s_waitcnt lgkmcnt(6)
    ds_read_b64_tr_b16 a[156:157], v6 offset:5184
    ds_read_b64_tr_b16 a[158:159], v6 offset:5696
    s_add_u32 s58, s50, 110592
    buffer_load_dwordx4 v42, s[16:19], s58 offen lds
    v_fma_f32 v26, v62, v62, s60
    v_fma_f32 v27, v63, v63, s60
    v_mul_f32 v24, v24, v60
    v_mfma_f32_32x32x16_bf16 v[144:159], a[168:171], a[36:39], v[144:159]
    s_add_u32 m0, s44, 8192
    ds_read_b64_tr_b16 a[160:161], v6 offset:6144
    ds_read_b64_tr_b16 a[162:163], v6 offset:6656
    v_mul_f32 v25, v25, v61
    v_mul_f32 v26, v26, v62
    v_mul_f32 v27, v27, v63
    v_exp_f32 v24, v24
    v_exp_f32 v25, v25
    v_mfma_f32_32x32x16_bf16 v[160:175], a[172:175], a[36:39], v[160:175]
    s_waitcnt lgkmcnt(6)
    ds_read_b64_tr_b16 a[164:165], v6 offset:6208
    ds_read_b64_tr_b16 a[166:167], v6 offset:6720
    v_exp_f32 v26, v26
    v_exp_f32 v27, v27
    v_add_f32 v24, 1.0, v24
    v_add_f32 v25, 1.0, v25
    v_add_f32 v26, 1.0, v26
    v_mfma_f32_32x32x16_bf16 v[144:159], a[144:147], a[40:43], v[144:159]
    s_add_u32 s58, s50, 147456
    ds_read_b64_tr_b16 a[168:169], v6 offset:7168
    ds_read_b64_tr_b16 a[170:171], v6 offset:7680
    buffer_load_dwordx4 v42, s[16:19], s58 offen lds
    v_add_f32 v27, 1.0, v27
    v_rcp_f32 v24, v24
    v_mfma_f32_32x32x16_bf16 v[160:175], a[148:151], a[40:43], v[160:175]
    s_waitcnt lgkmcnt(6)
    ds_read_b64_tr_b16 a[172:173], v6 offset:7232
    ds_read_b64_tr_b16 a[174:175], v6 offset:7744
    v_rcp_f32 v25, v25
    v_rcp_f32 v26, v26
    v_rcp_f32 v27, v27
    v_mul_f32 v24, v24, v60
    v_mfma_f32_32x32x16_bf16 v[144:159], a[152:155], a[44:47], v[144:159]
    s_add_u32 m0, s44, 10240
    ds_read_b64_tr_b16 a[144:145], v6 offset:8192
    ds_read_b64_tr_b16 a[146:147], v6 offset:8704
    s_waitcnt vmcnt(7)
    s_mov_b64 exec, 1
    buffer_store_dword v37, v19, s[20:23], s56 offen offset:12 sc1
    s_mov_b64 exec, -1
    v_mul_f32 v25, v25, v61
    v_mul_f32 v26, v26, v62
    v_mul_f32 v27, v27, v63
    v_mfma_f32_32x32x16_bf16 v[160:175], a[156:159], a[44:47], v[160:175]
    s_waitcnt lgkmcnt(6)
    ds_read_b64_tr_b16 a[148:149], v6 offset:8256
    ds_read_b64_tr_b16 a[150:151], v6 offset:8768
    s_add_u32 s58, s50, 184320
    buffer_load_dwordx4 v42, s[16:19], s58 offen lds
    v_cvt_pk_bf16_f32 v34, v24, v25
    v_cvt_pk_bf16_f32 v35, v26, v27
    v_accvgpr_write_b32 a70, v34
    v_mfma_f32_32x32x16_bf16 v[176:191], a[160:163], a[0:3], 0
    s_add_u32 m0, s44, 12288
    ds_read_b64_tr_b16 a[152:153], v6 offset:9216
    ds_read_b64_tr_b16 a[154:155], v6 offset:9728
    v_accvgpr_write_b32 a71, v35
    v_and_b32 v21, 7, v1
    v_xor_b32 v21, s39, v21
    v_min_u32 v20, 2, v21
    v_sub_u32 v20, 8, v20
    v_cmp_gt_u32 vcc, 4, v21
    s_nop 1
    v_cndmask_b32 v18, 2, v20, vcc
    v_and_b32 v20, 3, v1
    v_mfma_f32_32x32x16_bf16 v[192:207], a[164:167], a[0:3], 0
    s_waitcnt lgkmcnt(6)
    ds_read_b64_tr_b16 a[156:157], v6 offset:9280
    ds_read_b64_tr_b16 a[158:159], v6 offset:9792
    buffer_store_dwordx4 v[32:35], v2, s[20:23], s63 offen offset:1024 sc1
    s_and_b32 s67, s39, 4
    v_or_b32 v20, s67, v20
    s_mov_b32 s67, 2359296
    v_mul_lo_u32 v86, v20, s67
    v_and_b32 v20, 1, v18
    v_mfma_f32_32x32x16_bf16 v[176:191], a[168:171], a[4:7], v[176:191]
    s_add_u32 s58, s50, 0
    ds_read_b64_tr_b16 a[160:161], v6 offset:10240
    ds_read_b64_tr_b16 a[162:163], v6 offset:10752
    buffer_load_dwordx4 v43, s[16:19], s58 offen lds
    v_lshl_add_u32 v86, v20, 7, v86
    v_add_u32 v86, 11264, v86
    v_cmp_gt_u32 vcc, 32, v14
    s_nop 1
    v_cndmask_b32 v18, 3, v18, vcc
    v_add_u32 v8, 73984, v8
    v_mfma_f32_32x32x16_bf16 v[192:207], a[172:175], a[4:7], v[192:207]
    s_waitcnt lgkmcnt(6)
    ds_read_b64_tr_b16 a[164:165], v6 offset:10304
    ds_read_b64_tr_b16 a[166:167], v6 offset:10816
    s_lshl_b32 s67, s39, 2
    v_lshl_add_u32 v85, v1, 7, s67
    v_lshrrev_b32 v20, 4, v1
    v_and_b32 v21, 15, v1
    v_lshlrev_b32 v21, 2, v21
    v_lshl_add_u32 v20, v20, 9, v21
    s_lshl_b32 s67, s39, 6
    v_add_u32 v80, s67, v20
    v_and_b32 v82, 1, v1
    v_mfma_f32_32x32x16_bf16 v[176:191], a[144:147], a[8:11], v[176:191]
    s_add_u32 m0, s44, 14336
    ds_read_b64_tr_b16 a[168:169], v6 offset:11264
    ds_read_b64_tr_b16 a[170:171], v6 offset:11776
    v_lshlrev_b32 v82, 2, v82
    v_bfe_u32 v20, v1, 1, 1
    v_lshl_add_u32 v82, v20, 4, v82
    v_bfe_u32 v20, v1, 4, 1
    v_lshl_add_u32 v82, v20, 3, v82
    v_lshrrev_b32 v20, 5, v1
    v_lshl_add_u32 v82, v20, 5, v82
    v_mfma_f32_32x32x16_bf16 v[192:207], a[148:151], a[8:11], v[192:207]
    s_waitcnt lgkmcnt(6)
    ds_read_b64_tr_b16 a[172:173], v6 offset:11328
    ds_read_b64_tr_b16 a[174:175], v6 offset:11840
    s_add_u32 s58, s50, 36864
    buffer_load_dwordx4 v43, s[16:19], s58 offen lds
    v_bfe_u32 v20, v1, 2, 2
    v_mul_u32_u24 v20, 1152, v20
    s_mul_i32 s67, s39, 4608
    s_lshl_b32 s72, s41, 6
    s_add_u32 s67, s67, s72
    s_add_u32 s67, s67, 512
    v_add3_u32 v81, v20, v82, s67
    v_mfma_f32_32x32x16_bf16 v[176:191], a[152:155], a[12:15], v[176:191]
    s_add_u32 m0, s44, 16384
    ds_read_b64_tr_b16 a[144:145], v6 offset:12288
    ds_read_b64_tr_b16 a[146:147], v6 offset:12800
    v_lshrrev_b32 v20, 5, v1
    v_mul_u32_u24 v83, 1152, v3
    v_lshl_add_u32 v83, v20, 4, v83
    v_accvgpr_read_b32 v106, a192
    v_accvgpr_read_b32 v107, a193
    v_accvgpr_read_b32 v64, a176
    v_accvgpr_read_b32 v65, a177
    v_mfma_f32_32x32x16_bf16 v[192:207], a[156:159], a[12:15], v[192:207]
    s_waitcnt lgkmcnt(6)
    ds_read_b64_tr_b16 a[148:149], v6 offset:12352
    ds_read_b64_tr_b16 a[150:151], v6 offset:12864
    v_accvgpr_read_b32 v66, a178
    v_accvgpr_read_b32 v67, a179
    v_accvgpr_read_b32 v68, a180
    v_accvgpr_read_b32 v69, a181
    v_accvgpr_read_b32 v70, a182
    v_accvgpr_read_b32 v71, a183
    v_accvgpr_read_b32 v72, a184
    v_mfma_f32_32x32x16_bf16 v[176:191], a[160:163], a[16:19], v[176:191]
    s_add_u32 s58, s50, 73728
    ds_read_b64_tr_b16 a[152:153], v6 offset:13312
    ds_read_b64_tr_b16 a[154:155], v6 offset:13824
    buffer_load_dwordx4 v43, s[16:19], s58 offen lds
    v_accvgpr_read_b32 v73, a185
    v_accvgpr_read_b32 v74, a186
    v_accvgpr_read_b32 v75, a187
    v_accvgpr_read_b32 v76, a188
    v_mfma_f32_32x32x16_bf16 v[192:207], a[164:167], a[16:19], v[192:207]
    s_waitcnt lgkmcnt(6)
    ds_read_b64_tr_b16 a[156:157], v6 offset:13376
    ds_read_b64_tr_b16 a[158:159], v6 offset:13888
    s_waitcnt vmcnt(11)
    v_cmp_ne_u32 vcc, s2, v36
    s_nop 0
    s_cmp_lg_u64 vcc, 0
    s_cbranch_scc1 M_SPX2
M_SRX2:
    v_accvgpr_read_b32 v77, a189
    v_accvgpr_read_b32 v78, a190
    v_accvgpr_read_b32 v79, a191
    v_mfma_f32_32x32x16_bf16 v[176:191], a[168:171], a[20:23], v[176:191]
    ds_read_b64_tr_b16 a[160:161], v6 offset:14336
    ds_read_b64_tr_b16 a[162:163], v6 offset:14848
    s_add_u32 s71, s68, 8192
    buffer_load_dwordx4 a[104:107], v2, s[20:23], s71 offen offset:0 sc1
    v_mfma_f32_32x32x16_bf16 v[192:207], a[172:175], a[20:23], v[192:207]
    s_waitcnt lgkmcnt(6)
    ds_read_b64_tr_b16 a[164:165], v6 offset:14400
    ds_read_b64_tr_b16 a[166:167], v6 offset:14912
    v_mfma_f32_32x32x16_bf16 v[176:191], a[144:147], a[24:27], v[176:191]
    ds_read_b64_tr_b16 a[168:169], v6 offset:15360
    ds_read_b64_tr_b16 a[170:171], v6 offset:15872
    buffer_load_dwordx4 a[108:111], v2, s[20:23], s71 offen offset:1024 sc1
    v_mfma_f32_32x32x16_bf16 v[192:207], a[148:151], a[24:27], v[192:207]
    s_waitcnt lgkmcnt(6)
    ds_read_b64_tr_b16 a[172:173], v6 offset:15424
    ds_read_b64_tr_b16 a[174:175], v6 offset:15936
    v_mfma_f32_32x32x16_bf16 v[176:191], a[152:155], a[28:31], v[176:191]
    ds_read_b64_tr_b16 a[144:145], v6 offset:16384
    ds_read_b64_tr_b16 a[146:147], v6 offset:16896
    buffer_load_dwordx4 a[112:115], v2, s[20:23], s71 offen offset:2048 sc1
    v_mfma_f32_32x32x16_bf16 v[192:207], a[156:159], a[28:31], v[192:207]
    s_waitcnt lgkmcnt(6)
    ds_read_b64_tr_b16 a[148:149], v6 offset:16448
    ds_read_b64_tr_b16 a[150:151], v6 offset:16960
    v_mfma_f32_32x32x16_bf16 v[176:191], a[160:163], a[32:35], v[176:191]
    ds_read_b64_tr_b16 a[152:153], v6 offset:17408
    ds_read_b64_tr_b16 a[154:155], v6 offset:17920
    buffer_load_dwordx4 a[116:119], v2, s[20:23], s71 offen offset:3072 sc1
    v_mfma_f32_32x32x16_bf16 v[192:207], a[164:167], a[32:35], v[192:207]
    s_waitcnt lgkmcnt(6)
    ds_read_b64_tr_b16 a[156:157], v6 offset:17472
    ds_read_b64_tr_b16 a[158:159], v6 offset:17984
    v_mfma_f32_32x32x16_bf16 v[176:191], a[168:171], a[36:39], v[176:191]
    s_waitcnt vmcnt(18)
    s_barrier
    ds_read_b64_tr_b16 a[160:161], v7 offset:0
    ds_read_b64_tr_b16 a[162:163], v7 offset:512
    v_mfma_f32_32x32x16_bf16 v[192:207], a[172:175], a[36:39], v[192:207]
    s_waitcnt lgkmcnt(6)
    ds_read_b64_tr_b16 a[164:165], v7 offset:64
    ds_read_b64_tr_b16 a[166:167], v7 offset:576
    v_mfma_f32_32x32x16_bf16 v[176:191], a[144:147], a[40:43], v[176:191]
    s_add_u32 m0, s44, 36992
    ds_read_b64_tr_b16 a[168:169], v7 offset:1024
    ds_read_b64_tr_b16 a[170:171], v7 offset:1536
    s_add_u32 s58, s50, 110592
    buffer_load_dwordx4 v43, s[16:19], s58 offen lds
    v_mfma_f32_32x32x16_bf16 v[192:207], a[148:151], a[40:43], v[192:207]
    s_waitcnt lgkmcnt(6)
    ds_read_b64_tr_b16 a[172:173], v7 offset:1088
    ds_read_b64_tr_b16 a[174:175], v7 offset:1600
    v_mfma_f32_32x32x16_bf16 v[176:191], a[152:155], a[44:47], v[176:191]
    s_add_u32 m0, s44, 39040
    ds_read_b64_tr_b16 a[144:145], v7 offset:2048
    ds_read_b64_tr_b16 a[146:147], v7 offset:2560
    v_mfma_f32_32x32x16_bf16 v[192:207], a[156:159], a[44:47], v[192:207]
    s_waitcnt lgkmcnt(6)
    ds_read_b64_tr_b16 a[148:149], v7 offset:2112
    ds_read_b64_tr_b16 a[150:151], v7 offset:2624
    s_add_u32 s58, s50, 147456
    buffer_load_dwordx4 v43, s[16:19], s58 offen lds
    v_mfma_f32_32x32x16_bf16 v[112:127], a[160:163], a[48:51], v[112:127]
    s_add_u32 m0, s44, 41088
    ds_read_b64_tr_b16 a[152:153], v7 offset:3072
    ds_read_b64_tr_b16 a[154:155], v7 offset:3584
    v_mfma_f32_32x32x16_bf16 v[128:143], a[164:167], a[48:51], v[128:143]
    s_waitcnt lgkmcnt(6)
    ds_read_b64_tr_b16 a[156:157], v7 offset:3136
    ds_read_b64_tr_b16 a[158:159], v7 offset:3648
    v_mfma_f32_32x32x16_bf16 v[112:127], a[168:171], a[52:55], v[112:127]
    s_add_u32 s58, s50, 184320
    ds_read_b64_tr_b16 a[160:161], v7 offset:4096
    ds_read_b64_tr_b16 a[162:163], v7 offset:4608
    buffer_load_dwordx4 v43, s[16:19], s58 offen lds
    v_mfma_f32_32x32x16_bf16 v[128:143], a[172:175], a[52:55], v[128:143]
    s_waitcnt lgkmcnt(6)
    ds_read_b64_tr_b16 a[164:165], v7 offset:4160
    ds_read_b64_tr_b16 a[166:167], v7 offset:4672
    s_waitcnt vmcnt(10)
    s_mov_b64 exec, 1
    buffer_store_dword v37, v19, s[20:23], s56 offen offset:16 sc1
    s_mov_b64 exec, -1
    v_mfma_f32_32x32x16_bf16 v[112:127], a[144:147], a[56:59], v[112:127]
    s_add_u32 m0, s44, 43136
    ds_read_b64_tr_b16 a[168:169], v7 offset:5120
    ds_read_b64_tr_b16 a[170:171], v7 offset:5632
    v_mfma_f32_32x32x16_bf16 v[128:143], a[148:151], a[56:59], v[128:143]
    s_waitcnt lgkmcnt(6)
    ds_read_b64_tr_b16 a[172:173], v7 offset:5184
    ds_read_b64_tr_b16 a[174:175], v7 offset:5696
    s_add_u32 s58, s50, 221184
    buffer_load_dwordx4 v42, s[16:19], s58 offen lds
    v_mfma_f32_32x32x16_bf16 v[112:127], a[152:155], a[60:63], v[112:127]
    s_add_u32 m0, s44, 45184
    ds_read_b64_tr_b16 a[144:145], v7 offset:6144
    ds_read_b64_tr_b16 a[146:147], v7 offset:6656
    s_xor_b32 s70, s56, 8192
    buffer_load_dword v36, v19, s[20:23], s70 offen offset:12 sc1
    v_mfma_f32_32x32x16_bf16 v[128:143], a[156:159], a[60:63], v[128:143]
    s_waitcnt lgkmcnt(6)
    ds_read_b64_tr_b16 a[148:149], v7 offset:6208
    ds_read_b64_tr_b16 a[150:151], v7 offset:6720
    v_mfma_f32_32x32x16_bf16 v[112:127], a[160:163], a[64:67], v[112:127]
    s_add_u32 s58, s50, 258048
    ds_read_b64_tr_b16 a[152:153], v7 offset:7168
    ds_read_b64_tr_b16 a[154:155], v7 offset:7680
    buffer_load_dwordx4 v42, s[16:19], s58 offen lds
    v_mfma_f32_32x32x16_bf16 v[128:143], a[164:167], a[64:67], v[128:143]
    s_waitcnt lgkmcnt(6)
    ds_read_b64_tr_b16 a[156:157], v7 offset:7232
    ds_read_b64_tr_b16 a[158:159], v7 offset:7744
    v_mfma_f32_32x32x16_bf16 v[112:127], a[168:171], a[68:71], v[112:127]
    s_add_u32 m0, s44, 47232
    ds_read_b64_tr_b16 a[160:161], v7 offset:8192
    ds_read_b64_tr_b16 a[162:163], v7 offset:8704
    v_mfma_f32_32x32x16_bf16 v[128:143], a[172:175], a[68:71], v[128:143]
    s_waitcnt lgkmcnt(6)
    ds_read_b64_tr_b16 a[164:165], v7 offset:8256
    ds_read_b64_tr_b16 a[166:167], v7 offset:8768
    buffer_load_dwordx4 v42, s[16:19], s52 offen lds
    v_mfma_f32_32x32x16_bf16 v[144:159], a[144:147], a[48:51], v[144:159]
    s_add_u32 m0, s44, 49280
    ds_read_b64_tr_b16 a[168:169], v7 offset:9216
    ds_read_b64_tr_b16 a[170:171], v7 offset:9728
    v_mfma_f32_32x32x16_bf16 v[160:175], a[148:151], a[48:51], v[160:175]
    s_waitcnt lgkmcnt(6)
    ds_read_b64_tr_b16 a[172:173], v7 offset:9280
    ds_read_b64_tr_b16 a[174:175], v7 offset:9792
    v_mfma_f32_32x32x16_bf16 v[144:159], a[152:155], a[52:55], v[144:159]
    s_add_u32 s58, s50, 221184
    ds_read_b64_tr_b16 a[144:145], v7 offset:10240
    ds_read_b64_tr_b16 a[146:147], v7 offset:10752
    buffer_load_dwordx4 v43, s[16:19], s58 offen lds
    v_mfma_f32_32x32x16_bf16 v[160:175], a[156:159], a[52:55], v[160:175]
    s_waitcnt lgkmcnt(6)
    ds_read_b64_tr_b16 a[148:149], v7 offset:10304
    ds_read_b64_tr_b16 a[150:151], v7 offset:10816
    v_mfma_f32_32x32x16_bf16 v[144:159], a[160:163], a[56:59], v[144:159]
    s_add_u32 m0, s44, 51328
    ds_read_b64_tr_b16 a[152:153], v7 offset:11264
    ds_read_b64_tr_b16 a[154:155], v7 offset:11776
    v_mfma_f32_32x32x16_bf16 v[160:175], a[164:167], a[56:59], v[160:175]
    s_waitcnt lgkmcnt(6)
    ds_read_b64_tr_b16 a[156:157], v7 offset:11328
    ds_read_b64_tr_b16 a[158:159], v7 offset:11840
    s_add_u32 s58, s50, 258048
    buffer_load_dwordx4 v43, s[16:19], s58 offen lds
    v_mfma_f32_32x32x16_bf16 v[144:159], a[168:171], a[60:63], v[144:159]
    s_add_u32 m0, s44, 53376
    ds_read_b64_tr_b16 a[160:161], v7 offset:12288
    ds_read_b64_tr_b16 a[162:163], v7 offset:12800
    v_mfma_f32_32x32x16_bf16 v[160:175], a[172:175], a[60:63], v[160:175]
    s_waitcnt lgkmcnt(6)
    ds_read_b64_tr_b16 a[164:165], v7 offset:12352
    ds_read_b64_tr_b16 a[166:167], v7 offset:12864
    v_mfma_f32_32x32x16_bf16 v[144:159], a[144:147], a[64:67], v[144:159]
    ds_read_b64_tr_b16 a[168:169], v7 offset:13312
    ds_read_b64_tr_b16 a[170:171], v7 offset:13824
    buffer_load_dwordx4 v43, s[16:19], s52 offen lds
    v_mfma_f32_32x32x16_bf16 v[160:175], a[148:151], a[64:67], v[160:175]
    s_waitcnt lgkmcnt(6)
    ds_read_b64_tr_b16 a[172:173], v7 offset:13376
    ds_read_b64_tr_b16 a[174:175], v7 offset:13888
    v_mfma_f32_32x32x16_bf16 v[144:159], a[152:155], a[68:71], v[144:159]
    ds_read_b64_tr_b16 a[144:145], v7 offset:14336
    ds_read_b64_tr_b16 a[146:147], v7 offset:14848
    s_waitcnt vmcnt(5)
    v_cmp_ne_u32 vcc, s2, v36
    s_nop 0
    s_cmp_lg_u64 vcc, 0
    s_cbranch_scc1 M_SPX3
M_SRX3:
    v_mfma_f32_32x32x16_bf16 v[160:175], a[156:159], a[68:71], v[160:175]
    s_waitcnt lgkmcnt(6)
    ds_read_b64_tr_b16 a[148:149], v7 offset:14400
    ds_read_b64_tr_b16 a[150:151], v7 offset:14912
    s_add_u32 s71, s68, 12288
    buffer_load_dwordx4 a[120:123], v2, s[20:23], s71 offen offset:0 sc1
    v_mfma_f32_32x32x16_bf16 v[176:191], a[160:163], a[48:51], v[176:191]
    ds_read_b64_tr_b16 a[152:153], v7 offset:15360
    ds_read_b64_tr_b16 a[154:155], v7 offset:15872
    v_mfma_f32_32x32x16_bf16 v[192:207], a[164:167], a[48:51], v[192:207]
    s_waitcnt lgkmcnt(6)
    ds_read_b64_tr_b16 a[156:157], v7 offset:15424
    ds_read_b64_tr_b16 a[158:159], v7 offset:15936
    buffer_load_dwordx4 a[124:127], v2, s[20:23], s71 offen offset:1024 sc1
    v_mfma_f32_32x32x16_bf16 v[176:191], a[168:171], a[52:55], v[176:191]
    ds_read_b64_tr_b16 a[160:161], v7 offset:16384
    ds_read_b64_tr_b16 a[162:163], v7 offset:16896
    v_mfma_f32_32x32x16_bf16 v[192:207], a[172:175], a[52:55], v[192:207]
    s_waitcnt lgkmcnt(6)
    ds_read_b64_tr_b16 a[164:165], v7 offset:16448
    ds_read_b64_tr_b16 a[166:167], v7 offset:16960
    buffer_load_dwordx4 a[128:131], v2, s[20:23], s71 offen offset:2048 sc1
    v_mfma_f32_32x32x16_bf16 v[176:191], a[144:147], a[56:59], v[176:191]
    ds_read_b64_tr_b16 a[168:169], v7 offset:17408
    ds_read_b64_tr_b16 a[170:171], v7 offset:17920
    v_mfma_f32_32x32x16_bf16 v[192:207], a[148:151], a[56:59], v[192:207]
    s_waitcnt lgkmcnt(6)
    ds_read_b64_tr_b16 a[172:173], v7 offset:17472
    ds_read_b64_tr_b16 a[174:175], v7 offset:17984
    buffer_load_dwordx4 a[132:135], v2, s[20:23], s71 offen offset:3072 sc1
    v_mfma_f32_32x32x16_bf16 v[176:191], a[152:155], a[60:63], v[176:191]
    s_waitcnt vmcnt(19)
    s_barrier
    s_and_b32 s48, s36, 1
    s_lshl_b32 s48, s48, 10
    s_lshr_b32 s3, s36, 1
    s_mul_i32 s3, s3, 18432
    s_add_u32 s48, s48, s3
    s_add_u32 s48, s48, 1280
    ds_read_b64_tr_b16 a[144:145], v4 offset:0
    ds_read_b64_tr_b16 a[146:147], v4 offset:512
    v_mfma_f32_32x32x16_bf16 v[192:207], a[156:159], a[60:63], v[192:207]
    s_waitcnt lgkmcnt(6)
    ds_read_b64_tr_b16 a[148:149], v4 offset:64
    ds_read_b64_tr_b16 a[150:151], v4 offset:576
    v_mfma_f32_32x32x16_bf16 v[176:191], a[160:163], a[64:67], v[176:191]
    s_add_u32 m0, s48, 73984
    ds_read_b64_tr_b16 a[152:153], v4 offset:1024
    ds_read_b64_tr_b16 a[154:155], v4 offset:1536
    s_add_u32 s58, s54, 0
    buffer_load_dwordx4 v12, s[16:19], s58 offen lds
    v_mfma_f32_32x32x16_bf16 v[192:207], a[164:167], a[64:67], v[192:207]
    s_waitcnt lgkmcnt(6)
    ds_read_b64_tr_b16 a[156:157], v4 offset:1088
    ds_read_b64_tr_b16 a[158:159], v4 offset:1600
    v_mfma_f32_32x32x16_bf16 v[176:191], a[168:171], a[68:71], v[176:191]
    s_add_u32 m0, s48, 76032
    ds_read_b64_tr_b16 a[160:161], v4 offset:2048
    ds_read_b64_tr_b16 a[162:163], v4 offset:2560
    v_mfma_f32_32x32x16_bf16 v[192:207], a[172:175], a[68:71], v[192:207]
    s_waitcnt lgkmcnt(6)
    ds_read_b64_tr_b16 a[164:165], v4 offset:2112
    ds_read_b64_tr_b16 a[166:167], v4 offset:2624
    s_add_u32 s58, s54, 36864
    buffer_load_dwordx4 v12, s[16:19], s58 offen lds
    s_waitcnt vmcnt(63)
    v_mfma_f32_32x32x16_bf16 v[112:127], a[144:147], a[72:75], v[112:127]
    s_add_u32 m0, s48, 78080
    ds_read_b64_tr_b16 a[168:169], v4 offset:3072
    ds_read_b64_tr_b16 a[170:171], v4 offset:3584
    v_mfma_f32_32x32x16_bf16 v[128:143], a[148:151], a[72:75], v[128:143]
    s_waitcnt lgkmcnt(6)
    ds_read_b64_tr_b16 a[172:173], v4 offset:3136
    ds_read_b64_tr_b16 a[174:175], v4 offset:3648
    v_mfma_f32_32x32x16_bf16 v[112:127], a[152:155], a[76:79], v[112:127]
    s_add_u32 s58, s54, 73728
    ds_read_b64_tr_b16 a[144:145], v4 offset:4096
    ds_read_b64_tr_b16 a[146:147], v4 offset:4608
    buffer_load_dwordx4 v12, s[16:19], s58 offen lds
    v_mfma_f32_32x32x16_bf16 v[128:143], a[156:159], a[76:79], v[128:143]
    s_waitcnt lgkmcnt(6)
    ds_read_b64_tr_b16 a[148:149], v4 offset:4160
    ds_read_b64_tr_b16 a[150:151], v4 offset:4672
    s_waitcnt vmcnt(63)
    v_mfma_f32_32x32x16_bf16 v[112:127], a[160:163], a[80:83], v[112:127]
    s_add_u32 m0, s48, 80128
    ds_read_b64_tr_b16 a[152:153], v4 offset:5120
    ds_read_b64_tr_b16 a[154:155], v4 offset:5632
    s_xor_b32 s70, s56, 8192
    buffer_load_dword v36, v19, s[20:23], s70 offen offset:16 sc1
    v_mfma_f32_32x32x16_bf16 v[128:143], a[164:167], a[80:83], v[128:143]
    s_waitcnt lgkmcnt(6)
    ds_read_b64_tr_b16 a[156:157], v4 offset:5184
    ds_read_b64_tr_b16 a[158:159], v4 offset:5696
    s_add_u32 s58, s54, 110592
    buffer_load_dwordx4 v12, s[16:19], s58 offen lds
    v_mfma_f32_32x32x16_bf16 v[112:127], a[168:171], a[84:87], v[112:127]
    s_add_u32 m0, s48, 82176
    ds_read_b64_tr_b16 a[160:161], v4 offset:6144
    ds_read_b64_tr_b16 a[162:163], v4 offset:6656
    v_mfma_f32_32x32x16_bf16 v[128:143], a[172:175], a[84:87], v[128:143]
    s_waitcnt lgkmcnt(6)
    ds_read_b64_tr_b16 a[164:165], v4 offset:6208
    ds_read_b64_tr_b16 a[166:167], v4 offset:6720
    s_waitcnt vmcnt(52)
    v_mfma_f32_32x32x16_bf16 v[112:127], a[144:147], a[88:91], v[112:127]
    s_add_u32 s58, s54, 147456
    ds_read_b64_tr_b16 a[168:169], v4 offset:7168
    ds_read_b64_tr_b16 a[170:171], v4 offset:7680
    buffer_load_dwordx4 v12, s[16:19], s58 offen lds
    v_mfma_f32_32x32x16_bf16 v[128:143], a[148:151], a[88:91], v[128:143]
    s_waitcnt lgkmcnt(6)
    ds_read_b64_tr_b16 a[172:173], v4 offset:7232
    ds_read_b64_tr_b16 a[174:175], v4 offset:7744
    v_mfma_f32_32x32x16_bf16 v[112:127], a[152:155], a[92:95], v[112:127]
    s_add_u32 m0, s48, 84224
    ds_read_b64_tr_b16 a[144:145], v4 offset:8192
    ds_read_b64_tr_b16 a[146:147], v4 offset:8704
    v_mfma_f32_32x32x16_bf16 v[128:143], a[156:159], a[92:95], v[128:143]
    s_waitcnt lgkmcnt(6)
    ds_read_b64_tr_b16 a[148:149], v4 offset:8256
    ds_read_b64_tr_b16 a[150:151], v4 offset:8768
    s_add_u32 s58, s54, 184320
    buffer_load_dwordx4 v12, s[16:19], s58 offen lds
    s_waitcnt vmcnt(51)
    v_mfma_f32_32x32x16_bf16 v[112:127], a[160:163], a[96:99], v[112:127]
    s_add_u32 m0, s48, 86272
    ds_read_b64_tr_b16 a[152:153], v4 offset:9216
    ds_read_b64_tr_b16 a[154:155], v4 offset:9728
    v_mfma_f32_32x32x16_bf16 v[128:143], a[164:167], a[96:99], v[128:143]
    s_waitcnt lgkmcnt(6)
    ds_read_b64_tr_b16 a[156:157], v4 offset:9280
    ds_read_b64_tr_b16 a[158:159], v4 offset:9792
    v_mfma_f32_32x32x16_bf16 v[112:127], a[168:171], a[100:103], v[112:127]
    s_add_u32 s58, s54, 221184
    ds_read_b64_tr_b16 a[160:161], v4 offset:10240
    ds_read_b64_tr_b16 a[162:163], v4 offset:10752
    buffer_load_dwordx4 v12, s[16:19], s58 offen lds
    v_mfma_f32_32x32x16_bf16 v[128:143], a[172:175], a[100:103], v[128:143]
    s_waitcnt lgkmcnt(6)
    ds_read_b64_tr_b16 a[164:165], v4 offset:10304
    ds_read_b64_tr_b16 a[166:167], v4 offset:10816
    s_waitcnt vmcnt(25)
    v_mfma_f32_32x32x16_bf16 v[112:127], a[144:147], a[104:107], v[112:127]
    s_add_u32 m0, s48, 88320
    ds_read_b64_tr_b16 a[168:169], v4 offset:11264
    ds_read_b64_tr_b16 a[170:171], v4 offset:11776
    v_mfma_f32_32x32x16_bf16 v[128:143], a[148:151], a[104:107], v[128:143]
    s_waitcnt lgkmcnt(6)
    ds_read_b64_tr_b16 a[172:173], v4 offset:11328
    ds_read_b64_tr_b16 a[174:175], v4 offset:11840
    s_add_u32 s58, s54, 258048
    buffer_load_dwordx4 v12, s[16:19], s58 offen lds
    v_mfma_f32_32x32x16_bf16 v[112:127], a[152:155], a[108:111], v[112:127]
    s_add_u32 m0, s48, 90368
    ds_read_b64_tr_b16 a[144:145], v4 offset:12288
    ds_read_b64_tr_b16 a[146:147], v4 offset:12800
    v_mfma_f32_32x32x16_bf16 v[128:143], a[156:159], a[108:111], v[128:143]
    s_waitcnt lgkmcnt(6)
    ds_read_b64_tr_b16 a[148:149], v4 offset:12352
    ds_read_b64_tr_b16 a[150:151], v4 offset:12864
    s_waitcnt vmcnt(24)
    v_mfma_f32_32x32x16_bf16 v[112:127], a[160:163], a[112:115], v[112:127]
    ds_read_b64_tr_b16 a[152:153], v4 offset:13312
    ds_read_b64_tr_b16 a[154:155], v4 offset:13824
    buffer_load_dwordx4 v12, s[16:19], s53 offen lds
    v_mfma_f32_32x32x16_bf16 v[128:143], a[164:167], a[112:115], v[128:143]
    s_waitcnt lgkmcnt(6)
    ds_read_b64_tr_b16 a[156:157], v4 offset:13376
    ds_read_b64_tr_b16 a[158:159], v4 offset:13888
    s_waitcnt vmcnt(6)
    v_cmp_ne_u32 vcc, s2, v36
    s_nop 0
    s_cmp_lg_u64 vcc, 0
    s_cbranch_scc1 M_SPX4
M_SRX4:
    v_mfma_f32_32x32x16_bf16 v[112:127], a[168:171], a[116:119], v[112:127]
    ds_read_b64_tr_b16 a[160:161], v4 offset:14336
    ds_read_b64_tr_b16 a[162:163], v4 offset:14848
    s_add_u32 s71, s68, 16384
    buffer_load_dwordx4 a[136:139], v2, s[20:23], s71 offen offset:0 sc1
    v_mfma_f32_32x32x16_bf16 v[128:143], a[172:175], a[116:119], v[128:143]
    s_waitcnt lgkmcnt(6)
    ds_read_b64_tr_b16 a[164:165], v4 offset:14400
    ds_read_b64_tr_b16 a[166:167], v4 offset:14912
    v_mfma_f32_32x32x16_bf16 v[144:159], a[144:147], a[72:75], v[144:159]
    ds_read_b64_tr_b16 a[168:169], v4 offset:15360
    ds_read_b64_tr_b16 a[170:171], v4 offset:15872
    buffer_load_dwordx4 a[140:143], v2, s[20:23], s71 offen offset:1024 sc1
    v_mfma_f32_32x32x16_bf16 v[160:175], a[148:151], a[72:75], v[160:175]
    s_waitcnt lgkmcnt(6)
    ds_read_b64_tr_b16 a[172:173], v4 offset:15424
    ds_read_b64_tr_b16 a[174:175], v4 offset:15936
    v_mfma_f32_32x32x16_bf16 v[144:159], a[152:155], a[76:79], v[144:159]
    ds_read_b64_tr_b16 a[144:145], v4 offset:16384
    ds_read_b64_tr_b16 a[146:147], v4 offset:16896
    v_mfma_f32_32x32x16_bf16 v[160:175], a[156:159], a[76:79], v[160:175]
    s_waitcnt lgkmcnt(6)
    ds_read_b64_tr_b16 a[148:149], v4 offset:16448
    ds_read_b64_tr_b16 a[150:151], v4 offset:16960
    v_mfma_f32_32x32x16_bf16 v[144:159], a[160:163], a[80:83], v[144:159]
    ds_read_b64_tr_b16 a[152:153], v4 offset:17408
    ds_read_b64_tr_b16 a[154:155], v4 offset:17920
    v_mfma_f32_32x32x16_bf16 v[160:175], a[164:167], a[80:83], v[160:175]
    s_waitcnt lgkmcnt(6)
    ds_read_b64_tr_b16 a[156:157], v4 offset:17472
    ds_read_b64_tr_b16 a[158:159], v4 offset:17984
    v_mfma_f32_32x32x16_bf16 v[144:159], a[168:171], a[84:87], v[144:159]
    s_waitcnt vmcnt(16)
    s_barrier
    ds_read_b64_tr_b16 a[160:161], v5 offset:0
    ds_read_b64_tr_b16 a[162:163], v5 offset:512
    v_mfma_f32_32x32x16_bf16 v[160:175], a[172:175], a[84:87], v[160:175]
    s_waitcnt lgkmcnt(6)
    ds_read_b64_tr_b16 a[164:165], v5 offset:64
    ds_read_b64_tr_b16 a[166:167], v5 offset:576
    v_mfma_f32_32x32x16_bf16 v[144:159], a[144:147], a[88:91], v[144:159]
    s_add_u32 m0, s44, 110976
    ds_read_b64_tr_b16 a[168:169], v5 offset:1024
    ds_read_b64_tr_b16 a[170:171], v5 offset:1536
    s_add_u32 s58, s50, 0
    buffer_load_dwordx4 v46, s[16:19], s58 offen lds
    v_mfma_f32_32x32x16_bf16 v[160:175], a[148:151], a[88:91], v[160:175]
    s_waitcnt lgkmcnt(6)
    ds_read_b64_tr_b16 a[172:173], v5 offset:1088
    ds_read_b64_tr_b16 a[174:175], v5 offset:1600
    v_mfma_f32_32x32x16_bf16 v[144:159], a[152:155], a[92:95], v[144:159]
    s_add_u32 m0, s44, 113024
    ds_read_b64_tr_b16 a[144:145], v5 offset:2048
    ds_read_b64_tr_b16 a[146:147], v5 offset:2560
    v_mfma_f32_32x32x16_bf16 v[160:175], a[156:159], a[92:95], v[160:175]
    s_waitcnt lgkmcnt(6)
    ds_read_b64_tr_b16 a[148:149], v5 offset:2112
    ds_read_b64_tr_b16 a[150:151], v5 offset:2624
    s_add_u32 s58, s50, 36864
    buffer_load_dwordx4 v46, s[16:19], s58 offen lds
    v_mfma_f32_32x32x16_bf16 v[144:159], a[160:163], a[96:99], v[144:159]
    s_add_u32 m0, s44, 115072
    ds_read_b64_tr_b16 a[152:153], v5 offset:3072
    ds_read_b64_tr_b16 a[154:155], v5 offset:3584
    v_mfma_f32_32x32x16_bf16 v[160:175], a[164:167], a[96:99], v[160:175]
    s_waitcnt lgkmcnt(6)
    ds_read_b64_tr_b16 a[156:157], v5 offset:3136
    ds_read_b64_tr_b16 a[158:159], v5 offset:3648
    v_mfma_f32_32x32x16_bf16 v[144:159], a[168:171], a[100:103], v[144:159]
    s_add_u32 s58, s50, 73728
    ds_read_b64_tr_b16 a[160:161], v5 offset:4096
    ds_read_b64_tr_b16 a[162:163], v5 offset:4608
    buffer_load_dwordx4 v46, s[16:19], s58 offen lds
    v_lshlrev_b32 v48, 16, v64
    v_mfma_f32_32x32x16_bf16 v[160:175], a[172:175], a[100:103], v[160:175]
    s_waitcnt lgkmcnt(6)
    ds_read_b64_tr_b16 a[164:165], v5 offset:4160
    ds_read_b64_tr_b16 a[166:167], v5 offset:4672
    v_and_b32 v49, s69, v64
    v_lshlrev_b32 v20, 16, v72
    v_and_b32 v21, s69, v72
    v_lshlrev_b32 v50, 16, v65
    v_mfma_f32_32x32x16_bf16 v[144:159], a[144:147], a[104:107], v[144:159]
    s_add_u32 m0, s44, 117120
    ds_read_b64_tr_b16 a[168:169], v5 offset:5120
    ds_read_b64_tr_b16 a[170:171], v5 offset:5632
    v_and_b32 v51, s69, v65
    v_lshlrev_b32 v22, 16, v73
    v_and_b32 v23, s69, v73
    v_lshlrev_b32 v52, 16, v66
    v_mfma_f32_32x32x16_bf16 v[160:175], a[148:151], a[104:107], v[160:175]
    s_waitcnt lgkmcnt(6)
    ds_read_b64_tr_b16 a[172:173], v5 offset:5184
    ds_read_b64_tr_b16 a[174:175], v5 offset:5696
    s_add_u32 s58, s50, 110592
    buffer_load_dwordx4 v46, s[16:19], s58 offen lds
    v_mfma_f32_32x32x16_bf16 v[144:159], a[152:155], a[108:111], v[144:159]
    s_add_u32 m0, s44, 119168
    ds_read_b64_tr_b16 a[144:145], v5 offset:6144
    ds_read_b64_tr_b16 a[146:147], v5 offset:6656
    v_and_b32 v53, s69, v66
    v_lshlrev_b32 v24, 16, v74
    v_and_b32 v25, s69, v74
    v_lshlrev_b32 v54, 16, v67
    v_mfma_f32_32x32x16_bf16 v[160:175], a[156:159], a[108:111], v[160:175]
    s_waitcnt lgkmcnt(6)
    ds_read_b64_tr_b16 a[148:149], v5 offset:6208
    ds_read_b64_tr_b16 a[150:151], v5 offset:6720
    v_and_b32 v55, s69, v67
    v_lshlrev_b32 v26, 16, v75
    v_and_b32 v27, s69, v75
    v_add_f32 v48, v48, v20
    v_mfma_f32_32x32x16_bf16 v[144:159], a[160:163], a[112:115], v[144:159]
    s_add_u32 s58, s50, 147456
    ds_read_b64_tr_b16 a[152:153], v5 offset:7168
    ds_read_b64_tr_b16 a[154:155], v5 offset:7680
    buffer_load_dwordx4 v46, s[16:19], s58 offen lds
    v_add_f32 v49, v49, v21
    v_mfma_f32_32x32x16_bf16 v[160:175], a[164:167], a[112:115], v[160:175]
    s_waitcnt lgkmcnt(6)
    ds_read_b64_tr_b16 a[156:157], v5 offset:7232
    ds_read_b64_tr_b16 a[158:159], v5 offset:7744
    v_add_f32 v50, v50, v22
    v_add_f32 v51, v51, v23
    v_add_f32 v52, v52, v24
    v_add_f32 v53, v53, v25
    v_mfma_f32_32x32x16_bf16 v[144:159], a[168:171], a[116:119], v[144:159]
    s_add_u32 m0, s44, 121216
    ds_read_b64_tr_b16 a[160:161], v5 offset:8192
    ds_read_b64_tr_b16 a[162:163], v5 offset:8704
    v_add_f32 v54, v54, v26
    v_add_f32 v55, v55, v27
    v_mul_f32 v48, s59, v48
    v_mul_f32 v49, s59, v49
    v_mfma_f32_32x32x16_bf16 v[160:175], a[172:175], a[116:119], v[160:175]
    s_waitcnt lgkmcnt(6)
    ds_read_b64_tr_b16 a[164:165], v5 offset:8256
    ds_read_b64_tr_b16 a[166:167], v5 offset:8768
    s_add_u32 s58, s50, 184320
    buffer_load_dwordx4 v46, s[16:19], s58 offen lds
    s_waitcnt vmcnt(20)
    v_mfma_f32_32x32x16_bf16 v[112:127], a[144:147], a[120:123], v[112:127]
    s_add_u32 m0, s44, 123264
    ds_read_b64_tr_b16 a[168:169], v5 offset:9216
    ds_read_b64_tr_b16 a[170:171], v5 offset:9728
    v_mul_f32 v50, s59, v50
    v_mul_f32 v51, s59, v51
    v_mul_f32 v52, s59, v52
    v_mul_f32 v53, s59, v53
    v_mfma_f32_32x32x16_bf16 v[128:143], a[148:151], a[120:123], v[128:143]
    s_waitcnt lgkmcnt(6)
    ds_read_b64_tr_b16 a[172:173], v5 offset:9280
    ds_read_b64_tr_b16 a[174:175], v5 offset:9792
    v_mul_f32 v54, s59, v54
    v_mul_f32 v55, s59, v55
    v_lshlrev_b32 v56, 16, v68
    v_and_b32 v57, s69, v68
    v_mfma_f32_32x32x16_bf16 v[112:127], a[152:155], a[124:127], v[112:127]
    s_add_u32 s58, s50, 221184
    ds_read_b64_tr_b16 a[144:145], v5 offset:10240
    ds_read_b64_tr_b16 a[146:147], v5 offset:10752
    buffer_load_dwordx4 v46, s[16:19], s58 offen lds
    v_lshlrev_b32 v20, 16, v76
    v_mfma_f32_32x32x16_bf16 v[128:143], a[156:159], a[124:127], v[128:143]
    s_waitcnt lgkmcnt(6)
    ds_read_b64_tr_b16 a[148:149], v5 offset:10304
    ds_read_b64_tr_b16 a[150:151], v5 offset:10816
    v_and_b32 v21, s69, v76
    v_lshlrev_b32 v58, 16, v69
    v_and_b32 v59, s69, v69
    v_lshlrev_b32 v22, 16, v77
    s_waitcnt vmcnt(19)
    v_mfma_f32_32x32x16_bf16 v[112:127], a[160:163], a[128:131], v[112:127]
    s_add_u32 m0, s44, 125312
    ds_read_b64_tr_b16 a[152:153], v5 offset:11264
    ds_read_b64_tr_b16 a[154:155], v5 offset:11776
    v_and_b32 v23, s69, v77
    v_lshlrev_b32 v60, 16, v70
    v_and_b32 v61, s69, v70
    v_lshlrev_b32 v24, 16, v78
    v_mfma_f32_32x32x16_bf16 v[128:143], a[164:167], a[128:131], v[128:143]
    s_waitcnt lgkmcnt(6)
    ds_read_b64_tr_b16 a[156:157], v5 offset:11328
    ds_read_b64_tr_b16 a[158:159], v5 offset:11840
    s_add_u32 s58, s50, 258048
    buffer_load_dwordx4 v46, s[16:19], s58 offen lds
    v_mfma_f32_32x32x16_bf16 v[112:127], a[168:171], a[132:135], v[112:127]
    s_add_u32 m0, s44, 127360
    ds_read_b64_tr_b16 a[160:161], v5 offset:12288
    ds_read_b64_tr_b16 a[162:163], v5 offset:12800
    v_and_b32 v25, s69, v78
    v_lshlrev_b32 v62, 16, v71
    v_and_b32 v63, s69, v71
    v_lshlrev_b32 v26, 16, v79
    v_mfma_f32_32x32x16_bf16 v[128:143], a[172:175], a[132:135], v[128:143]
    s_waitcnt lgkmcnt(6)
    ds_read_b64_tr_b16 a[164:165], v5 offset:12352
    ds_read_b64_tr_b16 a[166:167], v5 offset:12864
    v_and_b32 v27, s69, v79
    v_add_f32 v56, v56, v20
    v_add_f32 v57, v57, v21
    v_add_f32 v58, v58, v22
    s_waitcnt vmcnt(8)
    v_mfma_f32_32x32x16_bf16 v[112:127], a[144:147], a[136:139], v[112:127]
    ds_read_b64_tr_b16 a[168:169], v5 offset:13312
    ds_read_b64_tr_b16 a[170:171], v5 offset:13824
    buffer_load_dwordx4 v46, s[16:19], s52 offen lds
    v_add_f32 v59, v59, v23
    v_mfma_f32_32x32x16_bf16 v[128:143], a[148:151], a[136:139], v[128:143]
    s_waitcnt lgkmcnt(6)
    ds_read_b64_tr_b16 a[172:173], v5 offset:13376
    ds_read_b64_tr_b16 a[174:175], v5 offset:13888
    v_add_f32 v60, v60, v24
    v_add_f32 v61, v61, v25
    v_add_f32 v62, v62, v26
    v_add_f32 v63, v63, v27
    v_mfma_f32_32x32x16_bf16 v[112:127], a[152:155], a[140:143], v[112:127]
    ds_read_b64_tr_b16 a[144:145], v5 offset:14336
    ds_read_b64_tr_b16 a[146:147], v5 offset:14848
    v_mul_f32 v56, s59, v56
    v_mul_f32 v57, s59, v57
    v_mul_f32 v58, s59, v58
    v_mul_f32 v59, s59, v59
    v_mfma_f32_32x32x16_bf16 v[128:143], a[156:159], a[140:143], v[128:143]
    s_waitcnt lgkmcnt(6)
    ds_read_b64_tr_b16 a[148:149], v5 offset:14400
    ds_read_b64_tr_b16 a[150:151], v5 offset:14912
    v_mul_f32 v60, s59, v60
    v_mul_f32 v61, s59, v61
    v_mul_f32 v62, s59, v62
    v_mul_f32 v63, s59, v63
    v_mfma_f32_32x32x16_bf16 v[144:159], a[160:163], a[120:123], v[144:159]
    ds_read_b64_tr_b16 a[152:153], v5 offset:15360
    ds_read_b64_tr_b16 a[154:155], v5 offset:15872
    v_cvt_pk_bf16_f32 v28, v112, v113
    v_cvt_pk_bf16_f32 v29, v114, v115
    v_cvt_pk_bf16_f32 v30, v116, v117
    v_cvt_pk_bf16_f32 v31, v118, v119
    v_mfma_f32_32x32x16_bf16 v[160:175], a[164:167], a[120:123], v[160:175]
    s_waitcnt lgkmcnt(6)
    ds_read_b64_tr_b16 a[156:157], v5 offset:15424
    ds_read_b64_tr_b16 a[158:159], v5 offset:15936
    s_xor_b32 s63, s64, 2
    s_lshl_b32 s63, s63, 12
    s_add_u32 s63, s63, s47
    buffer_store_dwordx4 v[28:31], v2, s[20:23], s63 offen offset:0 sc1
    v_mfma_f32_32x32x16_bf16 v[144:159], a[168:171], a[124:127], v[144:159]
    ds_read_b64_tr_b16 a[160:161], v5 offset:16384
    ds_read_b64_tr_b16 a[162:163], v5 offset:16896
    v_cvt_pk_bf16_f32 v32, v120, v121
    v_cvt_pk_bf16_f32 v33, v122, v123
    v_cvt_pk_bf16_f32 v34, v124, v125
    v_cvt_pk_bf16_f32 v35, v126, v127
    v_mfma_f32_32x32x16_bf16 v[160:175], a[172:175], a[124:127], v[160:175]
    s_waitcnt lgkmcnt(6)
    ds_read_b64_tr_b16 a[164:165], v5 offset:16448
    ds_read_b64_tr_b16 a[166:167], v5 offset:16960
    v_cvt_pk_bf16_f32 v28, v128, v129
    v_cvt_pk_bf16_f32 v29, v130, v131
    v_cvt_pk_bf16_f32 v30, v132, v133
    v_cvt_pk_bf16_f32 v31, v134, v135
    v_mfma_f32_32x32x16_bf16 v[144:159], a[144:147], a[128:131], v[144:159]
    ds_read_b64_tr_b16 a[168:169], v5 offset:17408
    ds_read_b64_tr_b16 a[170:171], v5 offset:17920
    buffer_store_dwordx4 v[32:35], v2, s[20:23], s63 offen offset:1024 sc1
    v_mfma_f32_32x32x16_bf16 v[160:175], a[148:151], a[128:131], v[160:175]
    s_waitcnt lgkmcnt(6)
    ds_read_b64_tr_b16 a[172:173], v5 offset:17472
    ds_read_b64_tr_b16 a[174:175], v5 offset:17984
    v_cvt_pk_bf16_f32 v32, v136, v137
    v_cvt_pk_bf16_f32 v33, v138, v139
    v_cvt_pk_bf16_f32 v34, v140, v141
    v_cvt_pk_bf16_f32 v35, v142, v143
    v_mfma_f32_32x32x16_bf16 v[144:159], a[152:155], a[132:135], v[144:159]
    s_waitcnt vmcnt(13)
    s_barrier
    ds_read_b64_tr_b16 a[144:145], v8 offset:0
    ds_read_b64_tr_b16 a[146:147], v8 offset:512
    v_mfma_f32_32x32x16_bf16 v[160:175], a[156:159], a[132:135], v[160:175]
    s_waitcnt lgkmcnt(6)
    ds_read_b64_tr_b16 a[148:149], v8 offset:1024
    ds_read_b64_tr_b16 a[150:151], v8 offset:1536
    buffer_store_dwordx4 v[28:31], v2, s[20:23], s63 offen offset:2048 sc1
    v_mfma_f32_32x32x16_bf16 v[144:159], a[160:163], a[136:139], v[144:159]
    s_add_u32 m0, s44, 0
    ds_read_b64_tr_b16 a[152:153], v8 offset:2048
    ds_read_b64_tr_b16 a[154:155], v8 offset:2560
    s_add_u32 s58, s49, 0
    buffer_load_dwordx4 v47, s[16:19], s58 offen lds
    v_mfma_f32_32x32x16_bf16 v[160:175], a[164:167], a[136:139], v[160:175]
    s_waitcnt lgkmcnt(6)
    ds_read_b64_tr_b16 a[156:157], v8 offset:3072
    ds_read_b64_tr_b16 a[158:159], v8 offset:3584
    v_mfma_f32_32x32x16_bf16 v[144:159], a[168:171], a[140:143], v[144:159]
    s_add_u32 m0, s44, 2048
    ds_read_b64_tr_b16 a[160:161], v8 offset:4096
    ds_read_b64_tr_b16 a[162:163], v8 offset:4608
    buffer_store_dwordx4 v[32:35], v2, s[20:23], s63 offen offset:3072 sc1
    v_mfma_f32_32x32x16_bf16 v[160:175], a[172:175], a[140:143], v[160:175]
    s_waitcnt lgkmcnt(6)
    ds_read_b64_tr_b16 a[164:165], v8 offset:5120
    ds_read_b64_tr_b16 a[166:167], v8 offset:5632
    s_add_u32 s58, s49, 36864
    buffer_load_dwordx4 v47, s[16:19], s58 offen lds
    v_mfma_f32_32x32x16_bf16 v[208:223], a[144:147], a[0:3], 0
    s_add_u32 m0, s44, 4096
    ds_read_b64_tr_b16 a[168:169], v8 offset:6144
    ds_read_b64_tr_b16 a[170:171], v8 offset:6656
    v_cvt_pk_bf16_f32 v28, v144, v145
    v_cvt_pk_bf16_f32 v29, v146, v147
    v_cvt_pk_bf16_f32 v30, v148, v149
    v_cvt_pk_bf16_f32 v31, v150, v151
    v_mfma_f32_32x32x16_bf16 v[208:223], a[148:151], a[4:7], v[208:223]
    s_waitcnt lgkmcnt(6)
    ds_read_b64_tr_b16 a[172:173], v8 offset:7168
    ds_read_b64_tr_b16 a[174:175], v8 offset:7680
    s_xor_b32 s63, s64, 3
    s_lshl_b32 s63, s63, 12
    s_add_u32 s63, s63, s47
    buffer_store_dwordx4 v[28:31], v2, s[20:23], s63 offen offset:0 sc1
    v_mfma_f32_32x32x16_bf16 v[208:223], a[152:155], a[8:11], v[208:223]
    s_add_u32 s58, s49, 73728
    ds_read_b64_tr_b16 a[144:145], v8 offset:8192
    ds_read_b64_tr_b16 a[146:147], v8 offset:8704
    buffer_load_dwordx4 v47, s[16:19], s58 offen lds
    v_cvt_pk_bf16_f32 v32, v152, v153
    v_mfma_f32_32x32x16_bf16 v[208:223], a[156:159], a[12:15], v[208:223]
    s_waitcnt lgkmcnt(6)
    ds_read_b64_tr_b16 a[148:149], v8 offset:9216
    ds_read_b64_tr_b16 a[150:151], v8 offset:9728
    v_cvt_pk_bf16_f32 v33, v154, v155
    v_cvt_pk_bf16_f32 v34, v156, v157
    v_cvt_pk_bf16_f32 v35, v158, v159
    v_cvt_pk_bf16_f32 v28, v160, v161
    v_mfma_f32_32x32x16_bf16 v[208:223], a[160:163], a[16:19], v[208:223]
    s_add_u32 m0, s44, 6144
    ds_read_b64_tr_b16 a[152:153], v8 offset:10240
    ds_read_b64_tr_b16 a[154:155], v8 offset:10752
    buffer_store_dwordx4 v[32:35], v2, s[20:23], s63 offen offset:1024 sc1
    v_mfma_f32_32x32x16_bf16 v[208:223], a[164:167], a[20:23], v[208:223]
    s_waitcnt lgkmcnt(6)
    ds_read_b64_tr_b16 a[156:157], v8 offset:11264
    ds_read_b64_tr_b16 a[158:159], v8 offset:11776
    s_add_u32 s58, s49, 110592
    buffer_load_dwordx4 v47, s[16:19], s58 offen lds
    v_mfma_f32_32x32x16_bf16 v[208:223], a[168:171], a[24:27], v[208:223]
    s_add_u32 m0, s44, 8192
    ds_read_b64_tr_b16 a[160:161], v8 offset:12288
    ds_read_b64_tr_b16 a[162:163], v8 offset:12800
    v_cvt_pk_bf16_f32 v29, v162, v163
    v_cvt_pk_bf16_f32 v30, v164, v165
    v_cvt_pk_bf16_f32 v31, v166, v167
    v_cvt_pk_bf16_f32 v32, v168, v169
    v_mfma_f32_32x32x16_bf16 v[208:223], a[172:175], a[28:31], v[208:223]
    s_waitcnt lgkmcnt(6)
    ds_read_b64_tr_b16 a[164:165], v8 offset:13312
    ds_read_b64_tr_b16 a[166:167], v8 offset:13824
    buffer_store_dwordx4 v[28:31], v2, s[20:23], s63 offen offset:2048 sc1
    v_mfma_f32_32x32x16_bf16 v[208:223], a[144:147], a[32:35], v[208:223]
    s_add_u32 s58, s49, 147456
    ds_read_b64_tr_b16 a[168:169], v8 offset:14336
    ds_read_b64_tr_b16 a[170:171], v8 offset:14848
    buffer_load_dwordx4 v47, s[16:19], s58 offen lds
    v_cvt_pk_bf16_f32 v33, v170, v171
    v_mfma_f32_32x32x16_bf16 v[208:223], a[148:151], a[36:39], v[208:223]
    s_waitcnt lgkmcnt(6)
    ds_read_b64_tr_b16 a[172:173], v8 offset:15360
    ds_read_b64_tr_b16 a[174:175], v8 offset:15872
    v_cvt_pk_bf16_f32 v34, v172, v173
    v_cvt_pk_bf16_f32 v35, v174, v175
    v_mfma_f32_32x32x16_bf16 v[208:223], a[152:155], a[40:43], v[208:223]
    s_add_u32 m0, s44, 10240
    ds_read_b64_tr_b16 a[144:145], v8 offset:16384
    ds_read_b64_tr_b16 a[146:147], v8 offset:16896
    buffer_store_dwordx4 v[32:35], v2, s[20:23], s63 offen offset:3072 sc1
    v_mfma_f32_32x32x16_bf16 v[208:223], a[156:159], a[44:47], v[208:223]
    s_waitcnt lgkmcnt(6)
    ds_read_b64_tr_b16 a[148:149], v8 offset:17408
    ds_read_b64_tr_b16 a[150:151], v8 offset:17920
    s_add_u32 s58, s49, 184320
    buffer_load_dwordx4 v47, s[16:19], s58 offen lds
    v_mfma_f32_32x32x16_bf16 v[208:223], a[160:163], a[48:51], v[208:223]
    s_add_u32 m0, s44, 12288
    ds_read_b64_tr_b16 a[152:153], v8 offset:18432
    ds_read_b64_tr_b16 a[154:155], v8 offset:18944
    v_mfma_f32_32x32x16_bf16 v[208:223], a[164:167], a[52:55], v[208:223]
    s_waitcnt lgkmcnt(6)
    ds_read_b64_tr_b16 a[156:157], v8 offset:19456
    ds_read_b64_tr_b16 a[158:159], v8 offset:19968
    v_mfma_f32_32x32x16_bf16 v[208:223], a[168:171], a[56:59], v[208:223]
    s_add_u32 s58, s49, 221184
    ds_read_b64_tr_b16 a[160:161], v8 offset:20480
    ds_read_b64_tr_b16 a[162:163], v8 offset:20992
    buffer_load_dwordx4 v47, s[16:19], s58 offen lds
    v_mfma_f32_32x32x16_bf16 v[208:223], a[172:175], a[60:63], v[208:223]
    s_waitcnt lgkmcnt(6)
    ds_read_b64_tr_b16 a[164:165], v8 offset:21504
    ds_read_b64_tr_b16 a[166:167], v8 offset:22016
    v_mfma_f32_32x32x16_bf16 v[208:223], a[144:147], a[64:67], v[208:223]
    s_add_u32 m0, s44, 14336
    ds_read_b64_tr_b16 a[168:169], v8 offset:22528
    ds_read_b64_tr_b16 a[170:171], v8 offset:23040
    v_mfma_f32_32x32x16_bf16 v[208:223], a[148:151], a[68:71], v[208:223]
    s_waitcnt lgkmcnt(6)
    ds_read_b64_tr_b16 a[172:173], v8 offset:23552
    ds_read_b64_tr_b16 a[174:175], v8 offset:24064
    s_add_u32 s58, s49, 258048
    buffer_load_dwordx4 v47, s[16:19], s58 offen lds
    v_mfma_f32_32x32x16_bf16 v[208:223], a[152:155], a[72:75], v[208:223]
    s_add_u32 m0, s44, 16384
    ds_read_b64_tr_b16 a[144:145], v8 offset:24576
    ds_read_b64_tr_b16 a[146:147], v8 offset:25088
    v_mfma_f32_32x32x16_bf16 v[208:223], a[156:159], a[76:79], v[208:223]
    s_waitcnt lgkmcnt(6)
    ds_read_b64_tr_b16 a[148:149], v8 offset:25600
    ds_read_b64_tr_b16 a[150:151], v8 offset:26112
    v_mfma_f32_32x32x16_bf16 v[208:223], a[160:163], a[80:83], v[208:223]
    ds_read_b64_tr_b16 a[152:153], v8 offset:26624
    ds_read_b64_tr_b16 a[154:155], v8 offset:27136
    buffer_load_dwordx4 v47, s[16:19], s51 offen lds
    v_mfma_f32_32x32x16_bf16 v[208:223], a[164:167], a[84:87], v[208:223]
    s_waitcnt lgkmcnt(6)
    ds_read_b64_tr_b16 a[156:157], v8 offset:27648
    ds_read_b64_tr_b16 a[158:159], v8 offset:28160
    v_mfma_f32_32x32x16_bf16 v[208:223], a[168:171], a[88:91], v[208:223]
    ds_read_b64_tr_b16 a[160:161], v8 offset:28672
    ds_read_b64_tr_b16 a[162:163], v8 offset:29184
    v_mfma_f32_32x32x16_bf16 v[208:223], a[172:175], a[92:95], v[208:223]
    s_waitcnt lgkmcnt(6)
    ds_read_b64_tr_b16 a[164:165], v8 offset:29696
    ds_read_b64_tr_b16 a[166:167], v8 offset:30208
    v_mfma_f32_32x32x16_bf16 v[208:223], a[144:147], a[96:99], v[208:223]
    ds_read_b64_tr_b16 a[168:169], v8 offset:30720
    ds_read_b64_tr_b16 a[170:171], v8 offset:31232
    v_mfma_f32_32x32x16_bf16 v[208:223], a[148:151], a[100:103], v[208:223]
    s_waitcnt lgkmcnt(6)
    ds_read_b64_tr_b16 a[172:173], v8 offset:31744
    ds_read_b64_tr_b16 a[174:175], v8 offset:32256
    v_mfma_f32_32x32x16_bf16 v[208:223], a[152:155], a[104:107], v[208:223]
    ds_read_b64_tr_b16 a[144:145], v8 offset:32768
    ds_read_b64_tr_b16 a[146:147], v8 offset:33280
    v_mfma_f32_32x32x16_bf16 v[208:223], a[156:159], a[108:111], v[208:223]
    s_waitcnt lgkmcnt(6)
    ds_read_b64_tr_b16 a[148:149], v8 offset:33792
    ds_read_b64_tr_b16 a[150:151], v8 offset:34304
    v_mfma_f32_32x32x16_bf16 v[208:223], a[160:163], a[112:115], v[208:223]
    ds_read_b64_tr_b16 a[152:153], v8 offset:34816
    ds_read_b64_tr_b16 a[154:155], v8 offset:35328
    v_mfma_f32_32x32x16_bf16 v[208:223], a[164:167], a[116:119], v[208:223]
    s_waitcnt lgkmcnt(6)
    ds_read_b64_tr_b16 a[156:157], v8 offset:35840
    ds_read_b64_tr_b16 a[158:159], v8 offset:36352
    v_mfma_f32_32x32x16_bf16 v[208:223], a[168:171], a[120:123], v[208:223]
    s_waitcnt vmcnt(17)
    s_barrier
    ds_read_b64_tr_b16 a[160:161], v7 offset:0
    ds_read_b64_tr_b16 a[162:163], v7 offset:512
    v_mfma_f32_32x32x16_bf16 v[208:223], a[172:175], a[124:127], v[208:223]
    s_waitcnt lgkmcnt(6)
    ds_read_b64_tr_b16 a[164:165], v7 offset:64
    ds_read_b64_tr_b16 a[166:167], v7 offset:576
    v_mfma_f32_32x32x16_bf16 v[208:223], a[144:147], a[128:131], v[208:223]
    s_add_u32 m0, s44, 36992
    ds_read_b64_tr_b16 a[168:169], v7 offset:1024
    ds_read_b64_tr_b16 a[170:171], v7 offset:1536
    s_add_u32 s58, s50, 0
    buffer_load_dwordx4 v47, s[16:19], s58 offen lds
    v_mfma_f32_32x32x16_bf16 v[208:223], a[148:151], a[132:135], v[208:223]
    s_waitcnt lgkmcnt(6)
    ds_read_b64_tr_b16 a[172:173], v7 offset:1088
    ds_read_b64_tr_b16 a[174:175], v7 offset:1600
    v_mfma_f32_32x32x16_bf16 v[208:223], a[152:155], a[136:139], v[208:223]
    s_add_u32 m0, s44, 39040
    ds_read_b64_tr_b16 a[144:145], v7 offset:2048
    ds_read_b64_tr_b16 a[146:147], v7 offset:2560
    v_mfma_f32_32x32x16_bf16 v[208:223], a[156:159], a[140:143], v[208:223]
    s_waitcnt lgkmcnt(6)
    ds_read_b64_tr_b16 a[148:149], v7 offset:2112
    ds_read_b64_tr_b16 a[150:151], v7 offset:2624
    s_add_u32 s58, s50, 36864
    buffer_load_dwordx4 v47, s[16:19], s58 offen lds
    v_mfma_f32_32x32x16_bf16 v[176:191], a[160:163], a[72:75], v[176:191]
    s_add_u32 m0, s44, 41088
    ds_read_b64_tr_b16 a[152:153], v7 offset:3072
    ds_read_b64_tr_b16 a[154:155], v7 offset:3584
    s_waitcnt vmcnt(14)
    s_xor_b32 s3, s64, 2
    s_lshl_b32 s3, s3, 8
    s_add_u32 s3, s3, s57
    s_mov_b64 exec, 3
    buffer_store_dword v37, v85, s[20:23], s3 offen sc1
    s_mov_b64 exec, -1
    v_mfma_f32_32x32x16_bf16 v[192:207], a[164:167], a[72:75], v[192:207]
    s_waitcnt lgkmcnt(6)
    ds_read_b64_tr_b16 a[156:157], v7 offset:3136
    ds_read_b64_tr_b16 a[158:159], v7 offset:3648
    v_cvt_pk_bf16_f32 v28, v208, v209
    v_cvt_pk_bf16_f32 v29, v210, v211
    v_cvt_pk_bf16_f32 v30, v212, v213
    v_cvt_pk_bf16_f32 v31, v214, v215
    v_mfma_f32_32x32x16_bf16 v[176:191], a[168:171], a[76:79], v[176:191]
    s_add_u32 s58, s50, 73728
    ds_read_b64_tr_b16 a[160:161], v7 offset:4096
    ds_read_b64_tr_b16 a[162:163], v7 offset:4608
    buffer_load_dwordx4 v47, s[16:19], s58 offen lds
    v_cvt_pk_bf16_f32 v32, v216, v217
    v_mfma_f32_32x32x16_bf16 v[192:207], a[172:175], a[76:79], v[192:207]
    s_waitcnt lgkmcnt(6)
    ds_read_b64_tr_b16 a[164:165], v7 offset:4160
    ds_read_b64_tr_b16 a[166:167], v7 offset:4672
    s_mul_i32 s63, s41, 4294948864
    s_add_u32 s63, s63, s47
    s_add_u32 s63, s63, 16384
    buffer_store_dwordx4 v[28:31], v2, s[20:23], s63 offen offset:0 sc1
    v_mfma_f32_32x32x16_bf16 v[176:191], a[144:147], a[80:83], v[176:191]
    s_add_u32 m0, s44, 43136
    ds_read_b64_tr_b16 a[168:169], v7 offset:5120
    ds_read_b64_tr_b16 a[170:171], v7 offset:5632
    v_cvt_pk_bf16_f32 v33, v218, v219
    v_cvt_pk_bf16_f32 v34, v220, v221
    v_cvt_pk_bf16_f32 v35, v222, v223
    v_mfma_f32_32x32x16_bf16 v[192:207], a[148:151], a[80:83], v[192:207]
    s_waitcnt lgkmcnt(6)
    ds_read_b64_tr_b16 a[172:173], v7 offset:5184
    ds_read_b64_tr_b16 a[174:175], v7 offset:5696
    s_add_u32 s58, s50, 110592
    buffer_load_dwordx4 v47, s[16:19], s58 offen lds
    v_mfma_f32_32x32x16_bf16 v[176:191], a[152:155], a[84:87], v[176:191]
    s_add_u32 m0, s44, 45184
    ds_read_b64_tr_b16 a[144:145], v7 offset:6144
    ds_read_b64_tr_b16 a[146:147], v7 offset:6656
    buffer_store_dwordx4 v[32:35], v2, s[20:23], s63 offen offset:1024 sc1
    v_mfma_f32_32x32x16_bf16 v[192:207], a[156:159], a[84:87], v[192:207]
    s_waitcnt lgkmcnt(6)
    ds_read_b64_tr_b16 a[148:149], v7 offset:6208
    ds_read_b64_tr_b16 a[150:151], v7 offset:6720
    v_mfma_f32_32x32x16_bf16 v[176:191], a[160:163], a[88:91], v[176:191]
    s_add_u32 s58, s50, 147456
    ds_read_b64_tr_b16 a[152:153], v7 offset:7168
    ds_read_b64_tr_b16 a[154:155], v7 offset:7680
    buffer_load_dwordx4 v47, s[16:19], s58 offen lds
    v_mfma_f32_32x32x16_bf16 v[192:207], a[164:167], a[88:91], v[192:207]
    s_waitcnt lgkmcnt(6)
    ds_read_b64_tr_b16 a[156:157], v7 offset:7232
    ds_read_b64_tr_b16 a[158:159], v7 offset:7744
    v_mfma_f32_32x32x16_bf16 v[176:191], a[168:171], a[92:95], v[176:191]
    s_add_u32 m0, s44, 47232
    ds_read_b64_tr_b16 a[160:161], v7 offset:8192
    ds_read_b64_tr_b16 a[162:163], v7 offset:8704
    v_mfma_f32_32x32x16_bf16 v[192:207], a[172:175], a[92:95], v[192:207]
    s_waitcnt lgkmcnt(6)
    ds_read_b64_tr_b16 a[164:165], v7 offset:8256
    ds_read_b64_tr_b16 a[166:167], v7 offset:8768
    s_add_u32 s58, s50, 184320
    buffer_load_dwordx4 v47, s[16:19], s58 offen lds
    v_mfma_f32_32x32x16_bf16 v[176:191], a[144:147], a[96:99], v[176:191]
    s_add_u32 m0, s44, 49280
    ds_read_b64_tr_b16 a[168:169], v7 offset:9216
    ds_read_b64_tr_b16 a[170:171], v7 offset:9728
    s_waitcnt vmcnt(13)
    s_xor_b32 s3, s64, 3
    s_lshl_b32 s3, s3, 8
    s_add_u32 s3, s3, s57
    s_mov_b64 exec, 3
    buffer_store_dword v37, v85, s[20:23], s3 offen sc1
    s_mov_b64 exec, -1
    v_mfma_f32_32x32x16_bf16 v[192:207], a[148:151], a[96:99], v[192:207]
    s_waitcnt lgkmcnt(6)
    ds_read_b64_tr_b16 a[172:173], v7 offset:9280
    ds_read_b64_tr_b16 a[174:175], v7 offset:9792
    v_mfma_f32_32x32x16_bf16 v[176:191], a[152:155], a[100:103], v[176:191]
    s_add_u32 s58, s50, 221184
    ds_read_b64_tr_b16 a[144:145], v7 offset:10240
    ds_read_b64_tr_b16 a[146:147], v7 offset:10752
    buffer_load_dwordx4 v47, s[16:19], s58 offen lds
    v_mfma_f32_32x32x16_bf16 v[192:207], a[156:159], a[100:103], v[192:207]
    s_waitcnt lgkmcnt(6)
    ds_read_b64_tr_b16 a[148:149], v7 offset:10304
    ds_read_b64_tr_b16 a[150:151], v7 offset:10816
    v_mfma_f32_32x32x16_bf16 v[176:191], a[160:163], a[104:107], v[176:191]
    s_add_u32 m0, s44, 51328
    ds_read_b64_tr_b16 a[152:153], v7 offset:11264
    ds_read_b64_tr_b16 a[154:155], v7 offset:11776
    v_mfma_f32_32x32x16_bf16 v[192:207], a[164:167], a[104:107], v[192:207]
    s_waitcnt lgkmcnt(6)
    ds_read_b64_tr_b16 a[156:157], v7 offset:11328
    ds_read_b64_tr_b16 a[158:159], v7 offset:11840
    s_add_u32 s58, s50, 258048
    buffer_load_dwordx4 v47, s[16:19], s58 offen lds
    v_mfma_f32_32x32x16_bf16 v[176:191], a[168:171], a[108:111], v[176:191]
    s_add_u32 m0, s44, 53376
    ds_read_b64_tr_b16 a[160:161], v7 offset:12288
    ds_read_b64_tr_b16 a[162:163], v7 offset:12800
    v_mfma_f32_32x32x16_bf16 v[192:207], a[172:175], a[108:111], v[192:207]
    s_waitcnt lgkmcnt(6)
    ds_read_b64_tr_b16 a[164:165], v7 offset:12352
    ds_read_b64_tr_b16 a[166:167], v7 offset:12864
    v_mfma_f32_32x32x16_bf16 v[176:191], a[144:147], a[112:115], v[176:191]
    ds_read_b64_tr_b16 a[168:169], v7 offset:13312
    ds_read_b64_tr_b16 a[170:171], v7 offset:13824
    buffer_load_dwordx4 v47, s[16:19], s52 offen lds
    v_mfma_f32_32x32x16_bf16 v[192:207], a[148:151], a[112:115], v[192:207]
    s_waitcnt lgkmcnt(6)
    ds_read_b64_tr_b16 a[172:173], v7 offset:13376
    ds_read_b64_tr_b16 a[174:175], v7 offset:13888
    v_mfma_f32_32x32x16_bf16 v[176:191], a[152:155], a[116:119], v[176:191]
    ds_read_b64_tr_b16 a[144:145], v7 offset:14336
    ds_read_b64_tr_b16 a[146:147], v7 offset:14848
    v_mfma_f32_32x32x16_bf16 v[192:207], a[156:159], a[116:119], v[192:207]
    s_waitcnt lgkmcnt(6)
    ds_read_b64_tr_b16 a[148:149], v7 offset:14400
    ds_read_b64_tr_b16 a[150:151], v7 offset:14912
    v_mfma_f32_32x32x16_bf16 v[176:191], a[160:163], a[120:123], v[176:191]
    ds_read_b64_tr_b16 a[152:153], v7 offset:15360
    ds_read_b64_tr_b16 a[154:155], v7 offset:15872
    v_mfma_f32_32x32x16_bf16 v[192:207], a[164:167], a[120:123], v[192:207]
    s_waitcnt lgkmcnt(6)
    ds_read_b64_tr_b16 a[156:157], v7 offset:15424
    ds_read_b64_tr_b16 a[158:159], v7 offset:15936
    v_mfma_f32_32x32x16_bf16 v[176:191], a[168:171], a[124:127], v[176:191]
    ds_read_b64_tr_b16 a[160:161], v7 offset:16384
    ds_read_b64_tr_b16 a[162:163], v7 offset:16896
    v_mfma_f32_32x32x16_bf16 v[192:207], a[172:175], a[124:127], v[192:207]
    s_waitcnt lgkmcnt(6)
    ds_read_b64_tr_b16 a[164:165], v7 offset:16448
    ds_read_b64_tr_b16 a[166:167], v7 offset:16960
    v_mfma_f32_32x32x16_bf16 v[176:191], a[144:147], a[128:131], v[176:191]
    ds_read_b64_tr_b16 a[168:169], v7 offset:17408
    ds_read_b64_tr_b16 a[170:171], v7 offset:17920
    v_mfma_f32_32x32x16_bf16 v[192:207], a[148:151], a[128:131], v[192:207]
    s_waitcnt lgkmcnt(6)
    ds_read_b64_tr_b16 a[172:173], v7 offset:17472
    ds_read_b64_tr_b16 a[174:175], v7 offset:17984
    v_mfma_f32_32x32x16_bf16 v[176:191], a[152:155], a[132:135], v[176:191]
    s_waitcnt vmcnt(13)
    s_barrier
    ds_read_b64_tr_b16 a[144:145], v38 offset:0
    ds_read_b64_tr_b16 a[146:147], v38 offset:512
    v_mfma_f32_32x32x16_bf16 v[192:207], a[156:159], a[132:135], v[192:207]
    s_waitcnt lgkmcnt(6)
    ds_read_b64_tr_b16 a[148:149], v38 offset:1024
    ds_read_b64_tr_b16 a[150:151], v38 offset:1536
    v_mfma_f32_32x32x16_bf16 v[176:191], a[160:163], a[136:139], v[176:191]
    ds_read_b64_tr_b16 a[152:153], v38 offset:2048
    ds_read_b64_tr_b16 a[154:155], v38 offset:2560
    v_mfma_f32_32x32x16_bf16 v[192:207], a[164:167], a[136:139], v[192:207]
    s_waitcnt lgkmcnt(6)
    ds_read_b64_tr_b16 a[156:157], v38 offset:3072
    ds_read_b64_tr_b16 a[158:159], v38 offset:3584
    v_mfma_f32_32x32x16_bf16 v[176:191], a[168:171], a[140:143], v[176:191]
    ds_read_b64_tr_b16 a[160:161], v38 offset:4096
    ds_read_b64_tr_b16 a[162:163], v38 offset:4608
    s_waitcnt vmcnt(6)
    s_add_u32 s3, s57, 32
    s_mov_b64 exec, 0xff
    buffer_store_dword v37, v85, s[20:23], s3 offen sc1
    s_mov_b64 exec, -1
    v_mfma_f32_32x32x16_bf16 v[192:207], a[172:175], a[140:143], v[192:207]
    s_waitcnt lgkmcnt(6)
    ds_read_b64_tr_b16 a[164:165], v38 offset:5120
    ds_read_b64_tr_b16 a[166:167], v38 offset:5632
    v_mfma_f32_32x32x16_bf16 v[112:127], a[144:147], a[0:3], 0
    ds_read_b64_tr_b16 a[168:169], v38 offset:6144
    ds_read_b64_tr_b16 a[170:171], v38 offset:6656
    v_cvt_pk_bf16_f32 v28, v176, v177
    v_cvt_pk_bf16_f32 v29, v178, v179
    v_cvt_pk_bf16_f32 v30, v180, v181
    v_cvt_pk_bf16_f32 v31, v182, v183
    v_mfma_f32_32x32x16_bf16 v[112:127], a[148:151], a[4:7], v[112:127]
    s_waitcnt lgkmcnt(6)
    ds_read_b64_tr_b16 a[172:173], v38 offset:7168
    ds_read_b64_tr_b16 a[174:175], v38 offset:7680
    s_add_u32 s63, s68, 12288
    s_cmp_lg_u32 s37, 0
    s_cbranch_scc1 M_V0
    buffer_store_dwordx4 v[28:31], v2, s[20:23], s63 offen offset:0 nt
M_W0:
    v_mfma_f32_32x32x16_bf16 v[112:127], a[152:155], a[8:11], v[112:127]
    ds_read_b64_tr_b16 a[144:145], v38 offset:8192
    ds_read_b64_tr_b16 a[146:147], v38 offset:8704
    v_cvt_pk_bf16_f32 v32, v184, v185
    v_cvt_pk_bf16_f32 v33, v186, v187
    v_cvt_pk_bf16_f32 v34, v188, v189
    v_cvt_pk_bf16_f32 v35, v190, v191
    v_mfma_f32_32x32x16_bf16 v[112:127], a[156:159], a[12:15], v[112:127]
    s_waitcnt lgkmcnt(6)
    ds_read_b64_tr_b16 a[148:149], v38 offset:9216
    ds_read_b64_tr_b16 a[150:151], v38 offset:9728
    s_cmp_lg_u32 s37, 0
    s_cbranch_scc1 M_V1
    buffer_store_dwordx4 v[32:35], v2, s[20:23], s63 offen offset:1024 nt
M_W1:
    v_mfma_f32_32x32x16_bf16 v[112:127], a[160:163], a[16:19], v[112:127]
    ds_read_b64_tr_b16 a[152:153], v38 offset:10240
    ds_read_b64_tr_b16 a[154:155], v38 offset:10752
    v_cvt_pk_bf16_f32 v28, v192, v193
    v_cvt_pk_bf16_f32 v29, v194, v195
    v_cvt_pk_bf16_f32 v30, v196, v197
    v_cvt_pk_bf16_f32 v31, v198, v199
    v_mfma_f32_32x32x16_bf16 v[112:127], a[164:167], a[20:23], v[112:127]
    s_waitcnt lgkmcnt(6)
    ds_read_b64_tr_b16 a[156:157], v38 offset:11264
    ds_read_b64_tr_b16 a[158:159], v38 offset:11776
    s_cmp_lg_u32 s37, 0
    s_cbranch_scc1 M_V2
    buffer_store_dwordx4 v[28:31], v2, s[20:23], s63 offen offset:2048 nt
M_W2:
    v_mfma_f32_32x32x16_bf16 v[112:127], a[168:171], a[24:27], v[112:127]
    ds_read_b64_tr_b16 a[160:161], v38 offset:12288
    ds_read_b64_tr_b16 a[162:163], v38 offset:12800
    v_cvt_pk_bf16_f32 v32, v200, v201
    v_cvt_pk_bf16_f32 v33, v202, v203
    v_cvt_pk_bf16_f32 v34, v204, v205
    v_cvt_pk_bf16_f32 v35, v206, v207
    v_mfma_f32_32x32x16_bf16 v[112:127], a[172:175], a[28:31], v[112:127]
    s_waitcnt lgkmcnt(6)
    ds_read_b64_tr_b16 a[164:165], v38 offset:13312
    ds_read_b64_tr_b16 a[166:167], v38 offset:13824
    s_cmp_lg_u32 s37, 0
    s_cbranch_scc1 M_V3
    buffer_store_dwordx4 v[32:35], v2, s[20:23], s63 offen offset:3072 nt
M_W3:
    v_mfma_f32_32x32x16_bf16 v[112:127], a[144:147], a[32:35], v[112:127]
    ds_read_b64_tr_b16 a[168:169], v38 offset:14336
    ds_read_b64_tr_b16 a[170:171], v38 offset:14848
    v_mfma_f32_32x32x16_bf16 v[112:127], a[148:151], a[36:39], v[112:127]
    s_waitcnt lgkmcnt(6)
    ds_read_b64_tr_b16 a[172:173], v38 offset:15360
    ds_read_b64_tr_b16 a[174:175], v38 offset:15872
    v_mfma_f32_32x32x16_bf16 v[112:127], a[152:155], a[40:43], v[112:127]
    ds_read_b64_tr_b16 a[144:145], v38 offset:16384
    ds_read_b64_tr_b16 a[146:147], v38 offset:16896
    buffer_load_dword v36, v14, s[20:23], s65 offen sc1
    v_mfma_f32_32x32x16_bf16 v[112:127], a[156:159], a[44:47], v[112:127]
    s_waitcnt lgkmcnt(6)
    ds_read_b64_tr_b16 a[148:149], v38 offset:17408
    ds_read_b64_tr_b16 a[150:151], v38 offset:17920
    v_mfma_f32_32x32x16_bf16 v[112:127], a[160:163], a[48:51], v[112:127]
    s_waitcnt vmcnt(6)
    s_barrier
    ds_read_b64_tr_b16 a[152:153], v39 offset:0
    ds_read_b64_tr_b16 a[154:155], v39 offset:512
    v_mfma_f32_32x32x16_bf16 v[112:127], a[164:167], a[52:55], v[112:127]
    s_waitcnt lgkmcnt(6)
    ds_read_b64_tr_b16 a[156:157], v39 offset:1024
    ds_read_b64_tr_b16 a[158:159], v39 offset:1536
    v_mfma_f32_32x32x16_bf16 v[112:127], a[168:171], a[56:59], v[112:127]
    ds_read_b64_tr_b16 a[160:161], v39 offset:2048
    ds_read_b64_tr_b16 a[162:163], v39 offset:2560
    v_mfma_f32_32x32x16_bf16 v[112:127], a[172:175], a[60:63], v[112:127]
    s_waitcnt lgkmcnt(6)
    ds_read_b64_tr_b16 a[164:165], v39 offset:3072
    ds_read_b64_tr_b16 a[166:167], v39 offset:3584
    v_mfma_f32_32x32x16_bf16 v[112:127], a[144:147], a[64:67], v[112:127]
    ds_read_b64_tr_b16 a[168:169], v39 offset:4096
    ds_read_b64_tr_b16 a[170:171], v39 offset:4608
    v_mfma_f32_32x32x16_bf16 v[112:127], a[148:151], a[68:71], v[112:127]
    s_waitcnt lgkmcnt(6)
    ds_read_b64_tr_b16 a[172:173], v39 offset:5120
    ds_read_b64_tr_b16 a[174:175], v39 offset:5632
    v_mfma_f32_32x32x16_bf16 v[112:127], a[152:155], a[72:75], v[112:127]
    ds_read_b64_tr_b16 a[144:145], v39 offset:6144
    ds_read_b64_tr_b16 a[146:147], v39 offset:6656
    v_mfma_f32_32x32x16_bf16 v[112:127], a[156:159], a[76:79], v[112:127]
    s_waitcnt lgkmcnt(6)
    ds_read_b64_tr_b16 a[148:149], v39 offset:7168
    ds_read_b64_tr_b16 a[150:151], v39 offset:7680
    v_mfma_f32_32x32x16_bf16 v[112:127], a[160:163], a[80:83], v[112:127]
    ds_read_b64_tr_b16 a[152:153], v39 offset:8192
    ds_read_b64_tr_b16 a[154:155], v39 offset:8704
    v_mfma_f32_32x32x16_bf16 v[112:127], a[164:167], a[84:87], v[112:127]
    s_waitcnt lgkmcnt(6)
    ds_read_b64_tr_b16 a[156:157], v39 offset:9216
    ds_read_b64_tr_b16 a[158:159], v39 offset:9728
    v_mfma_f32_32x32x16_bf16 v[112:127], a[168:171], a[88:91], v[112:127]
    ds_read_b64_tr_b16 a[160:161], v39 offset:10240
    ds_read_b64_tr_b16 a[162:163], v39 offset:10752
    v_mfma_f32_32x32x16_bf16 v[112:127], a[172:175], a[92:95], v[112:127]
    s_waitcnt lgkmcnt(6)
    ds_read_b64_tr_b16 a[164:165], v39 offset:11264
    ds_read_b64_tr_b16 a[166:167], v39 offset:11776
    v_mfma_f32_32x32x16_bf16 v[112:127], a[144:147], a[96:99], v[112:127]
    ds_read_b64_tr_b16 a[168:169], v39 offset:12288
    ds_read_b64_tr_b16 a[170:171], v39 offset:12800
    v_mfma_f32_32x32x16_bf16 v[112:127], a[148:151], a[100:103], v[112:127]
    s_waitcnt lgkmcnt(6)
    ds_read_b64_tr_b16 a[172:173], v39 offset:13312
    ds_read_b64_tr_b16 a[174:175], v39 offset:13824
    v_mfma_f32_32x32x16_bf16 v[112:127], a[152:155], a[104:107], v[112:127]
    ds_read_b64_tr_b16 a[144:145], v39 offset:14336
    ds_read_b64_tr_b16 a[146:147], v39 offset:14848
    v_mfma_f32_32x32x16_bf16 v[112:127], a[156:159], a[108:111], v[112:127]
    s_waitcnt lgkmcnt(6)
    ds_read_b64_tr_b16 a[148:149], v39 offset:15360
    ds_read_b64_tr_b16 a[150:151], v39 offset:15872
    v_mfma_f32_32x32x16_bf16 v[112:127], a[160:163], a[112:115], v[112:127]
    ds_read_b64_tr_b16 a[152:153], v39 offset:16384
    ds_read_b64_tr_b16 a[154:155], v39 offset:16896
    v_mfma_f32_32x32x16_bf16 v[112:127], a[164:167], a[116:119], v[112:127]
    s_waitcnt lgkmcnt(6)
    ds_read_b64_tr_b16 a[156:157], v39 offset:17408
    ds_read_b64_tr_b16 a[158:159], v39 offset:17920
    v_mfma_f32_32x32x16_bf16 v[112:127], a[168:171], a[120:123], v[112:127]
    ds_read_b64_tr_b16 a[160:161], v40 offset:0
    ds_read_b64_tr_b16 a[162:163], v40 offset:512
    s_waitcnt vmcnt(1)
    s_add_u32 s3, s68, 11264
    s_mov_b64 exec, 1
    s_cmp_lg_u32 s37, 0
    s_cbranch_scc1 M_V4
    buffer_store_dword v37, v19, s[20:23], s3 offen nt
M_W4:
    s_mov_b64 exec, -1
    v_mfma_f32_32x32x16_bf16 v[112:127], a[172:175], a[124:127], v[112:127]
    s_waitcnt lgkmcnt(6)
    ds_read_b64_tr_b16 a[164:165], v40 offset:1024
    ds_read_b64_tr_b16 a[166:167], v40 offset:1536
    v_mfma_f32_32x32x16_bf16 v[112:127], a[144:147], a[128:131], v[112:127]
    ds_read_b64_tr_b16 a[168:169], v40 offset:2048
    ds_read_b64_tr_b16 a[170:171], v40 offset:2560
    v_mfma_f32_32x32x16_bf16 v[112:127], a[148:151], a[132:135], v[112:127]
    s_waitcnt lgkmcnt(6)
    ds_read_b64_tr_b16 a[172:173], v40 offset:3072
    ds_read_b64_tr_b16 a[174:175], v40 offset:3584
    v_mfma_f32_32x32x16_bf16 v[112:127], a[152:155], a[136:139], v[112:127]
    ds_read_b64_tr_b16 a[144:145], v40 offset:4096
    ds_read_b64_tr_b16 a[146:147], v40 offset:4608
    v_mfma_f32_32x32x16_bf16 v[112:127], a[156:159], a[140:143], v[112:127]
    s_waitcnt lgkmcnt(6)
    ds_read_b64_tr_b16 a[148:149], v40 offset:5120
    ds_read_b64_tr_b16 a[150:151], v40 offset:5632
    v_mfma_f32_32x32x16_bf16 v[128:143], a[160:163], a[0:3], 0
    ds_read_b64_tr_b16 a[152:153], v40 offset:6144
    ds_read_b64_tr_b16 a[154:155], v40 offset:6656
    v_mfma_f32_32x32x16_bf16 v[128:143], a[164:167], a[4:7], v[128:143]
    s_waitcnt lgkmcnt(6)
    ds_read_b64_tr_b16 a[156:157], v40 offset:7168
    ds_read_b64_tr_b16 a[158:159], v40 offset:7680
    s_nop 1
    v_cvt_pk_bf16_f32 v28, v112, v113
    v_cvt_pk_bf16_f32 v29, v114, v115
    v_cvt_pk_bf16_f32 v30, v116, v117
    v_cvt_pk_bf16_f32 v31, v118, v119
    v_mfma_f32_32x32x16_bf16 v[128:143], a[168:171], a[8:11], v[128:143]
    ds_read_b64_tr_b16 a[160:161], v40 offset:8192
    ds_read_b64_tr_b16 a[162:163], v40 offset:8704
    s_add_u32 s63, s68, 16384
    s_cmp_lg_u32 s37, 0
    s_cbranch_scc1 M_V5
    buffer_store_dwordx4 v[28:31], v2, s[20:23], s63 offen offset:0 nt
M_W5:
    v_mfma_f32_32x32x16_bf16 v[128:143], a[172:175], a[12:15], v[128:143]
    s_waitcnt lgkmcnt(6)
    ds_read_b64_tr_b16 a[164:165], v40 offset:9216
    ds_read_b64_tr_b16 a[166:167], v40 offset:9728
    v_cvt_pk_bf16_f32 v32, v120, v121
    v_cvt_pk_bf16_f32 v33, v122, v123
    v_cvt_pk_bf16_f32 v34, v124, v125
    v_cvt_pk_bf16_f32 v35, v126, v127
    v_mfma_f32_32x32x16_bf16 v[128:143], a[144:147], a[16:19], v[128:143]
    ds_read_b64_tr_b16 a[168:169], v40 offset:10240
    ds_read_b64_tr_b16 a[170:171], v40 offset:10752
    s_cmp_lg_u32 s37, 0
    s_cbranch_scc1 M_V6
    buffer_store_dwordx4 v[32:35], v2, s[20:23], s63 offen offset:1024 nt
M_W6:
    v_mfma_f32_32x32x16_bf16 v[128:143], a[148:151], a[20:23], v[128:143]
    s_waitcnt lgkmcnt(6)
    ds_read_b64_tr_b16 a[172:173], v40 offset:11264
    ds_read_b64_tr_b16 a[174:175], v40 offset:11776
    s_waitcnt vmcnt(3)
    v_cmp_ge_u32 s[70:71], 2, v18
    v_cmp_ne_u32 vcc, s2, v36
    s_nop 0
    s_and_b64 vcc, vcc, s[70:71]
    s_cbranch_scc1 M_SPF2
M_SRF2:
    v_mfma_f32_32x32x16_bf16 v[128:143], a[152:155], a[24:27], v[128:143]
    ds_read_b64_tr_b16 a[144:145], v40 offset:12288
    ds_read_b64_tr_b16 a[146:147], v40 offset:12800
    s_mul_i32 s72, s39, 2359296
    s_sub_u32 s72, s68, s72
    buffer_load_dword v84, v86, s[20:23], s72 offen sc1
    v_mfma_f32_32x32x16_bf16 v[128:143], a[156:159], a[28:31], v[128:143]
    s_waitcnt lgkmcnt(6)
    ds_read_b64_tr_b16 a[148:149], v40 offset:13312
    ds_read_b64_tr_b16 a[150:151], v40 offset:13824
    buffer_load_dword v36, v14, s[20:23], s65 offen sc1
    v_mfma_f32_32x32x16_bf16 v[128:143], a[160:163], a[32:35], v[128:143]
    ds_read_b64_tr_b16 a[152:153], v40 offset:14336
    ds_read_b64_tr_b16 a[154:155], v40 offset:14848
    s_xor_b32 s3, s64, 2
    s_lshl_b32 s3, s3, 1
    s_mul_i32 s3, s3, 2359296
    s_add_u32 s70, s3, s66
    buffer_load_dwordx4 v[224:227], v2, s[20:23], s70 offen offset:0 sc1
    buffer_load_dwordx4 v[228:231], v2, s[20:23], s70 offen offset:1024 sc1
    v_mfma_f32_32x32x16_bf16 v[128:143], a[164:167], a[36:39], v[128:143]
    s_waitcnt lgkmcnt(6)
    ds_read_b64_tr_b16 a[156:157], v40 offset:15360
    ds_read_b64_tr_b16 a[158:159], v40 offset:15872
    v_mfma_f32_32x32x16_bf16 v[128:143], a[168:171], a[40:43], v[128:143]
    ds_read_b64_tr_b16 a[160:161], v40 offset:16384
    ds_read_b64_tr_b16 a[162:163], v40 offset:16896
    s_xor_b32 s3, s64, 2
    s_lshl_b32 s3, s3, 1
    s_add_u32 s3, s3, 1
    s_mul_i32 s3, s3, 2359296
    s_add_u32 s70, s3, s66
    buffer_load_dwordx4 v[232:235], v2, s[20:23], s70 offen offset:0 sc1
    buffer_load_dwordx4 v[236:239], v2, s[20:23], s70 offen offset:1024 sc1
    v_mfma_f32_32x32x16_bf16 v[128:143], a[172:175], a[44:47], v[128:143]
    s_waitcnt lgkmcnt(6)
    ds_read_b64_tr_b16 a[164:165], v40 offset:17408
    ds_read_b64_tr_b16 a[166:167], v40 offset:17920
    v_mfma_f32_32x32x16_bf16 v[128:143], a[144:147], a[48:51], v[128:143]
    ds_read_b64_tr_b16 a[168:169], v41 offset:0
    ds_read_b64_tr_b16 a[170:171], v41 offset:512
    s_xor_b32 s3, s64, 3
    s_lshl_b32 s3, s3, 1
    s_mul_i32 s3, s3, 2359296
    s_add_u32 s70, s3, s66
    buffer_load_dwordx4 v[240:243], v2, s[20:23], s70 offen offset:0 sc1
    buffer_load_dwordx4 v[244:247], v2, s[20:23], s70 offen offset:1024 sc1
    v_mfma_f32_32x32x16_bf16 v[128:143], a[148:151], a[52:55], v[128:143]
    s_waitcnt lgkmcnt(6)
    ds_read_b64_tr_b16 a[172:173], v41 offset:1024
    ds_read_b64_tr_b16 a[174:175], v41 offset:1536
    v_mfma_f32_32x32x16_bf16 v[128:143], a[152:155], a[56:59], v[128:143]
    ds_read_b64_tr_b16 a[144:145], v41 offset:2048
    ds_read_b64_tr_b16 a[146:147], v41 offset:2560
    s_xor_b32 s3, s64, 3
    s_lshl_b32 s3, s3, 1
    s_add_u32 s3, s3, 1
    s_mul_i32 s3, s3, 2359296
    s_add_u32 s70, s3, s66
    buffer_load_dwordx4 v[248:251], v2, s[20:23], s70 offen offset:0 sc1
    buffer_load_dwordx4 v[252:255], v2, s[20:23], s70 offen offset:1024 sc1
    v_mfma_f32_32x32x16_bf16 v[128:143], a[156:159], a[60:63], v[128:143]
    s_waitcnt lgkmcnt(6)
    ds_read_b64_tr_b16 a[148:149], v41 offset:3072
    ds_read_b64_tr_b16 a[150:151], v41 offset:3584
    v_mfma_f32_32x32x16_bf16 v[128:143], a[160:163], a[64:67], v[128:143]
    ds_read_b64_tr_b16 a[152:153], v41 offset:4096
    ds_read_b64_tr_b16 a[154:155], v41 offset:4608
    s_waitcnt vmcnt(10)
    s_add_u32 s3, s68, 11392
    s_mov_b64 exec, 1
    s_cmp_lg_u32 s37, 0
    s_cbranch_scc1 M_V7
    buffer_store_dword v37, v19, s[20:23], s3 offen nt
M_W7:
    s_mov_b64 exec, -1
    v_mfma_f32_32x32x16_bf16 v[128:143], a[164:167], a[68:71], v[128:143]
    s_waitcnt lgkmcnt(6)
    ds_read_b64_tr_b16 a[156:157], v41 offset:5120
    ds_read_b64_tr_b16 a[158:159], v41 offset:5632
    v_mfma_f32_32x32x16_bf16 v[128:143], a[168:171], a[72:75], v[128:143]
    ds_read_b64_tr_b16 a[160:161], v41 offset:6144
    ds_read_b64_tr_b16 a[162:163], v41 offset:6656
    v_mfma_f32_32x32x16_bf16 v[128:143], a[172:175], a[76:79], v[128:143]
    s_waitcnt lgkmcnt(6)
    ds_read_b64_tr_b16 a[164:165], v41 offset:7168
    ds_read_b64_tr_b16 a[166:167], v41 offset:7680
    s_waitcnt vmcnt(10)
    v_cmp_eq_u32 s[70:71], 6, v18
    v_cmp_ne_u32 vcc, s2, v84
    s_nop 0
    s_and_b64 vcc, vcc, s[70:71]
    s_cbranch_scc1 M_SPL3
M_SRL3:
    v_mfma_f32_32x32x16_bf16 v[128:143], a[144:147], a[80:83], v[128:143]
    ds_read_b64_tr_b16 a[168:169], v41 offset:8192
    ds_read_b64_tr_b16 a[170:171], v41 offset:8704
    s_xor_b32 s3, s64, 1
    s_lshl_b32 s3, s3, 1
    s_sub_u32 s3, s3, s39
    s_mul_i32 s3, s3, 2359296
    s_add_u32 s70, s3, s68
    s_and_b32 s3, s39, 1
    s_lshl_b32 s3, s3, 11
    s_add_u32 s70, s70, s3
    s_add_u32 s70, s70, 12288
    buffer_load_dwordx4 v[160:163], v2, s[20:23], s70 offen offset:0 sc1
    buffer_load_dwordx4 v[164:167], v2, s[20:23], s70 offen offset:1024 sc1
    v_mfma_f32_32x32x16_bf16 v[128:143], a[148:151], a[84:87], v[128:143]
    s_waitcnt lgkmcnt(6)
    ds_read_b64_tr_b16 a[172:173], v41 offset:9216
    ds_read_b64_tr_b16 a[174:175], v41 offset:9728
    v_mfma_f32_32x32x16_bf16 v[128:143], a[152:155], a[88:91], v[128:143]
    ds_read_b64_tr_b16 a[144:145], v41 offset:10240
    ds_read_b64_tr_b16 a[146:147], v41 offset:10752
    s_xor_b32 s3, s64, 1
    s_lshl_b32 s3, s3, 1
    s_add_u32 s3, s3, 1
    s_sub_u32 s3, s3, s39
    s_mul_i32 s3, s3, 2359296
    s_add_u32 s70, s3, s68
    s_and_b32 s3, s39, 1
    s_lshl_b32 s3, s3, 11
    s_add_u32 s70, s70, s3
    s_add_u32 s70, s70, 12288
    buffer_load_dwordx4 v[168:171], v2, s[20:23], s70 offen offset:0 sc1
    buffer_load_dwordx4 v[172:175], v2, s[20:23], s70 offen offset:1024 sc1
    v_mfma_f32_32x32x16_bf16 v[128:143], a[156:159], a[92:95], v[128:143]
    s_waitcnt lgkmcnt(6)
    ds_read_b64_tr_b16 a[148:149], v41 offset:11264
    ds_read_b64_tr_b16 a[150:151], v41 offset:11776
    v_mfma_f32_32x32x16_bf16 v[128:143], a[160:163], a[96:99], v[128:143]
    ds_read_b64_tr_b16 a[152:153], v41 offset:12288
    ds_read_b64_tr_b16 a[154:155], v41 offset:12800
    v_mfma_f32_32x32x16_bf16 v[128:143], a[164:167], a[100:103], v[128:143]
    s_waitcnt lgkmcnt(6)
    ds_read_b64_tr_b16 a[156:157], v41 offset:13312
    ds_read_b64_tr_b16 a[158:159], v41 offset:13824
    v_mfma_f32_32x32x16_bf16 v[128:143], a[168:171], a[104:107], v[128:143]
    ds_read_b64_tr_b16 a[160:161], v41 offset:14336
    ds_read_b64_tr_b16 a[162:163], v41 offset:14848
    v_mfma_f32_32x32x16_bf16 v[128:143], a[172:175], a[108:111], v[128:143]
    s_waitcnt lgkmcnt(6)
    ds_read_b64_tr_b16 a[164:165], v41 offset:15360
    ds_read_b64_tr_b16 a[166:167], v41 offset:15872
    v_mfma_f32_32x32x16_bf16 v[128:143], a[144:147], a[112:115], v[128:143]
    ds_read_b64_tr_b16 a[168:169], v41 offset:16384
    ds_read_b64_tr_b16 a[170:171], v41 offset:16896
    v_mfma_f32_32x32x16_bf16 v[128:143], a[148:151], a[116:119], v[128:143]
    s_waitcnt lgkmcnt(6)
    ds_read_b64_tr_b16 a[172:173], v41 offset:17408
    ds_read_b64_tr_b16 a[174:175], v41 offset:17920
    v_mfma_f32_32x32x16_bf16 v[128:143], a[152:155], a[120:123], v[128:143]
    s_mul_i32 s72, s39, 2359296
    s_sub_u32 s72, s68, s72
    buffer_load_dword v84, v86, s[20:23], s72 offen sc1
    v_mfma_f32_32x32x16_bf16 v[128:143], a[156:159], a[124:127], v[128:143]
    s_waitcnt lgkmcnt(4)
    v_mfma_f32_32x32x16_bf16 v[128:143], a[160:163], a[128:131], v[128:143]
    v_mfma_f32_32x32x16_bf16 v[128:143], a[164:167], a[132:135], v[128:143]
    s_waitcnt lgkmcnt(0)
    v_mfma_f32_32x32x16_bf16 v[128:143], a[168:171], a[136:139], v[128:143]
    v_mfma_f32_32x32x16_bf16 v[128:143], a[172:175], a[140:143], v[128:143]
    s_nop 11
    v_add_f32 v48, v48, v128
    v_add_f32 v49, v49, v129
    v_add_f32 v50, v50, v130
    v_add_f32 v51, v51, v131
    v_add_f32 v52, v52, v132
    v_add_f32 v53, v53, v133
    v_add_f32 v54, v54, v134
    v_add_f32 v55, v55, v135
    v_add_f32 v56, v56, v136
    v_add_f32 v57, v57, v137
    v_add_f32 v58, v58, v138
    v_add_f32 v59, v59, v139
    v_add_f32 v60, v60, v140
    v_add_f32 v61, v61, v141
    v_add_f32 v62, v62, v142
    v_add_f32 v63, v63, v143
    s_waitcnt vmcnt(0)
    v_cmp_eq_u32 s[70:71], 7, v18
    v_cmp_ne_u32 vcc, s2, v84
    s_nop 0
    s_and_b64 vcc, vcc, s[70:71]
    s_cbranch_scc1 M_SPU
M_SRU:
    s_xor_b32 s3, s39, 1
    s_sub_u32 s3, s3, s39
    s_mul_i32 s3, s3, 2359296
    s_add_u32 s70, s3, s68
    s_add_u32 s70, s70, 16384
    buffer_load_dwordx4 v[176:179], v2, s[20:23], s70 offen offset:0 sc1
    buffer_load_dwordx4 v[180:183], v2, s[20:23], s70 offen offset:1024 sc1
    s_waitcnt vmcnt(16)
    v_cmp_ge_u32 s[70:71], 3, v18
    v_cmp_ne_u32 vcc, s2, v36
    s_nop 0
    s_and_b64 vcc, vcc, s[70:71]
    s_cbranch_scc1 M_SPT
M_SRT:
    s_lshl_b32 s3, s41, 11
    s_add_u32 s71, s46, s3
    s_add_u32 s71, s71, 12337152
    buffer_load_dword v96, v80, s[20:23], s71 offen sc1
    s_add_u32 s71, s71, 2359296
    buffer_load_dword v97, v80, s[20:23], s71 offen sc1
    s_add_u32 s71, s71, 2359296
    buffer_load_dword v98, v80, s[20:23], s71 offen sc1
    s_add_u32 s71, s71, 2359296
    buffer_load_dword v99, v80, s[20:23], s71 offen sc1
    s_add_u32 s71, s71, 2359296
    buffer_load_dword v100, v80, s[20:23], s71 offen sc1
    s_add_u32 s71, s71, 2359296
    buffer_load_dword v101, v80, s[20:23], s71 offen sc1
    s_add_u32 s71, s71, 2359296
    buffer_load_dword v102, v80, s[20:23], s71 offen sc1
    s_add_u32 s71, s71, 2359296
    buffer_load_dword v103, v80, s[20:23], s71 offen sc1
    s_mul_i32 s70, s41, 640
    s_lshl_b32 s3, s39, 6
    s_add_u32 s70, s70, s3
    s_mul_i32 s67, s40, 36864
    s_add_u32 s70, s70, s67
    s_mov_b32 s71, 0xc0088e99
    v_dot2_f32_bf16 v48, v224, s61, v48
    v_dot2_f32_bf16 v49, v224, s62, v49
    v_dot2_f32_bf16 v50, v225, s61, v50
    v_dot2_f32_bf16 v51, v225, s62, v51
    v_dot2_f32_bf16 v52, v226, s61, v52
    v_dot2_f32_bf16 v53, v226, s62, v53
    v_dot2_f32_bf16 v54, v227, s61, v54
    v_dot2_f32_bf16 v55, v227, s62, v55
    v_dot2_f32_bf16 v56, v228, s61, v56
    v_dot2_f32_bf16 v57, v228, s62, v57
    v_dot2_f32_bf16 v58, v229, s61, v58
    v_dot2_f32_bf16 v59, v229, s62, v59
    v_dot2_f32_bf16 v60, v230, s61, v60
    v_dot2_f32_bf16 v61, v230, s62, v61
    v_dot2_f32_bf16 v62, v231, s61, v62
    v_dot2_f32_bf16 v63, v231, s62, v63
    v_dot2_f32_bf16 v48, v232, s61, v48
    v_dot2_f32_bf16 v49, v232, s62, v49
    v_dot2_f32_bf16 v50, v233, s61, v50
    v_dot2_f32_bf16 v51, v233, s62, v51
    v_dot2_f32_bf16 v52, v234, s61, v52
    v_dot2_f32_bf16 v53, v234, s62, v53
    v_dot2_f32_bf16 v54, v235, s61, v54
    v_dot2_f32_bf16 v55, v235, s62, v55
    v_dot2_f32_bf16 v56, v236, s61, v56
    v_dot2_f32_bf16 v57, v236, s62, v57
    v_dot2_f32_bf16 v58, v237, s61, v58
    v_dot2_f32_bf16 v59, v237, s62, v59
    v_dot2_f32_bf16 v60, v238, s61, v60
    v_dot2_f32_bf16 v61, v238, s62, v61
    v_dot2_f32_bf16 v62, v239, s61, v62
    v_dot2_f32_bf16 v63, v239, s62, v63
    v_dot2_f32_bf16 v48, v240, s61, v48
    v_dot2_f32_bf16 v49, v240, s62, v49
    v_dot2_f32_bf16 v50, v241, s61, v50
    v_dot2_f32_bf16 v51, v241, s62, v51
    v_dot2_f32_bf16 v52, v242, s61, v52
    v_dot2_f32_bf16 v53, v242, s62, v53
    v_dot2_f32_bf16 v54, v243, s61, v54
    v_dot2_f32_bf16 v55, v243, s62, v55
    v_dot2_f32_bf16 v56, v244, s61, v56
    v_dot2_f32_bf16 v57, v244, s62, v57
    v_dot2_f32_bf16 v58, v245, s61, v58
    v_dot2_f32_bf16 v59, v245, s62, v59
    v_dot2_f32_bf16 v60, v246, s61, v60
    v_dot2_f32_bf16 v61, v246, s62, v61
    v_dot2_f32_bf16 v62, v247, s61, v62
    v_dot2_f32_bf16 v63, v247, s62, v63
    v_dot2_f32_bf16 v48, v248, s61, v48
    v_dot2_f32_bf16 v49, v248, s62, v49
    v_dot2_f32_bf16 v50, v249, s61, v50
    v_dot2_f32_bf16 v51, v249, s62, v51
    v_dot2_f32_bf16 v52, v250, s61, v52
    v_dot2_f32_bf16 v53, v250, s62, v53
    v_dot2_f32_bf16 v54, v251, s61, v54
    v_dot2_f32_bf16 v55, v251, s62, v55
    v_dot2_f32_bf16 v56, v252, s61, v56
    v_dot2_f32_bf16 v57, v252, s62, v57
    v_dot2_f32_bf16 v58, v253, s61, v58
    v_dot2_f32_bf16 v59, v253, s62, v59
    v_dot2_f32_bf16 v60, v254, s61, v60
    v_dot2_f32_bf16 v61, v254, s62, v61
    v_dot2_f32_bf16 v62, v255, s61, v62
    v_dot2_f32_bf16 v63, v255, s62, v63
    v_dot2_f32_bf16 v48, v160, s61, v48
    v_dot2_f32_bf16 v49, v160, s62, v49
    v_dot2_f32_bf16 v50, v161, s61, v50
    v_dot2_f32_bf16 v51, v161, s62, v51
    v_dot2_f32_bf16 v52, v162, s61, v52
    v_dot2_f32_bf16 v53, v162, s62, v53
    v_dot2_f32_bf16 v54, v163, s61, v54
    v_dot2_f32_bf16 v55, v163, s62, v55
    v_dot2_f32_bf16 v56, v164, s61, v56
    v_dot2_f32_bf16 v57, v164, s62, v57
    v_dot2_f32_bf16 v58, v165, s61, v58
    v_dot2_f32_bf16 v59, v165, s62, v59
    v_dot2_f32_bf16 v60, v166, s61, v60
    v_dot2_f32_bf16 v61, v166, s62, v61
    v_dot2_f32_bf16 v62, v167, s61, v62
    v_dot2_f32_bf16 v63, v167, s62, v63
    v_dot2_f32_bf16 v48, v168, s61, v48
    v_dot2_f32_bf16 v49, v168, s62, v49
    v_dot2_f32_bf16 v50, v169, s61, v50
    v_dot2_f32_bf16 v51, v169, s62, v51
    v_dot2_f32_bf16 v52, v170, s61, v52
    v_dot2_f32_bf16 v53, v170, s62, v53
    v_dot2_f32_bf16 v54, v171, s61, v54
    v_dot2_f32_bf16 v55, v171, s62, v55
    v_dot2_f32_bf16 v56, v172, s61, v56
    v_dot2_f32_bf16 v57, v172, s62, v57
    v_dot2_f32_bf16 v58, v173, s61, v58
    v_dot2_f32_bf16 v59, v173, s62, v59
    v_dot2_f32_bf16 v60, v174, s61, v60
    v_dot2_f32_bf16 v61, v174, s62, v61
    v_dot2_f32_bf16 v62, v175, s61, v62
    v_dot2_f32_bf16 v63, v175, s62, v63
    s_waitcnt vmcnt(8)
    v_dot2_f32_bf16 v48, v176, s61, v48
    v_dot2_f32_bf16 v49, v176, s62, v49
    v_dot2_f32_bf16 v50, v177, s61, v50
    v_dot2_f32_bf16 v51, v177, s62, v51
    v_dot2_f32_bf16 v52, v178, s61, v52
    v_dot2_f32_bf16 v53, v178, s62, v53
    v_dot2_f32_bf16 v54, v179, s61, v54
    v_dot2_f32_bf16 v55, v179, s62, v55
    v_dot2_f32_bf16 v56, v180, s61, v56
    v_dot2_f32_bf16 v57, v180, s62, v57
    v_dot2_f32_bf16 v58, v181, s61, v58
    v_dot2_f32_bf16 v59, v181, s62, v59
    v_dot2_f32_bf16 v60, v182, s61, v60
    v_dot2_f32_bf16 v61, v182, s62, v61
    v_dot2_f32_bf16 v62, v183, s61, v62
    v_dot2_f32_bf16 v63, v183, s62, v63
    v_mul_f32 v48, s71, v48
    v_mul_f32 v49, s71, v49
    v_mul_f32 v50, s71, v50
    v_mul_f32 v51, s71, v51
    v_mul_f32 v52, s71, v52
    v_mul_f32 v53, s71, v53
    v_mul_f32 v54, s71, v54
    v_mul_f32 v55, s71, v55
    v_mul_f32 v56, s71, v56
    v_mul_f32 v57, s71, v57
    v_mul_f32 v58, s71, v58
    v_mul_f32 v59, s71, v59
    v_mul_f32 v60, s71, v60
    v_mul_f32 v61, s71, v61
    v_mul_f32 v62, s71, v62
    v_mul_f32 v63, s71, v63
    v_cvt_pk_bf16_f32 v28, v48, v49
    v_cvt_pk_bf16_f32 v29, v50, v51
    v_cvt_pk_bf16_f32 v30, v52, v53
    v_cvt_pk_bf16_f32 v31, v54, v55
    v_cvt_pk_bf16_f32 v32, v56, v57
    v_cvt_pk_bf16_f32 v33, v58, v59
    v_cvt_pk_bf16_f32 v34, v60, v61
    v_cvt_pk_bf16_f32 v35, v62, v63
    v_permlane32_swap_b32 v28, v30
    v_permlane32_swap_b32 v29, v31
    buffer_store_dwordx4 v[28:31], v83, s[32:35], s70 offen offset:0
    v_permlane32_swap_b32 v32, v34
    v_permlane32_swap_b32 v33, v35
    buffer_store_dwordx4 v[32:35], v83, s[32:35], s70 offen offset:32
    s_waitcnt vmcnt(2)
    v_dot2_f32_bf16 v104, v96, s61, 0
    v_dot2_f32_bf16 v105, v96, s62, 0
    v_dot2_f32_bf16 v104, v97, s61, v104
    v_dot2_f32_bf16 v105, v97, s62, v105
    v_dot2_f32_bf16 v104, v98, s61, v104
    v_dot2_f32_bf16 v105, v98, s62, v105
    v_dot2_f32_bf16 v104, v99, s61, v104
    v_dot2_f32_bf16 v105, v99, s62, v105
    v_dot2_f32_bf16 v104, v100, s61, v104
    v_dot2_f32_bf16 v105, v100, s62, v105
    v_dot2_f32_bf16 v104, v101, s61, v104
    v_dot2_f32_bf16 v105, v101, s62, v105
    v_dot2_f32_bf16 v104, v102, s61, v104
    v_dot2_f32_bf16 v105, v102, s62, v105
    v_dot2_f32_bf16 v104, v103, s61, v104
    v_dot2_f32_bf16 v105, v103, s62, v105
    s_nop 1
    v_mul_f32 v104, s71, v104
    v_mul_f32 v105, s71, v105
    v_dot2_f32_bf16 v104, v107, s61, v104
    v_dot2_f32_bf16 v105, v107, s62, v105
    v_dot2_f32_bf16 v104, v106, s61, v104
    v_dot2_f32_bf16 v105, v106, s62, v105
    s_nop 2
    v_cvt_pk_bf16_f32 v104, v104, v105
    buffer_store_dword v104, v81, s[32:35], s67 offen
    s_endpgm
M_SPX0:
    s_mov_b32 s3, 0x8000
M_SLX0:
    s_sleep 6
    s_xor_b32 s70, s56, 8192
    buffer_load_dword v36, v19, s[20:23], s70 offen offset:0 sc1
    s_waitcnt vmcnt(0)
    v_cmp_ne_u32 vcc, s2, v36
    s_nop 0
    s_cmp_lg_u64 vcc, 0
    s_cbranch_scc0 M_SRX0
    s_sub_u32 s3, s3, 1
    s_cmp_lg_u32 s3, 0
    s_cbranch_scc1 M_SLX0
    s_branch M_SRX0
M_SPX1:
    s_mov_b32 s3, 0x8000
M_SLX1:
    s_sleep 6
    s_xor_b32 s70, s56, 8192
    buffer_load_dword v36, v19, s[20:23], s70 offen offset:4 sc1
    s_waitcnt vmcnt(0)
    v_cmp_ne_u32 vcc, s2, v36
    s_nop 0
    s_cmp_lg_u64 vcc, 0
    s_cbranch_scc0 M_SRX1
    s_sub_u32 s3, s3, 1
    s_cmp_lg_u32 s3, 0
    s_cbranch_scc1 M_SLX1
    s_branch M_SRX1
M_SPX2:
    s_mov_b32 s3, 0x8000
M_SLX2:
    s_sleep 6
    s_xor_b32 s70, s56, 8192
    buffer_load_dword v36, v19, s[20:23], s70 offen offset:8 sc1
    s_waitcnt vmcnt(0)
    v_cmp_ne_u32 vcc, s2, v36
    s_nop 0
    s_cmp_lg_u64 vcc, 0
    s_cbranch_scc0 M_SRX2
    s_sub_u32 s3, s3, 1
    s_cmp_lg_u32 s3, 0
    s_cbranch_scc1 M_SLX2
    s_branch M_SRX2
M_SPX3:
    s_mov_b32 s3, 0x8000
M_SLX3:
    s_sleep 6
    s_xor_b32 s70, s56, 8192
    buffer_load_dword v36, v19, s[20:23], s70 offen offset:12 sc1
    s_waitcnt vmcnt(0)
    v_cmp_ne_u32 vcc, s2, v36
    s_nop 0
    s_cmp_lg_u64 vcc, 0
    s_cbranch_scc0 M_SRX3
    s_sub_u32 s3, s3, 1
    s_cmp_lg_u32 s3, 0
    s_cbranch_scc1 M_SLX3
    s_branch M_SRX3
M_SPX4:
    s_mov_b32 s3, 0x8000
M_SLX4:
    s_sleep 6
    s_xor_b32 s70, s56, 8192
    buffer_load_dword v36, v19, s[20:23], s70 offen offset:16 sc1
    s_waitcnt vmcnt(0)
    v_cmp_ne_u32 vcc, s2, v36
    s_nop 0
    s_cmp_lg_u64 vcc, 0
    s_cbranch_scc0 M_SRX4
    s_sub_u32 s3, s3, 1
    s_cmp_lg_u32 s3, 0
    s_cbranch_scc1 M_SLX4
    s_branch M_SRX4
M_SPF2:
    s_mov_b32 s3, 0x8000
M_SLF2:
    s_sleep 6
    buffer_load_dword v36, v14, s[20:23], s65 offen sc1
    s_waitcnt vmcnt(0)
    v_cmp_ge_u32 s[70:71], 2, v18
    v_cmp_ne_u32 vcc, s2, v36
    s_nop 0
    s_and_b64 vcc, vcc, s[70:71]
    s_cbranch_scc0 M_SRF2
    s_sub_u32 s3, s3, 1
    s_cmp_lg_u32 s3, 0
    s_cbranch_scc1 M_SLF2
    s_branch M_SRF2
M_SPL3:
    s_mov_b32 s3, 0x8000
M_SLL3:
    s_mul_i32 s72, s39, 2359296
    s_sub_u32 s72, s68, s72
    buffer_load_dword v84, v86, s[20:23], s72 offen sc1
    s_waitcnt vmcnt(0)
    v_cmp_eq_u32 s[70:71], 6, v18
    v_cmp_ne_u32 vcc, s2, v84
    s_nop 0
    s_and_b64 vcc, vcc, s[70:71]
    s_cbranch_scc0 M_SRL3
    s_sub_u32 s3, s3, 1
    s_cmp_lg_u32 s3, 0
    s_cbranch_scc1 M_SLL3
    s_branch M_SRL3
M_SPU:
    s_mov_b32 s3, 0x8000
M_SLU:
    s_mul_i32 s72, s39, 2359296
    s_sub_u32 s72, s68, s72
    buffer_load_dword v84, v86, s[20:23], s72 offen sc1
    s_waitcnt vmcnt(0)
    v_cmp_eq_u32 s[70:71], 7, v18
    v_cmp_ne_u32 vcc, s2, v84
    s_nop 0
    s_and_b64 vcc, vcc, s[70:71]
    s_cbranch_scc0 M_SRU
    s_sub_u32 s3, s3, 1
    s_cmp_lg_u32 s3, 0
    s_cbranch_scc1 M_SLU
    s_branch M_SRU
M_SPT:
    s_mov_b32 s3, 0x8000
M_SLT:
    buffer_load_dword v36, v14, s[20:23], s65 offen sc1
    s_waitcnt vmcnt(0)
    v_cmp_ge_u32 s[70:71], 3, v18
    v_cmp_ne_u32 vcc, s2, v36
    s_nop 0
    s_and_b64 vcc, vcc, s[70:71]
    s_cbranch_scc0 M_SRT
    s_sub_u32 s3, s3, 1
    s_cmp_lg_u32 s3, 0
    s_cbranch_scc1 M_SLT
    s_branch M_SRT
M_V0:
    buffer_store_dwordx4 v[28:31], v2, s[20:23], s63 offen offset:0 sc1
    s_nop 1
    s_branch M_W0
M_V1:
    buffer_store_dwordx4 v[32:35], v2, s[20:23], s63 offen offset:1024 sc1
    s_nop 1
    s_branch M_W1
M_V2:
    buffer_store_dwordx4 v[28:31], v2, s[20:23], s63 offen offset:2048 sc1
    s_nop 1
    s_branch M_W2
M_V3:
    buffer_store_dwordx4 v[32:35], v2, s[20:23], s63 offen offset:3072 sc1
    s_nop 1
    s_branch M_W3
M_V4:
    buffer_store_dword v37, v19, s[20:23], s3 offen sc1
    s_nop 1
    s_branch M_W4
M_V5:
    buffer_store_dwordx4 v[28:31], v2, s[20:23], s63 offen offset:0 sc1
    s_nop 1
    s_branch M_W5
M_V6:
    buffer_store_dwordx4 v[32:35], v2, s[20:23], s63 offen offset:1024 sc1
    s_nop 1
    s_branch M_W6
M_V7:
    buffer_store_dword v37, v19, s[20:23], s3 offen sc1
    s_nop 1
    s_branch M_W7
M_END:
    s_endpgm
M_SLOW:
    s_add_u32 m0, s42, 38912
    s_nop 0
    buffer_load_dwordx4 v2, s[20:23], m0 offen sc1 lds
    s_add_u32 m0, s42, 43008
    s_nop 0
    buffer_load_dwordx4 v2, s[20:23], m0 offen sc1 lds
    s_add_u32 m0, s42, 47104
    s_nop 0
    buffer_load_dwordx4 v2, s[20:23], m0 offen sc1 lds
    s_add_u32 m0, s42, 51200
    s_nop 0
    buffer_load_dwordx4 v2, s[20:23], m0 offen sc1 lds
    s_add_u32 m0, s43, 55296
    s_nop 0
    buffer_load_dwordx4 v2, s[20:23], m0 offen sc1 lds
    s_add_u32 m0, s42, 58368
    s_nop 0
    buffer_load_dwordx4 v2, s[20:23], m0 offen sc1 lds
    s_add_u32 m0, s42, 62464
    s_nop 0
    buffer_load_dwordx4 v2, s[20:23], m0 offen sc1 lds
    s_add_u32 m0, s42, 66560
    s_nop 0
    buffer_load_dwordx4 v2, s[20:23], m0 offen sc1 lds
    s_add_u32 m0, s42, 70656
    s_nop 0
    buffer_load_dwordx4 v2, s[20:23], m0 offen sc1 lds
    s_add_u32 m0, s43, 74752
    s_nop 0
    buffer_load_dwordx4 v2, s[20:23], m0 offen sc1 lds
    s_add_u32 m0, s42, 77824
    s_nop 0
    buffer_load_dwordx4 v2, s[20:23], m0 offen sc1 lds
    s_add_u32 m0, s42, 81920
    s_nop 0
    buffer_load_dwordx4 v2, s[20:23], m0 offen sc1 lds
    s_add_u32 m0, s42, 86016
    s_nop 0
    buffer_load_dwordx4 v2, s[20:23], m0 offen sc1 lds
    s_add_u32 m0, s42, 90112
    s_nop 0
    buffer_load_dwordx4 v2, s[20:23], m0 offen sc1 lds
    s_add_u32 m0, s43, 94208
    s_nop 0
    buffer_load_dwordx4 v2, s[20:23], m0 offen sc1 lds
    s_add_u32 m0, s42, 97280
    s_nop 0
    buffer_load_dwordx4 v2, s[20:23], m0 offen sc1 lds
    s_add_u32 m0, s42, 101376
    s_nop 0
    buffer_load_dwordx4 v2, s[20:23], m0 offen sc1 lds
    s_add_u32 m0, s42, 105472
    s_nop 0
    buffer_load_dwordx4 v2, s[20:23], m0 offen sc1 lds
    s_add_u32 m0, s42, 109568
    s_nop 0
    buffer_load_dwordx4 v2, s[20:23], m0 offen sc1 lds
    s_add_u32 m0, s43, 113664
    s_nop 0
    buffer_load_dwordx4 v2, s[20:23], m0 offen sc1 lds
    s_add_u32 m0, s42, 116736
    s_nop 0
    buffer_load_dwordx4 v2, s[20:23], m0 offen sc1 lds
    s_add_u32 m0, s42, 120832
    s_nop 0
    buffer_load_dwordx4 v2, s[20:23], m0 offen sc1 lds
    s_add_u32 m0, s42, 124928
    s_nop 0
    buffer_load_dwordx4 v2, s[20:23], m0 offen sc1 lds
    s_add_u32 m0, s42, 129024
    s_nop 0
    buffer_load_dwordx4 v2, s[20:23], m0 offen sc1 lds
    s_add_u32 m0, s43, 133120
    s_nop 0
    buffer_load_dwordx4 v2, s[20:23], m0 offen sc1 lds
    s_add_u32 m0, s42, 136192
    s_nop 0
    buffer_load_dwordx4 v2, s[20:23], m0 offen sc1 lds
    s_add_u32 m0, s42, 140288
    s_nop 0
    buffer_load_dwordx4 v2, s[20:23], m0 offen sc1 lds
    s_add_u32 m0, s42, 144384
    s_nop 0
    buffer_load_dwordx4 v2, s[20:23], m0 offen sc1 lds
    s_add_u32 m0, s42, 148480
    s_nop 0
    buffer_load_dwordx4 v2, s[20:23], m0 offen sc1 lds
    s_add_u32 m0, s43, 152576
    s_nop 0
    buffer_load_dwordx4 v2, s[20:23], m0 offen sc1 lds
    buffer_load_dwordx2 a[184:185], v211, s[28:31], 0 offen offset:0
    buffer_load_dwordx2 a[186:187], v211, s[28:31], 0 offen offset:16
    buffer_load_dwordx2 a[188:189], v211, s[28:31], 0 offen offset:32
    buffer_load_dwordx2 a[190:191], v211, s[28:31], 0 offen offset:48
    buffer_load_dword a193, v212, s[28:31], 0 offen offset:512
    buffer_load_ushort a194, v213, s[24:27], 0 offen
    buffer_load_ushort a195, v214, s[24:27], 0 offen offset:512
    s_waitcnt vmcnt(0) lgkmcnt(0)
    s_barrier
    v_mov_b32 v17, 0
    v_mov_b32 v19, 0
    v_mov_b32 v6, 0xff800000
    v_mov_b32 v7, 0xff800000
    v_mov_b32 v177, v176
    v_mov_b32 v180, v179
    s_mov_b32 s46, 32
M_S1:
    ds_read_b32 v28, v180 offset:0
    ds_read_b128 v[20:23], v177 offset:0
    ds_read_b128 v[24:27], v177 offset:1024
    s_waitcnt lgkmcnt(0)
    v_mfma_f32_32x32x4_2b_bf16 v[48:79], v[28:29], v[16:17], 0
    v_mfma_f32_32x32x4_2b_bf16 v[80:111], v[28:29], v[18:19], 0
    s_nop 15
    s_nop 0
    v_mfma_f32_32x32x16_bf16 v[48:63], v[20:23], v[8:11], v[48:63]
    v_mfma_f32_32x32x16_bf16 v[64:79], v[24:27], v[8:11], v[64:79]
    v_mfma_f32_32x32x16_bf16 v[80:95], v[20:23], v[12:15], v[80:95]
    v_mfma_f32_32x32x16_bf16 v[96:111], v[24:27], v[12:15], v[96:111]
    s_nop 8
    v_max3_f32 v6, v48, v49, v6
    v_max3_f32 v6, v50, v51, v6
    v_max3_f32 v6, v52, v53, v6
    v_max3_f32 v6, v54, v55, v6
    v_max3_f32 v6, v56, v57, v6
    v_max3_f32 v6, v58, v59, v6
    v_max3_f32 v6, v60, v61, v6
    v_max3_f32 v6, v62, v63, v6
    v_max3_f32 v6, v64, v65, v6
    v_max3_f32 v6, v66, v67, v6
    v_max3_f32 v6, v68, v69, v6
    v_max3_f32 v6, v70, v71, v6
    v_max3_f32 v6, v72, v73, v6
    v_max3_f32 v6, v74, v75, v6
    v_max3_f32 v6, v76, v77, v6
    v_max3_f32 v6, v78, v79, v6
    v_max3_f32 v7, v80, v81, v7
    v_max3_f32 v7, v82, v83, v7
    v_max3_f32 v7, v84, v85, v7
    v_max3_f32 v7, v86, v87, v7
    v_max3_f32 v7, v88, v89, v7
    v_max3_f32 v7, v90, v91, v7
    v_max3_f32 v7, v92, v93, v7
    v_max3_f32 v7, v94, v95, v7
    v_max3_f32 v7, v96, v97, v7
    v_max3_f32 v7, v98, v99, v7
    v_max3_f32 v7, v100, v101, v7
    v_max3_f32 v7, v102, v103, v7
    v_max3_f32 v7, v104, v105, v7
    v_max3_f32 v7, v106, v107, v7
    v_max3_f32 v7, v108, v109, v7
    v_max3_f32 v7, v110, v111, v7
    v_add_u32 v177, 4864, v177
    v_add_u32 v180, 4864, v180
    s_sub_u32 s46, s46, 1
    s_cmp_lg_u32 s46, 0
    s_cbranch_scc1 M_S1
    v_mov_b32 v46, v6
    s_nop 1
    v_permlane32_swap_b32 v6, v46
    v_max_f32 v6, v6, v46
    v_mov_b32 v46, v7
    s_nop 1
    v_permlane32_swap_b32 v7, v46
    v_max_f32 v7, v7, v46
    s_mov_b32 s46, 32
M_S2:
    ds_read_b32 v28, v179 offset:0
    ds_read_b128 v[20:23], v176 offset:0
    ds_read_b128 v[24:27], v176 offset:1024
    ds_read_b128 v[32:35], v182 offset:0
    ds_read_b128 v[36:39], v182 offset:640
    ds_read_b128 v[40:43], v182 offset:1280
    ds_read_b128 v[44:47], v182 offset:1920
    s_waitcnt lgkmcnt(0)
    v_mfma_f32_32x32x4_2b_bf16 v[48:79], v[28:29], v[16:17], 0
    v_mfma_f32_32x32x4_2b_bf16 v[80:111], v[28:29], v[18:19], 0
    s_nop 15
    s_nop 0
    v_mfma_f32_32x32x16_bf16 v[48:63], v[20:23], v[8:11], v[48:63]
    v_mfma_f32_32x32x16_bf16 v[64:79], v[24:27], v[8:11], v[64:79]
    v_mfma_f32_32x32x16_bf16 v[80:95], v[20:23], v[12:15], v[80:95]
    v_mfma_f32_32x32x16_bf16 v[96:111], v[24:27], v[12:15], v[96:111]
    s_nop 8
    v_sub_f32 v48, v48, v6
    v_sub_f32 v49, v49, v6
    v_sub_f32 v50, v50, v6
    v_sub_f32 v51, v51, v6
    v_sub_f32 v52, v52, v6
    v_sub_f32 v53, v53, v6
    v_sub_f32 v54, v54, v6
    v_sub_f32 v55, v55, v6
    v_sub_f32 v56, v56, v6
    v_sub_f32 v57, v57, v6
    v_sub_f32 v58, v58, v6
    v_sub_f32 v59, v59, v6
    v_sub_f32 v60, v60, v6
    v_sub_f32 v61, v61, v6
    v_sub_f32 v62, v62, v6
    v_sub_f32 v63, v63, v6
    v_sub_f32 v64, v64, v6
    v_sub_f32 v65, v65, v6
    v_sub_f32 v66, v66, v6
    v_sub_f32 v67, v67, v6
    v_sub_f32 v68, v68, v6
    v_sub_f32 v69, v69, v6
    v_sub_f32 v70, v70, v6
    v_sub_f32 v71, v71, v6
    v_sub_f32 v72, v72, v6
    v_sub_f32 v73, v73, v6
    v_sub_f32 v74, v74, v6
    v_sub_f32 v75, v75, v6
    v_sub_f32 v76, v76, v6
    v_sub_f32 v77, v77, v6
    v_sub_f32 v78, v78, v6
    v_sub_f32 v79, v79, v6
    v_exp_f32 v48, v48
    v_exp_f32 v49, v49
    v_exp_f32 v50, v50
    v_exp_f32 v51, v51
    v_exp_f32 v52, v52
    v_exp_f32 v53, v53
    v_exp_f32 v54, v54
    v_exp_f32 v55, v55
    v_exp_f32 v56, v56
    v_exp_f32 v57, v57
    v_exp_f32 v58, v58
    v_exp_f32 v59, v59
    v_exp_f32 v60, v60
    v_exp_f32 v61, v61
    v_exp_f32 v62, v62
    v_exp_f32 v63, v63
    v_exp_f32 v64, v64
    v_exp_f32 v65, v65
    v_exp_f32 v66, v66
    v_exp_f32 v67, v67
    v_exp_f32 v68, v68
    v_exp_f32 v69, v69
    v_exp_f32 v70, v70
    v_exp_f32 v71, v71
    v_exp_f32 v72, v72
    v_exp_f32 v73, v73
    v_exp_f32 v74, v74
    v_exp_f32 v75, v75
    v_exp_f32 v76, v76
    v_exp_f32 v77, v77
    v_exp_f32 v78, v78
    v_exp_f32 v79, v79
    v_cvt_pk_bf16_f32 v112, v48, v49
    v_cvt_pk_bf16_f32 v113, v50, v51
    v_cvt_pk_bf16_f32 v114, v52, v53
    v_cvt_pk_bf16_f32 v115, v54, v55
    v_cvt_pk_bf16_f32 v116, v56, v57
    v_cvt_pk_bf16_f32 v117, v58, v59
    v_cvt_pk_bf16_f32 v118, v60, v61
    v_cvt_pk_bf16_f32 v119, v62, v63
    v_cvt_pk_bf16_f32 v120, v64, v65
    v_cvt_pk_bf16_f32 v121, v66, v67
    v_cvt_pk_bf16_f32 v122, v68, v69
    v_cvt_pk_bf16_f32 v123, v70, v71
    v_cvt_pk_bf16_f32 v124, v72, v73
    v_cvt_pk_bf16_f32 v125, v74, v75
    v_cvt_pk_bf16_f32 v126, v76, v77
    v_cvt_pk_bf16_f32 v127, v78, v79
    v_mfma_f32_32x32x16_bf16 v[144:159], v[32:35], v[112:115], v[144:159]
    v_mfma_f32_32x32x16_bf16 v[144:159], v[36:39], v[116:119], v[144:159]
    v_mfma_f32_32x32x16_bf16 v[144:159], v[40:43], v[120:123], v[144:159]
    v_mfma_f32_32x32x16_bf16 v[144:159], v[44:47], v[124:127], v[144:159]
    v_sub_f32 v80, v80, v7
    v_sub_f32 v81, v81, v7
    v_sub_f32 v82, v82, v7
    v_sub_f32 v83, v83, v7
    v_sub_f32 v84, v84, v7
    v_sub_f32 v85, v85, v7
    v_sub_f32 v86, v86, v7
    v_sub_f32 v87, v87, v7
    v_sub_f32 v88, v88, v7
    v_sub_f32 v89, v89, v7
    v_sub_f32 v90, v90, v7
    v_sub_f32 v91, v91, v7
    v_sub_f32 v92, v92, v7
    v_sub_f32 v93, v93, v7
    v_sub_f32 v94, v94, v7
    v_sub_f32 v95, v95, v7
    v_sub_f32 v96, v96, v7
    v_sub_f32 v97, v97, v7
    v_sub_f32 v98, v98, v7
    v_sub_f32 v99, v99, v7
    v_sub_f32 v100, v100, v7
    v_sub_f32 v101, v101, v7
    v_sub_f32 v102, v102, v7
    v_sub_f32 v103, v103, v7
    v_sub_f32 v104, v104, v7
    v_sub_f32 v105, v105, v7
    v_sub_f32 v106, v106, v7
    v_sub_f32 v107, v107, v7
    v_sub_f32 v108, v108, v7
    v_sub_f32 v109, v109, v7
    v_sub_f32 v110, v110, v7
    v_sub_f32 v111, v111, v7
    v_exp_f32 v80, v80
    v_exp_f32 v81, v81
    v_exp_f32 v82, v82
    v_exp_f32 v83, v83
    v_exp_f32 v84, v84
    v_exp_f32 v85, v85
    v_exp_f32 v86, v86
    v_exp_f32 v87, v87
    v_exp_f32 v88, v88
    v_exp_f32 v89, v89
    v_exp_f32 v90, v90
    v_exp_f32 v91, v91
    v_exp_f32 v92, v92
    v_exp_f32 v93, v93
    v_exp_f32 v94, v94
    v_exp_f32 v95, v95
    v_exp_f32 v96, v96
    v_exp_f32 v97, v97
    v_exp_f32 v98, v98
    v_exp_f32 v99, v99
    v_exp_f32 v100, v100
    v_exp_f32 v101, v101
    v_exp_f32 v102, v102
    v_exp_f32 v103, v103
    v_exp_f32 v104, v104
    v_exp_f32 v105, v105
    v_exp_f32 v106, v106
    v_exp_f32 v107, v107
    v_exp_f32 v108, v108
    v_exp_f32 v109, v109
    v_exp_f32 v110, v110
    v_exp_f32 v111, v111
    v_cvt_pk_bf16_f32 v128, v80, v81
    v_cvt_pk_bf16_f32 v129, v82, v83
    v_cvt_pk_bf16_f32 v130, v84, v85
    v_cvt_pk_bf16_f32 v131, v86, v87
    v_cvt_pk_bf16_f32 v132, v88, v89
    v_cvt_pk_bf16_f32 v133, v90, v91
    v_cvt_pk_bf16_f32 v134, v92, v93
    v_cvt_pk_bf16_f32 v135, v94, v95
    v_cvt_pk_bf16_f32 v136, v96, v97
    v_cvt_pk_bf16_f32 v137, v98, v99
    v_cvt_pk_bf16_f32 v138, v100, v101
    v_cvt_pk_bf16_f32 v139, v102, v103
    v_cvt_pk_bf16_f32 v140, v104, v105
    v_cvt_pk_bf16_f32 v141, v106, v107
    v_cvt_pk_bf16_f32 v142, v108, v109
    v_cvt_pk_bf16_f32 v143, v110, v111
    v_mfma_f32_32x32x16_bf16 v[160:175], v[32:35], v[128:131], v[160:175]
    v_mfma_f32_32x32x16_bf16 v[160:175], v[36:39], v[132:135], v[160:175]
    v_mfma_f32_32x32x16_bf16 v[160:175], v[40:43], v[136:139], v[160:175]
    v_mfma_f32_32x32x16_bf16 v[160:175], v[44:47], v[140:143], v[160:175]
    v_add_u32 v176, 4864, v176
    v_add_u32 v179, 4864, v179
    v_add_u32 v182, 4864, v182
    s_nop 7
    s_nop 7
    s_sub_u32 s46, s46, 1
    s_cmp_lg_u32 s46, 0
    s_cbranch_scc1 M_S2
    s_barrier
    s_add_u32 m0, s42, 0
    s_add_u32 s72, s64, 0
    buffer_load_dwordx4 v185, s[8:11], s72 offen lds
    s_add_u32 m0, s42, 4096
    s_add_u32 s72, s64, 0
    buffer_load_dwordx4 v187, s[8:11], s72 offen lds
    s_add_u32 m0, s42, 9216
    s_add_u32 s72, s64, 82944
    buffer_load_dwordx4 v185, s[8:11], s72 offen lds
    s_add_u32 m0, s42, 13312
    s_add_u32 s72, s64, 82944
    buffer_load_dwordx4 v187, s[8:11], s72 offen lds
    s_add_u32 m0, s42, 18432
    s_add_u32 s72, s64, 165888
    buffer_load_dwordx4 v185, s[8:11], s72 offen lds
    s_add_u32 m0, s42, 22528
    s_add_u32 s72, s64, 165888
    buffer_load_dwordx4 v187, s[8:11], s72 offen lds
    s_add_u32 m0, s42, 27648
    s_add_u32 s72, s64, 248832
    buffer_load_dwordx4 v185, s[8:11], s72 offen lds
    s_add_u32 m0, s42, 31744
    s_add_u32 s72, s64, 248832
    buffer_load_dwordx4 v187, s[8:11], s72 offen lds
    s_add_u32 m0, s42, 36864
    s_add_u32 s72, s64, 331776
    buffer_load_dwordx4 v185, s[8:11], s72 offen lds
    s_add_u32 m0, s42, 40960
    s_add_u32 s72, s64, 331776
    buffer_load_dwordx4 v187, s[8:11], s72 offen lds
    s_add_u32 m0, s42, 46080
    s_add_u32 s72, s64, 414720
    buffer_load_dwordx4 v185, s[8:11], s72 offen lds
    s_add_u32 m0, s42, 50176
    s_add_u32 s72, s64, 414720
    buffer_load_dwordx4 v187, s[8:11], s72 offen lds
    s_add_u32 m0, s42, 55296
    s_add_u32 s72, s64, 497664
    buffer_load_dwordx4 v185, s[8:11], s72 offen lds
    s_add_u32 m0, s42, 59392
    s_add_u32 s72, s64, 497664
    buffer_load_dwordx4 v187, s[8:11], s72 offen lds
    s_add_u32 m0, s42, 64512
    s_add_u32 s72, s64, 580608
    buffer_load_dwordx4 v185, s[8:11], s72 offen lds
    s_add_u32 m0, s42, 68608
    s_add_u32 s72, s64, 580608
    buffer_load_dwordx4 v187, s[8:11], s72 offen lds
    s_add_u32 m0, s42, 73728
    s_add_u32 s72, s64, 0
    buffer_load_dwordx4 v186, s[8:11], s72 offen lds
    s_add_u32 m0, s42, 77824
    s_add_u32 s72, s64, 0
    buffer_load_dwordx4 v188, s[8:11], s72 offen lds
    s_add_u32 m0, s66, 8192
    s_add_u32 s72, s65, 0
    buffer_load_dwordx4 v189, s[8:11], s72 offen lds
    s_add_u32 m0, s66, 45056
    s_add_u32 s72, s65, 331776
    buffer_load_dwordx4 v189, s[8:11], s72 offen lds
    s_mov_b32 m0, 81920
    s_nop 0
    buffer_load_dwordx4 v190, s[8:11], s64 offen lds
    s_branch M_EPI
M_CODE_END:
.section .rodata,"a"
.p2align 6
.amdhsa_kernel sequential_preLN__grouped_kv_mqa__mixer_channel_mlp__prompt_kernel
  .amdhsa_next_free_vgpr 492
  .amdhsa_next_free_sgpr 74
  .amdhsa_accum_offset 256
  .amdhsa_group_segment_fixed_size 0
  .amdhsa_kernarg_size 104
  .amdhsa_user_sgpr_count 2
  .amdhsa_user_sgpr_kernarg_segment_ptr 1
  .amdhsa_system_sgpr_workgroup_id_x 1
.end_amdhsa_kernel
```
